```python
import torch

def _softmax(x, axis=-1):
    return torch.softmax(x, dim=axis)
def _gelu(x):
    return torch.nn.functional.gelu(x, approximate="tanh")
def _silu(x):
    return torch.nn.functional.silu(x)
def _sigmoid(x):
    return torch.sigmoid(x)
def _layernorm(x, axis=-1, eps=1e-5):
    m = x.mean(dim=axis, keepdim=True)
    v = x.var(dim=axis, keepdim=True, unbiased=False)
    return (x - m) / torch.sqrt(v + eps)
def _scatter_add(tgt, idx, src, axis=0):
    return tgt.clone().index_add_(axis, idx, src)
def _segment_sum(src, seg, n):
    out = torch.zeros((n,) + src.shape[1:], dtype=src.dtype)
    return out.index_add_(0, seg, src)
def _pad(x, pw):
    flat = tuple(v for pair in reversed(pw) for v in pair)
    return torch.nn.functional.pad(x, flat)

kernel_name = 'recurrent_scan__linear_attn_block__dense_activation_gelu__prompt'

def setup_inputs():

    _w = (lambda a: (lambda t: t.to(torch.bfloat16) if t.is_floating_point() else t)(torch.as_tensor(a)))
    def _A_setup():
        B, S, D = 1, 2048, 512
        return {
            "x": _w((lambda *s: torch.randn(*s, dtype=torch.bfloat16) * 0.05)(B, S, D)),
            "wqkv": _w((lambda *s: torch.randn(*s, dtype=torch.bfloat16) * 0.2)(D, 3 * D)),
            "wo": _w((lambda *s: torch.randn(*s, dtype=torch.bfloat16) * 0.2)(D, D)),
        }
    _A_in = _A_setup()

    def _B_setup():
        B, S, D, F = 1, 2048, 512, 1792
        return {
            "x": _w((lambda *s: torch.randn(*s, dtype=torch.bfloat16) * 0.05)(B, S, D)),
            "w1": _w((lambda *s: torch.randn(*s, dtype=torch.bfloat16) * 0.4)(D, F) * (D ** -0.5)),
            "b1": _w((lambda *s: torch.randn(*s, dtype=torch.bfloat16) * 12.8)(F) * 0.01),
            "w2": _w((lambda *s: torch.randn(*s, dtype=torch.bfloat16) * 0.1)(F, D) * (F ** -0.5)),
            "b2": _w((lambda *s: torch.randn(*s, dtype=torch.bfloat16) * 1.6)(D) * 0.01),
        }
    _B_in = _B_setup()

    return {
        "A_x": _A_in["x"],
        "A_wqkv": _A_in["wqkv"],
        "A_wo": _A_in["wo"],
        "B_x": _B_in["x"],
        "B_w1": _B_in["w1"],
        "B_b1": _B_in["b1"],
        "B_w2": _B_in["w2"],
        "B_b2": _B_in["b2"],
    }

def reference(A_x, A_wqkv, A_wo, B_x, B_w1, B_b1, B_w2, B_b2):
    def _A_ref(x, wqkv, wo):
        B, S, D = x.shape
        H = 32; Dh = D // H
        qkv = (lambda x, *d: x.permute(*d))((x @ wqkv).reshape(B, S, 3, H, Dh), 2, 0, 3, 1, 4)
        q, k, v = qkv[0], qkv[1], qkv[2]
        phi = lambda t: torch.where(t > 0, t + 1, torch.exp(t)) + 1e-6
        pq, pk = phi(q), phi(k)
        kv = torch.einsum("bhsd,bhse->bhde", pk, v)
        z = torch.einsum("bhsd->bhd", pk)
        num = torch.einsum("bhqd,bhde->bhqe", pq, kv)
        den = torch.einsum("bhqd,bhd->bhq", pq, z)[..., None] + 1e-6
        o = num / den
        return (lambda x, *d: x.permute(*d))(o, 0, 2, 1, 3).reshape(B, S, D) @ wo

    def _B_ref(x, w1, b1, w2, b2):
        h = torch.einsum("bsd,df->bsf", x, w1) + b1
        h = _gelu(h)
        return torch.einsum("bsf,fd->bsd", h, w2) + b2

    x = A_x
    xn = _layernorm(x, axis=-1)
    s = _A_ref(xn, A_wqkv, A_wo)
    g = _silu(_B_ref(xn, B_w1, B_b1, B_w2, B_b2))
    return x + s * g
```

```asm
; @launch grid=(256,1,1) block=(512,1,1) lds=163840
.amdgcn_target "amdgcn-amd-amdhsa--gfx950"
.text
.p2align 12
.globl recurrent_scan__linear_attn_block__dense_activation_gelu__prompt_kernel
.p2align 8
.type recurrent_scan__linear_attn_block__dense_activation_gelu__prompt_kernel,@function
recurrent_scan__linear_attn_block__dense_activation_gelu__prompt_kernel:

    s_load_dwordx2 s[8:9], s[0:1], 0
    s_load_dwordx2 s[16:17], s[0:1], 32
    s_cmp_ge_u32 s2, 256
    s_cbranch_scc1 L_exit
    v_lshrrev_b32 v2, 6, v0
    v_lshrrev_b32 v112, 3, v0
    v_and_b32 v17, 7, v0
    v_readfirstlane_b32 s50, v2
    s_bfe_u32 s67, s2, 0x30003
    s_lshr_b32 s77, s2, 6
    s_and_b32 s78, s2, 1
    s_lshl3_add_u32 s75, s78, s67
    s_lshl_b32 s53, s75, 17
    s_add_u32 s69, s53, 65536
    s_mov_b32 s79, s67
    s_lshl_b32 s79, s79, 3
    s_and_b32 s3, s79, 63
    v_bfe_u32 v18, v0, 4, 3
    v_xor_b32 v18, v17, v18
    v_lshlrev_b32 v18, 4, v18
    v_lshl_add_u32 v2, v112, 10, v18
    s_bitcmp1_b32 s2, 6
    s_cselect_b32 s82, 12, 9
    s_cselect_b32 s83, 14, 8
    s_cselect_b32 s76, 0, 64
    s_lshl_b32 s51, s50, 10
    s_lshl_b32 s82, s82, 13
    s_add_u32 s82, s82, s51
    s_mov_b32 s10, 2097152
    s_mov_b32 s11, 0x20000
    s_mov_b32 m0, s82
    s_lshl4_add_u32 s62, s3, s53
    s_waitcnt lgkmcnt(0)
    buffer_load_dwordx4 v2, s[8:11], s62 offen lds
    s_add_u32 m0, s82, 8192
    s_lshl4_add_u32 s62, s3, s69
    buffer_load_dwordx4 v2, s[8:11], s62 offen lds
    s_bfe_u32 s80, s2, 0x20001
    s_mul_i32 s81, s80, 448
    s_bitcmp1_b32 s2, 6
    s_cselect_b32 s84, 3, 2
    s_lshr_b32 s85, s2, 7
    s_mul_i32 s86, s85, 96
    s_lshl_b32 s86, s86, s84
    s_add_u32 s76, s76, s81
    s_lshl1_add_u32 s54, s76, s86
    v_bfe_u32 v18, v0, 4, 1
    v_lshlrev_b32 v18, 2, v18
    v_xor_b32 v18, v17, v18
    v_lshlrev_b32 v113, 4, v18
    s_movk_i32 s62, 3584
    v_mad_u32_u24 v4, v112, s62, v113
    s_mov_b32 s18, 1835008
    s_mov_b32 s19, 0x20000
    s_lshl_b32 s83, s83, 13
    s_add_u32 s83, s83, s51
    s_mov_b32 m0, s83
    s_mul_i32 s62, s3, 28672
    s_add_u32 s62, s62, s54
    buffer_load_dwordx4 v4, s[16:19], s62 offen lds
    s_cmp_lg_u32 s50, 7
    s_cbranch_scc1 L_nopf
    s_getpc_b64 s[88:89]
L_pc:
    s_lshr_b32 s87, s2, 3
    s_mul_i32 s87, s87, 24
    v_and_b32 v19, 63, v0
    v_add_u32 v19, s87, v19
    v_lshlrev_b32 v19, 6, v19
    v_min_u32 v19, L_code_end-L_pc-4, v19
    s_mov_b64 exec, 0xffffff
    global_load_dword v106, v19, s[88:89]
    s_mov_b64 exec, -1
L_nopf:
    s_load_dwordx2 s[28:29], s[0:1], 80
    s_load_dwordx2 s[40:41], s[0:1], 40
    s_load_dwordx2 s[12:13], s[0:1], 8
    s_load_dwordx2 s[20:21], s[0:1], 48
    s_load_dwordx2 s[24:25], s[0:1], 16
    s_load_dwordx2 s[46:47], s[0:1], 56
    s_load_dwordx2 s[26:27], s[0:1], 64
    s_load_dwordx2 s[36:37], s[0:1], 72
    s_add_u32 s79, s79, 8
    s_and_b32 s4, s79, 63
    s_barrier
    s_add_u32 m0, s82, 24576
    s_lshl4_add_u32 s62, s4, s53
    buffer_load_dwordx4 v2, s[8:11], s62 offen lds
    s_add_u32 m0, s82, 32768
    s_lshl4_add_u32 s62, s4, s69
    buffer_load_dwordx4 v2, s[8:11], s62 offen lds
    s_add_u32 m0, s83, 24576
    s_mul_i32 s62, s4, 28672
    s_add_u32 s62, s62, s54
    buffer_load_dwordx4 v4, s[16:19], s62 offen lds
    v_and_b32 v1, 63, v0
    s_lshl_b32 s84, s2, 13
    s_add_u32 s84, s84, s51
    v_lshlrev_b32 v19, 6, v1
    s_mov_b64 exec, 0xffff
    buffer_load_dword v105, v19, s[8:11], s84 offen sc1
    s_mov_b64 exec, -1
    s_lshl2_add_u32 s52, s80, s77
    s_lshl4_add_u32 s66, s78, s52
    s_lshl_b32 s35, s85, 5
    s_add_u32 s35, s35, s81
    s_add_u32 s35, s35, 192
    s_and_b32 s77, s50, 3
    s_add_u32 s5, s3, 16
    s_and_b32 s5, s5, 63
    s_add_u32 s6, s3, 24
    s_and_b32 s6, s6, 63
    v_and_b32 v17, 31, v1
    v_bfe_u32 v18, v1, 1, 3
    v_lshrrev_b32 v19, 5, v1
    v_xor_b32 v18, v18, v19
    v_lshlrev_b32 v17, 7, v17
    v_lshl_add_u32 v17, v18, 4, v17
    s_lshl_b32 s79, s77, 5
    v_xor_b32 v17, s79, v17
    s_lshl_b32 s79, s77, 12
    s_add_u32 s79, s79, 57344
    v_add_u32 v12, s79, v17
    v_xor_b32 v13, 32, v12
    v_xor_b32 v14, 64, v12
    v_xor_b32 v15, 96, v12
    v_lshlrev_b32 v16, 10, v19
    v_bfe_u32 v18, v1, 2, 2
    v_lshl_add_u32 v16, v18, 7, v16
    v_bfe_u32 v18, v1, 3, 1
    v_lshl_add_u32 v16, v18, 6, v16
    v_bfe_u32 v18, v1, 4, 1
    v_lshl_add_u32 v16, v18, 5, v16
    v_and_b32 v18, 3, v1
    v_lshl_add_u32 v16, v18, 3, v16
    s_bitcmp1_b32 s2, 6
    s_cselect_b32 s79, 56, 28
    s_add_u32 s79, s79, s77
    s_lshl_b32 s79, s79, 5
    s_lshr_b32 s78, s50, 2
    s_add_u32 s79, s79, s78
    s_lshl_b32 s79, s79, 6
    v_xor_b32 v8, s79, v16
    v_xor_b32 v9, 2048, v8
    v_xor_b32 v10, 4096, v8
    v_xor_b32 v11, 6144, v8
    v_mov_b32 v18, 0x3f803f80
    s_mov_b32 vcc_lo, 0x30003
    s_mov_b32 vcc_hi, 0x30003
    v_cndmask_b32 v84, 0, v18, vcc
    v_cndmask_b32 v85, 0, v18, vcc
    s_mov_b32 vcc_lo, 0x300030
    s_mov_b32 vcc_hi, 0x300030
    v_cndmask_b32 v86, 0, v18, vcc
    v_cndmask_b32 v87, 0, v18, vcc
    v_and_b32 v18, 1, v1
    v_mul_u32_u24 v18, 0xaaaa, v18
    v_add_u32 v103, 0x4444, v18
    v_mov_b32 v124, 0
    v_mov_b32 v125, 0
    v_mov_b32 v80, 0
    v_mov_b32 v81, 0
    v_mov_b32 v82, 0
    v_mov_b32 v83, 0
    v_mov_b32 v88, 0
    v_mov_b32 v89, 0
    v_mov_b32 v90, 0
    v_mov_b32 v91, 0
    s_mov_b32 s30, 10551296
    s_mov_b32 s31, 0x20000
    s_waitcnt lgkmcnt(0)
    s_cmp_ge_u32 s2, 8
    s_cbranch_scc1 L_noinit
    v_mov_b32 v20, 0
    v_mov_b32 v21, 0
    v_mov_b32 v22, 0
    v_mov_b32 v23, 0
    v_lshlrev_b32 v17, 4, v0
    s_lshl_b32 s76, s2, 13
    s_add_u32 s76, s76, 10485760
    buffer_store_dwordx4 v[20:23], v17, s[28:31], s76 offen sc1
L_noinit:
    s_bitcmp1_b32 s2, 6
    s_cselect_b32 s76, 0, 15
    s_lshl_b32 s76, s76, 13
    s_add_u32 m0, s76, s51
    s_lshl4_add_u32 s62, s5, s53
    buffer_load_dwordx4 v2, s[8:11], s62 offen lds
    s_waitcnt vmcnt(5)
    s_barrier
    s_bitcmp1_b32 s2, 6
    s_cbranch_scc1 L_kv
    s_cmp_ge_u32 s50, 4
    s_cbranch_scc1 L_q1
    s_branch L_q0
L_kv:
    s_cmp_ge_u32 s50, 4
    s_cbranch_scc1 L_kv1
    s_branch L_kv0
L_exit:
    s_endpgm
.p2align 6
L_q0:
    ds_read_b128 v[192:195], v12 offset:16384
    ds_read_b128 v[196:199], v13 offset:16384
    ds_read_b128 v[200:203], v14 offset:16384
    ds_read_b128 v[204:207], v15 offset:16384
    ds_read_b64_tr_b16 v[16:17], v8 offset:8192
    ds_read_b64_tr_b16 v[18:19], v8 offset:8704
    ds_read_b64_tr_b16 v[24:25], v9 offset:8192
    ds_read_b64_tr_b16 v[26:27], v9 offset:8704
    s_mov_b32 s38, 256
    s_mov_b32 s39, 0x20000
    s_add_u32 s7, s3, 32
    s_and_b32 s7, s7, 63
    s_add_u32 s32, s3, 40
    s_and_b32 s32, s32, 63
    s_add_u32 s33, s3, 48
    s_and_b32 s33, s33, 63
    s_add_u32 s34, s3, 56
    s_and_b32 s34, s34, 63
    s_waitcnt lgkmcnt(2)
    v_mfma_f32_32x32x16_bf16 v[32:47], v[16:19], v[192:195], 0
    s_setprio 0
    s_add_u32 m0, s51, 114688
    s_mul_i32 s62, s5, 28672
    s_add_u32 s62, s62, s54
    buffer_load_dwordx4 v4, s[16:19], s62 offen lds
    ds_read_b64_tr_b16 v[28:29], v10 offset:8192
    ds_read_b64_tr_b16 v[30:31], v10 offset:8704
    s_mov_b32 s14, 1572864
    s_mov_b32 s15, 0x20000
    s_mov_b32 s42, 3584
    s_mov_b32 s43, 0x20000
    s_waitcnt lgkmcnt(2)
    v_mfma_f32_32x32x16_bf16 v[32:47], v[24:27], v[196:199], v[32:47]
    s_add_u32 m0, s51, 131072
    s_lshl4_add_u32 s62, s5, s69
    buffer_load_dwordx4 v2, s[8:11], s62 offen lds
    v_dot2c_f32_bf16 v124, v192, v192
    v_dot2c_f32_bf16 v125, v193, v193
    v_dot2c_f32_bf16 v124, v194, v194
    v_dot2c_f32_bf16 v125, v195, v195
    v_dot2c_f32_bf16 v124, v196, v196
    v_dot2c_f32_bf16 v125, v197, v197
    v_dot2c_f32_bf16 v124, v198, v198
    v_dot2c_f32_bf16 v125, v199, v199
    v_dot2c_f32_bf16 v124, v200, v200
    v_dot2c_f32_bf16 v125, v201, v201
    v_dot2c_f32_bf16 v124, v202, v202
    v_dot2c_f32_bf16 v125, v203, v203
    v_dot2c_f32_bf16 v124, v204, v204
    v_dot2c_f32_bf16 v125, v205, v205
    v_dot2c_f32_bf16 v124, v206, v206
    v_dot2c_f32_bf16 v125, v207, v207
    ds_read_b64_tr_b16 v[108:109], v11 offset:8192
    ds_read_b64_tr_b16 v[110:111], v11 offset:8704
    s_mov_b32 s22, 1835008
    s_mov_b32 s23, 0x20000
    s_movk_i32 s76, 3072
    v_mad_u32_u24 v3, v112, s76, v113
    s_waitcnt lgkmcnt(2)
    v_mfma_f32_32x32x16_bf16 v[32:47], v[28:31], v[200:203], v[32:47]
    s_add_u32 m0, s51, 139264
    s_mul_i32 s62, s6, 28672
    s_add_u32 s62, s62, s54
    buffer_load_dwordx4 v4, s[16:19], s62 offen lds
    s_waitcnt vmcnt(5)
    s_barrier
    ds_read_b128 v[128:131], v12 offset:40960
    ds_read_b128 v[132:135], v13 offset:40960
    ds_read_b128 v[136:139], v14 offset:40960
    ds_read_b128 v[140:143], v15 offset:40960
    ds_read_b64_tr_b16 v[20:21], v8 offset:32768
    ds_read_b64_tr_b16 v[22:23], v8 offset:33280
    v_lshl_add_u32 v6, v112, 10, v113
    s_waitcnt lgkmcnt(6)
    v_mfma_f32_32x32x16_bf16 v[32:47], v[108:111], v[204:207], v[32:47]
    s_add_u32 m0, s51, 0
    s_lshl4_add_u32 s62, s6, s53
    buffer_load_dwordx4 v2, s[8:11], s62 offen lds
    ds_read_b64_tr_b16 v[24:25], v9 offset:32768
    ds_read_b64_tr_b16 v[26:27], v9 offset:33280
    s_lshl_b32 s76, s67, 7
    v_add_u32 v6, s76, v6
    v_and_b32 v117, 31, v0
    s_waitcnt lgkmcnt(2)
    v_mfma_f32_32x32x16_bf16 v[32:47], v[20:23], v[128:131], v[32:47]
    v_smfmac_f32_16x16x64_bf16 v[80:83], v[84:87], v[16:23], v103
    s_setprio 1
    s_add_u32 m0, s51, 8192
    s_lshl4_add_u32 s62, s6, s69
    buffer_load_dwordx4 v2, s[8:11], s62 offen lds
    ds_read_b64_tr_b16 v[28:29], v10 offset:32768
    ds_read_b64_tr_b16 v[30:31], v10 offset:33280
    v_lshlrev_b32 v116, 1, v117
    s_waitcnt lgkmcnt(2)
    v_mfma_f32_32x32x16_bf16 v[32:47], v[24:27], v[132:135], v[32:47]
    s_add_u32 m0, s51, 16384
    s_mul_i32 s62, s7, 28672
    s_add_u32 s62, s62, s54
    buffer_load_dwordx4 v4, s[16:19], s62 offen lds
    v_dot2c_f32_bf16 v124, v128, v128
    v_dot2c_f32_bf16 v125, v129, v129
    v_dot2c_f32_bf16 v124, v130, v130
    v_dot2c_f32_bf16 v125, v131, v131
    v_dot2c_f32_bf16 v124, v132, v132
    v_dot2c_f32_bf16 v125, v133, v133
    v_dot2c_f32_bf16 v124, v134, v134
    v_dot2c_f32_bf16 v125, v135, v135
    v_dot2c_f32_bf16 v124, v136, v136
    v_dot2c_f32_bf16 v125, v137, v137
    v_dot2c_f32_bf16 v124, v138, v138
    v_dot2c_f32_bf16 v125, v139, v139
    v_dot2c_f32_bf16 v124, v140, v140
    v_dot2c_f32_bf16 v125, v141, v141
    v_dot2c_f32_bf16 v124, v142, v142
    v_dot2c_f32_bf16 v125, v143, v143
    ds_read_b64_tr_b16 v[108:109], v11 offset:32768
    ds_read_b64_tr_b16 v[110:111], v11 offset:33280
    v_lshlrev_b32 v117, 2, v117
    v_add_u32 v126, 147456, v117
    s_waitcnt lgkmcnt(2)
    v_mfma_f32_32x32x16_bf16 v[32:47], v[28:31], v[136:139], v[32:47]
    s_add_u32 m0, s51, 24576
    s_lshl4_add_u32 s62, s7, s53
    buffer_load_dwordx4 v2, s[8:11], s62 offen lds
    s_waitcnt vmcnt(5)
    s_barrier
    s_cmp_lg_u32 s50, 1
    s_cbranch_scc1 L_ini_1
    s_cmp_ge_u32 s2, 8
    s_cbranch_scc1 L_ini_1
    v_mov_b32 v104, 1
    s_mov_b64 exec, 1
    buffer_atomic_add v104, off, s[36:39], 0
    s_mov_b64 exec, -1
L_ini_1:
    v_add_u32 v12, 57344, v12
    v_add_u32 v13, 57344, v13
    v_add_u32 v14, 57344, v14
    v_add_u32 v15, 57344, v15
    ds_read_b128 v[208:211], v12 offset:8192
    ds_read_b128 v[212:215], v13 offset:8192
    ds_read_b128 v[216:219], v14 offset:8192
    ds_read_b128 v[220:223], v15 offset:8192
    v_add_u32 v8, 57344, v8
    v_add_u32 v9, 57344, v9
    v_add_u32 v10, 57344, v10
    v_add_u32 v11, 57344, v11
    ds_read_b64_tr_b16 v[16:17], v8 offset:0
    ds_read_b64_tr_b16 v[18:19], v8 offset:512
    s_mul_i32 s73, s75, 589824
    s_add_u32 s72, s73, 0
    s_lshr_b32 s76, s52, 1
    s_lshl_b32 s80, s76, 7
    s_lshl_b32 s78, s54, 5
    s_waitcnt lgkmcnt(6)
    v_mfma_f32_32x32x16_bf16 v[32:47], v[108:111], v[140:143], v[32:47]
    s_add_u32 m0, s51, 32768
    s_lshl4_add_u32 s62, s7, s69
    buffer_load_dwordx4 v2, s[8:11], s62 offen lds
    ds_read_b64_tr_b16 v[24:25], v9 offset:0
    ds_read_b64_tr_b16 v[26:27], v9 offset:512
    s_add_u32 s78, s78, s72
    s_add_u32 s55, s54, 128
    s_lshl_b32 s56, s35, 1
    s_mov_b32 s57, s80
    s_mov_b32 s58, s78
    s_add_u32 s59, s78, 4096
    s_lshl_b32 s60, s35, 6
    s_waitcnt lgkmcnt(2)
    v_mfma_f32_32x32x16_bf16 v[32:47], v[16:19], v[208:211], v[32:47]
    s_setprio 0
    s_add_u32 m0, s51, 40960
    s_mul_i32 s62, s32, 28672
    s_add_u32 s62, s62, s54
    buffer_load_dwordx4 v4, s[16:19], s62 offen lds
    ds_read_b64_tr_b16 v[28:29], v10 offset:0
    ds_read_b64_tr_b16 v[30:31], v10 offset:512
    s_add_u32 s60, s60, s73
    s_add_u32 s60, s60, 0
    s_lshl_b32 s61, s76, 12
    s_add_u32 s61, s61, s72
    s_add_u32 s61, s61, 114688
    v_bfe_u32 v117, v0, 2, 6
    s_waitcnt lgkmcnt(2)
    v_mfma_f32_32x32x16_bf16 v[32:47], v[24:27], v[212:215], v[32:47]
    s_add_u32 m0, s51, 49152
    s_lshl4_add_u32 s62, s32, s53
    buffer_load_dwordx4 v2, s[8:11], s62 offen lds
    v_dot2c_f32_bf16 v124, v208, v208
    v_dot2c_f32_bf16 v125, v209, v209
    v_dot2c_f32_bf16 v124, v210, v210
    v_dot2c_f32_bf16 v125, v211, v211
    v_dot2c_f32_bf16 v124, v212, v212
    v_dot2c_f32_bf16 v125, v213, v213
    v_dot2c_f32_bf16 v124, v214, v214
    v_dot2c_f32_bf16 v125, v215, v215
    v_dot2c_f32_bf16 v124, v216, v216
    v_dot2c_f32_bf16 v125, v217, v217
    v_dot2c_f32_bf16 v124, v218, v218
    v_dot2c_f32_bf16 v125, v219, v219
    v_dot2c_f32_bf16 v124, v220, v220
    v_dot2c_f32_bf16 v125, v221, v221
    v_dot2c_f32_bf16 v124, v222, v222
    v_dot2c_f32_bf16 v125, v223, v223
    ds_read_b64_tr_b16 v[108:109], v11 offset:0
    ds_read_b64_tr_b16 v[110:111], v11 offset:512
    v_and_b32 v118, 3, v0
    v_lshlrev_b32 v118, 4, v118
    s_movk_i32 s80, 3584
    s_waitcnt lgkmcnt(2)
    v_mfma_f32_32x32x16_bf16 v[32:47], v[28:31], v[216:219], v[32:47]
    s_add_u32 m0, s51, 57344
    s_lshl4_add_u32 s62, s32, s69
    buffer_load_dwordx4 v2, s[8:11], s62 offen lds
    s_waitcnt vmcnt(6)
    s_barrier
    v_subrev_u32 v12, 114688, v12
    v_subrev_u32 v13, 114688, v13
    v_subrev_u32 v14, 114688, v14
    v_subrev_u32 v15, 114688, v15
    ds_read_b128 v[144:147], v12 offset:0
    ds_read_b128 v[148:151], v13 offset:0
    ds_read_b128 v[152:155], v14 offset:0
    ds_read_b128 v[156:159], v15 offset:0
    ds_read_b64_tr_b16 v[20:21], v8 offset:24576
    ds_read_b64_tr_b16 v[22:23], v8 offset:25088
    v_mad_u32_u24 v5, v117, s80, v118
    buffer_load_ushort v92, v116, s[40:43], s54 offen offset:0
    s_waitcnt lgkmcnt(6)
    v_mfma_f32_32x32x16_bf16 v[32:47], v[108:111], v[220:223], v[32:47]
    s_add_u32 m0, s51, 73728
    s_lshl4_add_u32 s62, s33, s53
    buffer_load_dwordx4 v2, s[8:11], s62 offen lds
    ds_read_b64_tr_b16 v[24:25], v9 offset:24576
    ds_read_b64_tr_b16 v[26:27], v9 offset:25088
    buffer_load_ushort v93, v116, s[40:43], s55 offen offset:0
    buffer_load_ushort v94, v116, s[40:43], s56 offen offset:0
    s_waitcnt lgkmcnt(2)
    v_mfma_f32_32x32x16_bf16 v[32:47], v[20:23], v[144:147], v[32:47]
    v_smfmac_f32_16x16x64_bf16 v[80:83], v[84:87], v[16:23], v103
    s_setprio 1
    s_add_u32 m0, s51, 81920
    s_lshl4_add_u32 s62, s33, s69
    buffer_load_dwordx4 v2, s[8:11], s62 offen lds
    ds_read_b64_tr_b16 v[28:29], v10 offset:24576
    ds_read_b64_tr_b16 v[30:31], v10 offset:25088
    s_mov_b32 s64, 0x3fb8aa3b
    s_mov_b32 s65, 0x358637bd
    s_mov_b32 s48, 0x0000ffff
    s_mov_b32 s49, 0x0000ffff
    s_mul_i32 s79, s77, 147456
    s_waitcnt lgkmcnt(2)
    v_mfma_f32_32x32x16_bf16 v[32:47], v[24:27], v[148:151], v[32:47]
    s_add_u32 m0, s51, 65536
    s_mul_i32 s62, s33, 28672
    s_add_u32 s62, s62, s54
    buffer_load_dwordx4 v4, s[16:19], s62 offen lds
    v_dot2c_f32_bf16 v124, v144, v144
    v_dot2c_f32_bf16 v125, v145, v145
    v_dot2c_f32_bf16 v124, v146, v146
    v_dot2c_f32_bf16 v125, v147, v147
    v_dot2c_f32_bf16 v124, v148, v148
    v_dot2c_f32_bf16 v125, v149, v149
    v_dot2c_f32_bf16 v124, v150, v150
    v_dot2c_f32_bf16 v125, v151, v151
    v_dot2c_f32_bf16 v124, v152, v152
    v_dot2c_f32_bf16 v125, v153, v153
    v_dot2c_f32_bf16 v124, v154, v154
    v_dot2c_f32_bf16 v125, v155, v155
    v_dot2c_f32_bf16 v124, v156, v156
    v_dot2c_f32_bf16 v125, v157, v157
    v_dot2c_f32_bf16 v124, v158, v158
    v_dot2c_f32_bf16 v125, v159, v159
    ds_read_b64_tr_b16 v[108:109], v11 offset:24576
    ds_read_b64_tr_b16 v[110:111], v11 offset:25088
    v_lshlrev_b32 v7, 4, v1
    v_add_u32 v7, s79, v7
    s_lshr_b32 s79, s66, 1
    s_lshl_b32 s79, s79, 11
    s_add_u32 s79, s79, 10486912
    s_add_u32 s44, s28, s79
    s_addc_u32 s45, s29, 0
    s_lshl_b32 s68, s75, 11
    s_lshl2_add_u32 s68, s76, s68
    s_add_u32 s68, s68, 10486912
    s_lshl_b32 s79, s66, 1
    s_add_u32 s79, s79, 0
    s_mul_i32 s79, s79, 147456
    s_mul_i32 s70, s77, 28672
    s_add_u32 s70, s70, s79
    s_lshl_b32 s74, s77, 13
    s_add_u32 s74, s74, s79
    s_add_u32 s74, s74, 114688
    s_waitcnt lgkmcnt(2)
    v_mfma_f32_32x32x16_bf16 v[32:47], v[28:31], v[152:155], v[32:47]
    s_add_u32 m0, s51, 98304
    s_lshl4_add_u32 s62, s34, s53
    buffer_load_dwordx4 v2, s[8:11], s62 offen lds
    s_waitcnt vmcnt(10)
    s_barrier
    ds_read_b128 v[224:227], v12 offset:24576
    ds_read_b128 v[228:231], v13 offset:24576
    ds_read_b128 v[232:235], v14 offset:24576
    ds_read_b128 v[236:239], v15 offset:24576
    v_subrev_u32 v8, 114688, v8
    v_subrev_u32 v9, 114688, v9
    v_subrev_u32 v10, 114688, v10
    v_subrev_u32 v11, 114688, v11
    ds_read_b64_tr_b16 v[16:17], v8 offset:16384
    ds_read_b64_tr_b16 v[18:19], v8 offset:16896
    s_waitcnt lgkmcnt(6)
    v_mfma_f32_32x32x16_bf16 v[32:47], v[108:111], v[156:159], v[32:47]
    s_add_u32 m0, s51, 106496
    s_lshl4_add_u32 s62, s34, s69
    buffer_load_dwordx4 v2, s[8:11], s62 offen lds
    ds_read_b64_tr_b16 v[24:25], v9 offset:16384
    ds_read_b64_tr_b16 v[26:27], v9 offset:16896
    s_waitcnt lgkmcnt(2)
    v_mfma_f32_32x32x16_bf16 v[32:47], v[16:19], v[224:227], v[32:47]
    s_setprio 0
    s_add_u32 m0, s51, 90112
    s_mul_i32 s62, s34, 28672
    s_add_u32 s62, s62, s54
    buffer_load_dwordx4 v4, s[16:19], s62 offen lds
    ds_read_b64_tr_b16 v[28:29], v10 offset:16384
    ds_read_b64_tr_b16 v[30:31], v10 offset:16896
    s_waitcnt lgkmcnt(2)
    v_mfma_f32_32x32x16_bf16 v[32:47], v[24:27], v[228:231], v[32:47]
    s_add_u32 m0, s51, 122880
    s_mul_i32 s62, s4, 24576
    s_add_u32 s62, s62, s57
    buffer_load_dwordx4 v3, s[12:15], s62 offen lds
    v_dot2c_f32_bf16 v124, v224, v224
    v_dot2c_f32_bf16 v125, v225, v225
    v_dot2c_f32_bf16 v124, v226, v226
    v_dot2c_f32_bf16 v125, v227, v227
    v_dot2c_f32_bf16 v124, v228, v228
    v_dot2c_f32_bf16 v125, v229, v229
    v_dot2c_f32_bf16 v124, v230, v230
    v_dot2c_f32_bf16 v125, v231, v231
    v_dot2c_f32_bf16 v124, v232, v232
    v_dot2c_f32_bf16 v125, v233, v233
    v_dot2c_f32_bf16 v124, v234, v234
    v_dot2c_f32_bf16 v125, v235, v235
    v_dot2c_f32_bf16 v124, v236, v236
    v_dot2c_f32_bf16 v125, v237, v237
    v_dot2c_f32_bf16 v124, v238, v238
    v_dot2c_f32_bf16 v125, v239, v239
    ds_read_b64_tr_b16 v[108:109], v11 offset:16384
    ds_read_b64_tr_b16 v[110:111], v11 offset:16896
    s_waitcnt lgkmcnt(2)
    v_mfma_f32_32x32x16_bf16 v[32:47], v[28:31], v[232:235], v[32:47]
    s_add_u32 m0, s51, 131072
    s_mul_i32 s62, s5, 24576
    s_add_u32 s62, s62, s57
    buffer_load_dwordx4 v3, s[12:15], s62 offen lds
    s_waitcnt vmcnt(11)
    s_barrier
    ds_read_b128 v[160:163], v12 offset:49152
    ds_read_b128 v[164:167], v13 offset:49152
    ds_read_b128 v[168:171], v14 offset:49152
    ds_read_b128 v[172:175], v15 offset:49152
    ds_read_b64_tr_b16 v[20:21], v8 offset:40960
    ds_read_b64_tr_b16 v[22:23], v8 offset:41472
    s_waitcnt lgkmcnt(6)
    v_mfma_f32_32x32x16_bf16 v[32:47], v[108:111], v[236:239], v[32:47]
    s_add_u32 m0, s51, 114688
    s_mul_i32 s62, s3, 24576
    s_add_u32 s62, s62, s57
    buffer_load_dwordx4 v3, s[12:15], s62 offen lds
    ds_read_b64_tr_b16 v[24:25], v9 offset:40960
    ds_read_b64_tr_b16 v[26:27], v9 offset:41472
    s_waitcnt lgkmcnt(2)
    v_mfma_f32_32x32x16_bf16 v[32:47], v[20:23], v[160:163], v[32:47]
    v_smfmac_f32_16x16x64_bf16 v[80:83], v[84:87], v[16:23], v103
    s_setprio 1
    s_add_u32 m0, s51, 0
    s_mul_i32 s62, s7, 24576
    s_add_u32 s62, s62, s57
    buffer_load_dwordx4 v3, s[12:15], s62 offen lds
    ds_read_b64_tr_b16 v[28:29], v10 offset:40960
    ds_read_b64_tr_b16 v[30:31], v10 offset:41472
    s_waitcnt lgkmcnt(2)
    v_mfma_f32_32x32x16_bf16 v[32:47], v[24:27], v[164:167], v[32:47]
    s_add_u32 m0, s51, 8192
    s_mul_i32 s62, s32, 24576
    s_add_u32 s62, s62, s57
    buffer_load_dwordx4 v3, s[12:15], s62 offen lds
    v_dot2c_f32_bf16 v124, v160, v160
    v_dot2c_f32_bf16 v125, v161, v161
    v_dot2c_f32_bf16 v124, v162, v162
    v_dot2c_f32_bf16 v125, v163, v163
    v_dot2c_f32_bf16 v124, v164, v164
    v_dot2c_f32_bf16 v125, v165, v165
    v_dot2c_f32_bf16 v124, v166, v166
    v_dot2c_f32_bf16 v125, v167, v167
    v_dot2c_f32_bf16 v124, v168, v168
    v_dot2c_f32_bf16 v125, v169, v169
    v_dot2c_f32_bf16 v124, v170, v170
    v_dot2c_f32_bf16 v125, v171, v171
    v_dot2c_f32_bf16 v124, v172, v172
    v_dot2c_f32_bf16 v125, v173, v173
    v_dot2c_f32_bf16 v124, v174, v174
    v_dot2c_f32_bf16 v125, v175, v175
    s_and_b32 s72, s50, 3
    s_lshl_b32 s72, s72, 11
    s_add_u32 s72, s72, 155648
    v_lshlrev_b32 v2, 2, v1
    v_add_u32 v2, s72, v2
    ds_read_b64_tr_b16 v[108:109], v11 offset:40960
    ds_read_b64_tr_b16 v[110:111], v11 offset:41472
    s_waitcnt lgkmcnt(2)
    v_mfma_f32_32x32x16_bf16 v[32:47], v[28:31], v[168:171], v[32:47]
    s_add_u32 m0, s51, 139264
    s_mul_i32 s62, s6, 24576
    s_add_u32 s62, s62, s57
    buffer_load_dwordx4 v3, s[12:15], s62 offen lds
    s_waitcnt vmcnt(9)
    s_barrier
    s_cmp_lg_u32 s50, 0
    s_cbranch_scc1 L_ip_2
    buffer_load_dword v107, off, s[36:39], 0 sc1
L_ip_2:
    v_add_u32 v12, 57344, v12
    v_add_u32 v13, 57344, v13
    v_add_u32 v14, 57344, v14
    v_add_u32 v15, 57344, v15
    ds_read_b128 v[240:243], v12 offset:16384
    ds_read_b128 v[244:247], v13 offset:16384
    ds_read_b128 v[248:251], v14 offset:16384
    ds_read_b128 v[252:255], v15 offset:16384
    v_add_u32 v8, 57344, v8
    v_add_u32 v9, 57344, v9
    v_add_u32 v10, 57344, v10
    v_add_u32 v11, 57344, v11
    ds_read_b64_tr_b16 v[16:17], v8 offset:8192
    ds_read_b64_tr_b16 v[18:19], v8 offset:8704
    s_waitcnt lgkmcnt(6)
    v_mfma_f32_32x32x16_bf16 v[32:47], v[108:111], v[172:175], v[32:47]
    s_add_u32 m0, s51, 24576
    s_mul_i32 s62, s34, 24576
    s_add_u32 s62, s62, s57
    buffer_load_dwordx4 v3, s[12:15], s62 offen lds
    ds_read_b64_tr_b16 v[24:25], v9 offset:8192
    ds_read_b64_tr_b16 v[26:27], v9 offset:8704
    s_waitcnt lgkmcnt(2)
    v_mfma_f32_32x32x16_bf16 v[32:47], v[16:19], v[240:243], v[32:47]
    s_setprio 0
    s_add_u32 m0, s51, 16384
    s_mul_i32 s62, s33, 24576
    s_add_u32 s62, s62, s57
    buffer_load_dwordx4 v3, s[12:15], s62 offen lds
    ds_read_b64_tr_b16 v[28:29], v10 offset:8192
    ds_read_b64_tr_b16 v[30:31], v10 offset:8704
    s_waitcnt lgkmcnt(2)
    v_mfma_f32_32x32x16_bf16 v[32:47], v[24:27], v[244:247], v[32:47]
    s_add_u32 m0, s51, 49152
    s_mul_i32 s62, s3, 28672
    s_add_u32 s62, s62, s55
    buffer_load_dwordx4 v4, s[16:19], s62 offen lds
    v_dot2c_f32_bf16 v124, v240, v240
    v_dot2c_f32_bf16 v125, v241, v241
    v_dot2c_f32_bf16 v124, v242, v242
    v_dot2c_f32_bf16 v125, v243, v243
    v_dot2c_f32_bf16 v124, v244, v244
    v_dot2c_f32_bf16 v125, v245, v245
    v_dot2c_f32_bf16 v124, v246, v246
    v_dot2c_f32_bf16 v125, v247, v247
    v_dot2c_f32_bf16 v124, v248, v248
    v_dot2c_f32_bf16 v125, v249, v249
    v_dot2c_f32_bf16 v124, v250, v250
    v_dot2c_f32_bf16 v125, v251, v251
    v_dot2c_f32_bf16 v124, v252, v252
    v_dot2c_f32_bf16 v125, v253, v253
    v_dot2c_f32_bf16 v124, v254, v254
    v_dot2c_f32_bf16 v125, v255, v255
    ds_read_b64_tr_b16 v[108:109], v11 offset:8192
    ds_read_b64_tr_b16 v[110:111], v11 offset:8704
    s_waitcnt lgkmcnt(2)
    v_mfma_f32_32x32x16_bf16 v[32:47], v[28:31], v[248:251], v[32:47]
    s_add_u32 m0, s51, 57344
    s_mul_i32 s62, s4, 28672
    s_add_u32 s62, s62, s55
    buffer_load_dwordx4 v4, s[16:19], s62 offen lds
    s_waitcnt vmcnt(10)
    s_barrier
    ds_read_b128 v[176:179], v12 offset:40960
    ds_read_b128 v[180:183], v13 offset:40960
    ds_read_b128 v[184:187], v14 offset:40960
    ds_read_b128 v[188:191], v15 offset:40960
    ds_read_b64_tr_b16 v[20:21], v8 offset:32768
    ds_read_b64_tr_b16 v[22:23], v8 offset:33280
    s_waitcnt lgkmcnt(6)
    v_mfma_f32_32x32x16_bf16 v[32:47], v[108:111], v[252:255], v[32:47]
    s_add_u32 m0, s51, 73728
    s_mul_i32 s62, s6, 28672
    s_add_u32 s62, s62, s55
    buffer_load_dwordx4 v4, s[16:19], s62 offen lds
    s_waitcnt lgkmcnt(2)
    v_dot2c_f32_bf16 v124, v176, v176
    v_dot2c_f32_bf16 v125, v177, v177
    v_dot2c_f32_bf16 v124, v178, v178
    v_dot2c_f32_bf16 v125, v179, v179
    v_dot2c_f32_bf16 v124, v180, v180
    v_dot2c_f32_bf16 v125, v181, v181
    v_dot2c_f32_bf16 v124, v182, v182
    v_dot2c_f32_bf16 v125, v183, v183
    v_dot2c_f32_bf16 v124, v184, v184
    v_dot2c_f32_bf16 v125, v185, v185
    v_dot2c_f32_bf16 v124, v186, v186
    v_dot2c_f32_bf16 v125, v187, v187
    v_dot2c_f32_bf16 v124, v188, v188
    v_dot2c_f32_bf16 v125, v189, v189
    v_dot2c_f32_bf16 v124, v190, v190
    v_dot2c_f32_bf16 v125, v191, v191
    ds_read_b64_tr_b16 v[24:25], v9 offset:32768
    ds_read_b64_tr_b16 v[26:27], v9 offset:33280
    s_waitcnt lgkmcnt(2)
    v_mfma_f32_32x32x16_bf16 v[32:47], v[20:23], v[176:179], v[32:47]
    v_smfmac_f32_16x16x64_bf16 v[80:83], v[84:87], v[16:23], v103
    s_setprio 1
    s_add_u32 m0, s51, 81920
    s_mul_i32 s62, s7, 28672
    s_add_u32 s62, s62, s55
    buffer_load_dwordx4 v4, s[16:19], s62 offen lds
    ds_read_b64_tr_b16 v[28:29], v10 offset:32768
    ds_read_b64_tr_b16 v[30:31], v10 offset:33280
    s_waitcnt lgkmcnt(2)
    v_mfma_f32_32x32x16_bf16 v[32:47], v[24:27], v[180:183], v[32:47]
    v_add_f32 v124, v124, v125
    v_add_f32 v88, v88, v89
    v_lshlrev_b32 v125, 2, v0
    v_add_u32 v125, 147456, v125
    ds_write2st64_b32 v125, v124, v88 offset0:0 offset1:16
    v_and_b32 v124, 0xdf, v0
    v_lshlrev_b32 v124, 2, v124
    v_add_u32 v125, 147584, v124
    v_add_u32 v124, 147456, v124
    ds_read_b64_tr_b16 v[108:109], v11 offset:32768
    ds_read_b64_tr_b16 v[110:111], v11 offset:33280
    s_waitcnt lgkmcnt(3)
    v_mfma_f32_32x32x16_bf16 v[32:47], v[28:31], v[184:187], v[32:47]
    v_add_f32 v82, v80, v81
    ds_write_b32 v2, v82 offset:0
    v_mov_b32 v80, 0
    v_mov_b32 v81, 0
    s_waitcnt vmcnt(9) lgkmcnt(0)
    s_barrier
    v_add_u32 v8, 57344, v8
    v_add_u32 v9, 57344, v9
    v_add_u32 v10, 57344, v10
    v_add_u32 v11, 57344, v11
    ds_read_b64_tr_b16 v[16:17], v8 offset:0
    ds_read_b64_tr_b16 v[18:19], v8 offset:512
    v_mfma_f32_32x32x16_bf16 v[32:47], v[108:111], v[188:191], v[32:47]
    s_add_u32 m0, s51, 65536
    s_mul_i32 s62, s5, 28672
    s_add_u32 s62, s62, s55
    buffer_load_dwordx4 v4, s[16:19], s62 offen lds
    v_lshrrev_b32 v112, 5, v1
    v_lshlrev_b32 v112, 9, v112
    v_bfe_u32 v113, v1, 2, 2
    v_lshl_add_u32 v112, v113, 6, v112
    v_bfe_u32 v113, v1, 4, 1
    v_lshl_add_u32 v112, v113, 5, v112
    v_and_b32 v113, 3, v1
    v_lshl_add_u32 v112, v113, 3, v112
    s_and_b32 s72, s50, 3
    s_xor_b32 s73, s72, 0
    s_lshl_b32 s73, s73, 10
    v_add_u32 v12, s73, v112
    s_xor_b32 s73, s72, 1
    s_lshl_b32 s73, s73, 10
    v_add_u32 v13, s73, v112
    s_xor_b32 s73, s72, 2
    s_lshl_b32 s73, s73, 10
    v_add_u32 v14, s73, v112
    s_xor_b32 s73, s72, 3
    s_lshl_b32 s73, s73, 10
    v_add_u32 v15, s73, v112
    ds_read_b64_tr_b16 v[24:25], v9 offset:0
    ds_read_b64_tr_b16 v[26:27], v9 offset:512
    ds_read2st64_b32 v[112:113], v124 offset0:16 offset1:20
    ds_read2st64_b32 v[116:117], v124 offset0:0 offset1:4
    ds_read2st64_b32 v[118:119], v125 offset0:0 offset1:4
    v_mov_b32 v99, 0
    v_cmp_gt_u32 vcc, 32, v1
    s_waitcnt lgkmcnt(0)
    v_add_f32 v116, v116, v118
    v_add_f32 v117, v117, v119
    v_add_f32 v112, v112, v113
    v_mfma_f32_32x32x16_bf16 v[48:63], v[16:19], v[192:195], 0
    s_setprio 0
    s_add_u32 m0, s51, 98304
    s_mul_i32 s62, s33, 28672
    s_add_u32 s62, s62, s55
    buffer_load_dwordx4 v4, s[16:19], s62 offen lds
    ds_read_b64_tr_b16 v[28:29], v10 offset:0
    ds_read_b64_tr_b16 v[30:31], v10 offset:512
    v_add_f32 v116, v116, v117
    v_mul_f32 v112, 0xbb000000, v112
    v_mul_f32 v116, 0x3b000000, v116
    v_fma_f32 v116, -v112, v112, v116
    v_and_b32 v113, 0xffff0000, v112
    v_max_f32 v116, 0, v116
    v_sub_f32 v112, v112, v113
    v_mfma_f32_32x32x16_bf16 v[48:63], v[24:27], v[196:199], v[48:63]
    s_lshr_b32 s73, s2, 6
    s_add_u32 s73, s73, s67
    s_and_b32 s73, s73, 3
    s_lshl_b32 s73, s73, 2
    s_lshr_b32 s73, 0x60416041, s73
    s_bfe_u32 s75, s73, 0x40000
    s_lshl_b32 s75, s75, 12
    s_bfe_u32 s63, s73, 0x40004
    s_lshl_b32 s63, s63, 12
    s_bfe_u32 s54, s73, 0x40008
    s_lshl_b32 s54, s54, 12
    s_bfe_u32 s53, s73, 0x4000c
    s_lshl_b32 s53, s53, 12
    ds_read_b64_tr_b16 v[108:109], v11 offset:0
    ds_read_b64_tr_b16 v[110:111], v11 offset:512
    v_add_f32 v116, 0x3727c5ac, v116
    v_cvt_pk_bf16_f32 v96, v113, v113
    v_rsq_f32 v120, v116
    v_sqrt_f32 v121, v116
    v_cndmask_b32 v96, 0, v96, vcc
    v_mul_f32 v116, v120, v120
    v_and_b32 v114, 0xffff0000, v121
    s_waitcnt lgkmcnt(2)
    v_mfma_f32_32x32x16_bf16 v[48:63], v[28:31], v[200:203], v[48:63]
    s_add_u32 m0, s51, 106496
    s_mul_i32 s62, s34, 28672
    s_add_u32 s62, s62, s55
    buffer_load_dwordx4 v4, s[16:19], s62 offen lds
    ds_read_b64_tr_b16 v[20:21], v8 offset:8192
    ds_read_b64_tr_b16 v[22:23], v8 offset:8704
    v_mul_f32 v122, 0xc0135761, v120
    v_sub_f32 v115, v121, v114
    v_cvt_pk_bf16_f32 v97, v112, v114
    v_mul_f32 v123, v122, v116
    v_cvt_pk_bf16_f32 v98, v115, v99
    v_mul_f32 v123, 0x3d372713, v123
    v_cndmask_b32 v97, 0, v97, vcc
    s_waitcnt lgkmcnt(2)
    v_mfma_f32_32x32x16_bf16 v[48:63], v[108:111], v[204:207], v[48:63]
    ds_read_b64_tr_b16 v[24:25], v9 offset:8192
    ds_read_b64_tr_b16 v[26:27], v9 offset:8704
    v_cndmask_b32 v98, 0, v98, vcc
    ds_read2st64_b32 v[88:89], v126 offset0:32 offset1:40
    ds_read2st64_b32 v[90:91], v126 offset0:48 offset1:56
    v_mov_b32 v102, v92
    v_lshlrev_b32 v113, 16, v92
    s_waitcnt lgkmcnt(0)
    v_add_f32 v88, v88, v89
    v_add_f32 v90, v90, v91
    v_add_f32 v88, v88, v90
    v_mfma_f32_32x32x16_bf16 v[48:63], v[20:23], v[128:131], v[48:63]
    v_smfmac_f32_16x16x64_bf16 v[80:83], v[84:87], v[16:23], v103
    s_setprio 1
    ds_read_b64_tr_b16 v[28:29], v10 offset:8192
    ds_read_b64_tr_b16 v[30:31], v10 offset:8704
    v_and_b32 v112, 0xffff0000, v88
    v_sub_f32 v88, v88, v112
    v_cvt_pk_bf16_f32 v101, v112, v113
    v_cvt_pk_bf16_f32 v100, v112, v88
    s_nop 1
    v_mfma_f32_32x32x16_bf16 v[32:47], v[100:103], v[96:99], v[32:47]
    v_mfma_f32_32x32x16_bf16 v[48:63], v[24:27], v[132:135], v[48:63]
    ds_read_b64_tr_b16 v[108:109], v11 offset:8192
    ds_read_b64_tr_b16 v[110:111], v11 offset:8704
    s_waitcnt lgkmcnt(2)
    v_mfma_f32_32x32x16_bf16 v[48:63], v[28:31], v[136:139], v[48:63]
    s_cmp_lg_u32 s50, 0
    s_cbranch_scc1 L_ic_3
    s_mov_b32 s69, 0
    s_waitcnt vmcnt(9)
L_il_4:
    v_readfirstlane_b32 s72, v107
    s_nop 1
    s_cmp_ge_u32 s72, 8
    s_cbranch_scc1 L_ic_3
    s_add_u32 s69, s69, 1
    s_cmp_ge_u32 s69, 0x40000
    s_cbranch_scc1 L_ic_3
    buffer_load_dword v107, off, s[36:39], 0 sc1
    s_waitcnt vmcnt(0)
    s_branch L_il_4
L_ic_3:
    s_waitcnt vmcnt(9)
    s_barrier
    ds_read_b64_tr_b16 v[16:17], v8 offset:16384
    ds_read_b64_tr_b16 v[18:19], v8 offset:16896
    s_nop 0
    v_mul_f32 v116, v32, v32
    v_mul_f32 v117, v33, v33
    v_mul_f32 v118, v34, v34
    v_mul_f32 v119, v35, v35
    v_fma_f32 v116, v116, v123, v122
    v_fma_f32 v117, v117, v123, v122
    v_fma_f32 v118, v118, v123, v122
    s_waitcnt lgkmcnt(2)
    v_mfma_f32_32x32x16_bf16 v[48:63], v[108:111], v[140:143], v[48:63]
    s_lshl3_add_u32 s35, s2, s50
    s_mul_i32 s62, s35, 896
    v_lshlrev_b32 v125, 6, v1
    s_mov_b64 exec, 0x3fff
    buffer_load_dword v92, v125, s[20:23], s62 offen sc1
    s_lshl_b32 s62, s35, 8
    v_add_u32 v125, s62, v125
    s_mov_b64 exec, 15
    global_load_dword v92, v125, s[24:25] sc1
    s_mov_b64 exec, -1
    ds_read_b64_tr_b16 v[24:25], v9 offset:16384
    ds_read_b64_tr_b16 v[26:27], v9 offset:16896
    v_fma_f32 v119, v119, v123, v122
    v_mul_f32 v116, v32, v116
    v_mul_f32 v117, v33, v117
    v_mul_f32 v118, v34, v118
    v_mul_f32 v119, v35, v119
    v_exp_f32 v116, v116
    s_waitcnt lgkmcnt(2)
    v_mfma_f32_32x32x16_bf16 v[48:63], v[16:19], v[208:211], v[48:63]
    s_setprio 0
    s_add_u32 m0, s51, 90112
    s_mul_i32 s62, s32, 28672
    s_add_u32 s62, s62, s55
    buffer_load_dwordx4 v4, s[16:19], s62 offen lds
    ds_read_b64_tr_b16 v[28:29], v10 offset:16384
    ds_read_b64_tr_b16 v[30:31], v10 offset:16896
    v_exp_f32 v117, v117
    v_exp_f32 v118, v118
    v_exp_f32 v119, v119
    v_fma_f32 v116, v116, v121, v121
    s_waitcnt lgkmcnt(2)
    v_mfma_f32_32x32x16_bf16 v[48:63], v[24:27], v[212:215], v[48:63]
    ds_read_b64_tr_b16 v[108:109], v11 offset:16384
    ds_read_b64_tr_b16 v[110:111], v11 offset:16896
    v_fma_f32 v117, v117, v121, v121
    v_fma_f32 v118, v118, v121, v121
    v_fma_f32 v119, v119, v121, v121
    v_rcp_f32 v116, v116
    v_rcp_f32 v117, v117
    s_waitcnt lgkmcnt(2)
    v_mfma_f32_32x32x16_bf16 v[48:63], v[28:31], v[216:219], v[48:63]
    ds_read_b64_tr_b16 v[20:21], v8 offset:24576
    ds_read_b64_tr_b16 v[22:23], v8 offset:25088
    v_rcp_f32 v118, v118
    v_rcp_f32 v119, v119
    v_mul_f32 v112, v32, v116
    v_mul_f32 v113, v33, v117
    v_mul_f32 v114, v34, v118
    v_mul_f32 v115, v35, v119
    s_waitcnt lgkmcnt(2)
    v_mfma_f32_32x32x16_bf16 v[48:63], v[108:111], v[220:223], v[48:63]
    ds_read_b64_tr_b16 v[24:25], v9 offset:24576
    ds_read_b64_tr_b16 v[26:27], v9 offset:25088
    v_cvt_pk_bf16_f32 v104, v112, v113
    v_cvt_pk_bf16_f32 v105, v114, v115
    v_mul_f32 v116, v36, v36
    v_mul_f32 v117, v37, v37
    v_mul_f32 v118, v38, v38
    v_mul_f32 v119, v39, v39
    v_fma_f32 v116, v116, v123, v122
    v_fma_f32 v117, v117, v123, v122
    s_waitcnt lgkmcnt(2)
    v_mfma_f32_32x32x16_bf16 v[48:63], v[20:23], v[144:147], v[48:63]
    v_smfmac_f32_16x16x64_bf16 v[80:83], v[84:87], v[16:23], v103
    s_setprio 1
    ds_read_b64_tr_b16 v[28:29], v10 offset:24576
    ds_read_b64_tr_b16 v[30:31], v10 offset:25088
    v_fma_f32 v118, v118, v123, v122
    v_fma_f32 v119, v119, v123, v122
    v_mul_f32 v116, v36, v116
    v_mul_f32 v117, v37, v117
    v_mul_f32 v118, v38, v118
    v_mul_f32 v119, v39, v119
    v_exp_f32 v116, v116
    s_waitcnt lgkmcnt(2)
    v_mfma_f32_32x32x16_bf16 v[48:63], v[24:27], v[148:151], v[48:63]
    ds_read_b64_tr_b16 v[108:109], v11 offset:24576
    ds_read_b64_tr_b16 v[110:111], v11 offset:25088
    v_exp_f32 v117, v117
    v_exp_f32 v118, v118
    v_exp_f32 v119, v119
    v_fma_f32 v116, v116, v121, v121
    s_waitcnt lgkmcnt(2)
    v_mfma_f32_32x32x16_bf16 v[48:63], v[28:31], v[152:155], v[48:63]
    s_barrier
    v_subrev_u32 v8, 114688, v8
    v_subrev_u32 v9, 114688, v9
    v_subrev_u32 v10, 114688, v10
    v_subrev_u32 v11, 114688, v11
    ds_read_b64_tr_b16 v[16:17], v8 offset:0
    ds_read_b64_tr_b16 v[18:19], v8 offset:512
    v_fma_f32 v117, v117, v121, v121
    v_fma_f32 v118, v118, v121, v121
    v_fma_f32 v119, v119, v121, v121
    v_rcp_f32 v116, v116
    v_rcp_f32 v117, v117
    s_waitcnt lgkmcnt(2)
    v_mfma_f32_32x32x16_bf16 v[48:63], v[108:111], v[156:159], v[48:63]
    ds_read_b64_tr_b16 v[24:25], v9 offset:0
    ds_read_b64_tr_b16 v[26:27], v9 offset:512
    v_rcp_f32 v118, v118
    v_rcp_f32 v119, v119
    v_mul_f32 v112, v36, v116
    v_mul_f32 v113, v37, v117
    v_mul_f32 v114, v38, v118
    v_mul_f32 v115, v39, v119
    s_waitcnt lgkmcnt(2)
    v_mfma_f32_32x32x16_bf16 v[48:63], v[16:19], v[224:227], v[48:63]
    s_setprio 0
    s_add_u32 m0, s51, 114688
    s_mul_i32 s62, s3, 28672
    s_add_u32 s62, s62, s56
    buffer_load_dwordx4 v5, s[16:19], s62 offen lds
    ds_read_b64_tr_b16 v[28:29], v10 offset:0
    ds_read_b64_tr_b16 v[30:31], v10 offset:512
    v_cvt_pk_bf16_f32 v106, v112, v113
    v_cvt_pk_bf16_f32 v107, v114, v115
    buffer_store_dwordx4 v[104:107], v7, s[28:31], s58 offen offset:0 sc1
    v_mul_f32 v116, v40, v40
    v_mul_f32 v117, v41, v41
    s_waitcnt lgkmcnt(2)
    v_mfma_f32_32x32x16_bf16 v[48:63], v[24:27], v[228:231], v[48:63]
    ds_read_b64_tr_b16 v[108:109], v11 offset:0
    ds_read_b64_tr_b16 v[110:111], v11 offset:512
    v_mul_f32 v118, v42, v42
    v_mul_f32 v119, v43, v43
    v_fma_f32 v116, v116, v123, v122
    v_fma_f32 v117, v117, v123, v122
    v_fma_f32 v118, v118, v123, v122
    v_fma_f32 v119, v119, v123, v122
    v_mul_f32 v116, v40, v116
    s_waitcnt lgkmcnt(2)
    v_mfma_f32_32x32x16_bf16 v[48:63], v[28:31], v[232:235], v[48:63]
    s_add_u32 m0, s51, 122880
    s_mul_i32 s62, s4, 28672
    s_add_u32 s62, s62, s56
    buffer_load_dwordx4 v5, s[16:19], s62 offen lds
    ds_read_b64_tr_b16 v[20:21], v8 offset:8192
    ds_read_b64_tr_b16 v[22:23], v8 offset:8704
    v_mul_f32 v117, v41, v117
    v_mul_f32 v118, v42, v118
    v_mul_f32 v119, v43, v119
    v_exp_f32 v116, v116
    v_exp_f32 v117, v117
    s_waitcnt lgkmcnt(2)
    v_mfma_f32_32x32x16_bf16 v[48:63], v[108:111], v[236:239], v[48:63]
    ds_read_b64_tr_b16 v[24:25], v9 offset:8192
    ds_read_b64_tr_b16 v[26:27], v9 offset:8704
    v_exp_f32 v118, v118
    v_exp_f32 v119, v119
    v_fma_f32 v116, v116, v121, v121
    v_fma_f32 v117, v117, v121, v121
    v_fma_f32 v118, v118, v121, v121
    s_waitcnt lgkmcnt(2)
    v_mfma_f32_32x32x16_bf16 v[48:63], v[20:23], v[160:163], v[48:63]
    v_smfmac_f32_16x16x64_bf16 v[80:83], v[84:87], v[16:23], v103
    s_setprio 1
    ds_read_b64_tr_b16 v[28:29], v10 offset:8192
    ds_read_b64_tr_b16 v[30:31], v10 offset:8704
    v_fma_f32 v119, v119, v121, v121
    v_rcp_f32 v116, v116
    v_rcp_f32 v117, v117
    v_rcp_f32 v118, v118
    v_rcp_f32 v119, v119
    s_waitcnt lgkmcnt(2)
    v_mfma_f32_32x32x16_bf16 v[48:63], v[24:27], v[164:167], v[48:63]
    ds_read_b64_tr_b16 v[108:109], v11 offset:8192
    ds_read_b64_tr_b16 v[110:111], v11 offset:8704
    v_mul_f32 v112, v40, v116
    v_mul_f32 v113, v41, v117
    v_mul_f32 v114, v42, v118
    v_mul_f32 v115, v43, v119
    v_cvt_pk_bf16_f32 v104, v112, v113
    v_cvt_pk_bf16_f32 v105, v114, v115
    v_mul_f32 v116, v44, v44
    v_mul_f32 v117, v45, v45
    s_waitcnt lgkmcnt(2)
    v_mfma_f32_32x32x16_bf16 v[48:63], v[28:31], v[168:171], v[48:63]
    s_waitcnt vmcnt(13)
    s_barrier
    ds_read_b64_tr_b16 v[16:17], v8 offset:16384
    ds_read_b64_tr_b16 v[18:19], v8 offset:16896
    v_mul_f32 v118, v46, v46
    v_mul_f32 v119, v47, v47
    v_fma_f32 v116, v116, v123, v122
    v_fma_f32 v117, v117, v123, v122
    v_fma_f32 v118, v118, v123, v122
    v_fma_f32 v119, v119, v123, v122
    s_waitcnt lgkmcnt(2)
    v_mfma_f32_32x32x16_bf16 v[48:63], v[108:111], v[172:175], v[48:63]
    s_add_u32 m0, s51, 131072
    s_mul_i32 s62, s7, 28672
    s_add_u32 s62, s62, s56
    buffer_load_dwordx4 v5, s[16:19], s62 offen lds
    ds_read_b64_tr_b16 v[24:25], v9 offset:16384
    ds_read_b64_tr_b16 v[26:27], v9 offset:16896
    v_mul_f32 v116, v44, v116
    v_mul_f32 v117, v45, v117
    v_mul_f32 v118, v46, v118
    v_mul_f32 v119, v47, v119
    v_exp_f32 v116, v116
    v_exp_f32 v117, v117
    s_waitcnt lgkmcnt(2)
    v_mfma_f32_32x32x16_bf16 v[48:63], v[16:19], v[240:243], v[48:63]
    s_setprio 0
    s_add_u32 m0, s51, 139264
    s_mul_i32 s62, s32, 28672
    s_add_u32 s62, s62, s56
    buffer_load_dwordx4 v5, s[16:19], s62 offen lds
    ds_read_b64_tr_b16 v[28:29], v10 offset:16384
    ds_read_b64_tr_b16 v[30:31], v10 offset:16896
    v_exp_f32 v118, v118
    v_exp_f32 v119, v119
    v_fma_f32 v116, v116, v121, v121
    v_fma_f32 v117, v117, v121, v121
    v_fma_f32 v118, v118, v121, v121
    s_waitcnt lgkmcnt(2)
    v_mfma_f32_32x32x16_bf16 v[48:63], v[24:27], v[244:247], v[48:63]
    ds_read_b64_tr_b16 v[108:109], v11 offset:16384
    ds_read_b64_tr_b16 v[110:111], v11 offset:16896
    v_fma_f32 v119, v119, v121, v121
    v_rcp_f32 v116, v116
    v_rcp_f32 v117, v117
    v_rcp_f32 v118, v118
    v_rcp_f32 v119, v119
    s_waitcnt lgkmcnt(2)
    v_mfma_f32_32x32x16_bf16 v[48:63], v[28:31], v[248:251], v[48:63]
    s_add_u32 m0, s51, 32768
    s_lshl4_add_u32 s62, s63, 0
    buffer_load_dwordx4 v6, s[20:23], s62 offen lds
    ds_read_b64_tr_b16 v[20:21], v8 offset:24576
    ds_read_b64_tr_b16 v[22:23], v8 offset:25088
    v_mul_f32 v112, v44, v116
    v_mul_f32 v113, v45, v117
    v_mul_f32 v114, v46, v118
    v_mul_f32 v115, v47, v119
    v_cvt_pk_bf16_f32 v106, v112, v113
    v_cvt_pk_bf16_f32 v107, v114, v115
    buffer_store_dwordx4 v[104:107], v7, s[28:31], s58 offen offset:1024 sc1
    s_waitcnt lgkmcnt(2)
    v_mfma_f32_32x32x16_bf16 v[48:63], v[108:111], v[252:255], v[48:63]
    ds_read_b64_tr_b16 v[24:25], v9 offset:24576
    ds_read_b64_tr_b16 v[26:27], v9 offset:25088
    s_waitcnt lgkmcnt(2)
    v_mfma_f32_32x32x16_bf16 v[48:63], v[20:23], v[176:179], v[48:63]
    v_smfmac_f32_16x16x64_bf16 v[80:83], v[84:87], v[16:23], v103
    s_setprio 1
    s_add_u32 m0, s51, 40960
    s_lshl4_add_u32 s62, s63, 458752
    buffer_load_dwordx4 v6, s[20:23], s62 offen lds
    ds_read_b64_tr_b16 v[28:29], v10 offset:24576
    ds_read_b64_tr_b16 v[30:31], v10 offset:25088
    s_waitcnt lgkmcnt(2)
    v_mfma_f32_32x32x16_bf16 v[48:63], v[24:27], v[180:183], v[48:63]
    ds_read_b64_tr_b16 v[108:109], v11 offset:24576
    ds_read_b64_tr_b16 v[110:111], v11 offset:25088
    s_waitcnt lgkmcnt(2)
    v_mfma_f32_32x32x16_bf16 v[48:63], v[28:31], v[184:187], v[48:63]
    v_add_f32 v82, v80, v81
    ds_write_b32 v2, v82 offset:1536
    v_mov_b32 v80, 0
    v_mov_b32 v81, 0
    s_waitcnt vmcnt(16) lgkmcnt(0)
    s_barrier
    ds_read_b64_tr_b16 v[16:17], v8 offset:49152
    ds_read_b64_tr_b16 v[18:19], v8 offset:49664
    v_mfma_f32_32x32x16_bf16 v[48:63], v[108:111], v[188:191], v[48:63]
    ds_read_b64_tr_b16 v[24:25], v9 offset:49152
    ds_read_b64_tr_b16 v[26:27], v9 offset:49664
    v_mul_f32 v95, s64, v120
    v_mul_f32 v127, s65, v121
    ds_read2st64_b32 v[88:89], v126 offset0:38 offset1:46
    ds_read2st64_b32 v[90:91], v126 offset0:54 offset1:62
    v_mov_b32 v102, 0x3586
    v_mov_b32 v113, 0x35860000
    s_waitcnt lgkmcnt(4)
    v_mfma_f32_32x32x16_bf16 v[64:79], v[16:19], v[192:195], 0
    s_setprio 0
    s_add_u32 m0, s51, 0
    s_lshl4_add_u32 s62, s75, 0
    buffer_load_dwordx4 v6, s[20:23], s62 offen lds
    ds_read_b64_tr_b16 v[28:29], v10 offset:49152
    ds_read_b64_tr_b16 v[30:31], v10 offset:49664
    s_waitcnt lgkmcnt(2)
    v_add_f32 v88, v88, v89
    v_mfma_f32_32x32x16_bf16 v[64:79], v[24:27], v[196:199], v[64:79]
    ds_read_b64_tr_b16 v[108:109], v11 offset:49152
    ds_read_b64_tr_b16 v[110:111], v11 offset:49664
    v_add_f32 v90, v90, v91
    v_add_f32 v88, v88, v90
    v_and_b32 v112, 0xffff0000, v88
    v_sub_f32 v88, v88, v112
    v_cvt_pk_bf16_f32 v101, v112, v113
    s_waitcnt lgkmcnt(2)
    v_mfma_f32_32x32x16_bf16 v[64:79], v[28:31], v[200:203], v[64:79]
    s_add_u32 m0, s51, 8192
    s_lshl4_add_u32 s62, s75, 458752
    buffer_load_dwordx4 v6, s[20:23], s62 offen lds
    v_add_u32 v8, 57344, v8
    v_add_u32 v9, 57344, v9
    v_add_u32 v10, 57344, v10
    v_add_u32 v11, 57344, v11
    ds_read_b64_tr_b16 v[20:21], v8 offset:0
    ds_read_b64_tr_b16 v[22:23], v8 offset:512
    v_cvt_pk_bf16_f32 v100, v112, v88
    s_nop 1
    v_mfma_f32_32x32x16_bf16 v[48:63], v[100:103], v[96:99], v[48:63]
    s_waitcnt lgkmcnt(2)
    v_mfma_f32_32x32x16_bf16 v[64:79], v[108:111], v[204:207], v[64:79]
    ds_read_b64_tr_b16 v[24:25], v9 offset:0
    ds_read_b64_tr_b16 v[26:27], v9 offset:512
    s_waitcnt lgkmcnt(2)
    v_mfma_f32_32x32x16_bf16 v[64:79], v[20:23], v[128:131], v[64:79]
    v_smfmac_f32_16x16x64_bf16 v[80:83], v[84:87], v[16:23], v103
    s_setprio 1
    ds_read_b64_tr_b16 v[28:29], v10 offset:0
    ds_read_b64_tr_b16 v[30:31], v10 offset:512
    s_waitcnt lgkmcnt(2)
    v_mfma_f32_32x32x16_bf16 v[64:79], v[24:27], v[132:135], v[64:79]
    ds_read_b64_tr_b16 v[108:109], v11 offset:0
    ds_read_b64_tr_b16 v[110:111], v11 offset:512
    v_mul_f32 v116, v48, v95
    v_mul_f32 v117, v49, v95
    v_mul_f32 v118, v50, v95
    v_mul_f32 v119, v51, v95
    s_waitcnt lgkmcnt(2)
    v_mfma_f32_32x32x16_bf16 v[64:79], v[28:31], v[136:139], v[64:79]
    s_waitcnt vmcnt(3)
    s_barrier
    s_cmp_lg_u32 s50, 1
    s_cbranch_scc1 L_pub_5
    v_mov_b32 v124, 1
    s_mov_b64 exec, 1
    buffer_store_dword v124, off, s[28:31], s68 sc1
    s_mov_b64 exec, -1
L_pub_5:
    ds_read_b64_tr_b16 v[16:17], v8 offset:8192
    ds_read_b64_tr_b16 v[18:19], v8 offset:8704
    v_max_f32 v112, v48, v127
    v_max_f32 v113, v49, v127
    v_max_f32 v114, v50, v127
    v_max_f32 v115, v51, v127
    v_exp_f32 v116, v116 clamp
    s_waitcnt lgkmcnt(2)
    v_mfma_f32_32x32x16_bf16 v[64:79], v[108:111], v[140:143], v[64:79]
    ds_read_b64_tr_b16 v[24:25], v9 offset:8192
    ds_read_b64_tr_b16 v[26:27], v9 offset:8704
    v_exp_f32 v117, v117 clamp
    v_exp_f32 v118, v118 clamp
    s_waitcnt lgkmcnt(2)
    v_mfma_f32_32x32x16_bf16 v[64:79], v[16:19], v[208:211], v[64:79]
    s_setprio 0
    s_add_u32 m0, s51, 16384
    s_lshl4_add_u32 s62, s75, 917504
    buffer_load_dwordx4 v6, s[20:23], s62 offen lds
    ds_read_b64_tr_b16 v[28:29], v10 offset:8192
    ds_read_b64_tr_b16 v[30:31], v10 offset:8704
    v_exp_f32 v119, v119 clamp
    v_fma_f32 v112, v112, v120, v116
    s_waitcnt lgkmcnt(2)
    v_mfma_f32_32x32x16_bf16 v[64:79], v[24:27], v[212:215], v[64:79]
    ds_read_b64_tr_b16 v[108:109], v11 offset:8192
    ds_read_b64_tr_b16 v[110:111], v11 offset:8704
    v_fma_f32 v113, v113, v120, v117
    v_fma_f32 v114, v114, v120, v118
    v_fma_f32 v115, v115, v120, v119
    s_waitcnt lgkmcnt(2)
    v_mfma_f32_32x32x16_bf16 v[64:79], v[28:31], v[216:219], v[64:79]
    s_add_u32 m0, s51, 24576
    s_lshl4_add_u32 s62, s75, 1376256
    buffer_load_dwordx4 v6, s[20:23], s62 offen lds
    ds_read_b64_tr_b16 v[20:21], v8 offset:16384
    ds_read_b64_tr_b16 v[22:23], v8 offset:16896
    v_cvt_pk_bf16_f32 v104, v112, v113
    v_cvt_pk_bf16_f32 v105, v114, v115
    v_mul_f32 v116, v52, v95
    v_mul_f32 v117, v53, v95
    s_waitcnt lgkmcnt(2)
    v_mfma_f32_32x32x16_bf16 v[64:79], v[108:111], v[220:223], v[64:79]
    ds_read_b64_tr_b16 v[24:25], v9 offset:16384
    ds_read_b64_tr_b16 v[26:27], v9 offset:16896
    v_mul_f32 v118, v54, v95
    v_mul_f32 v119, v55, v95
    v_max_f32 v112, v52, v127
    v_max_f32 v113, v53, v127
    s_waitcnt lgkmcnt(2)
    v_mfma_f32_32x32x16_bf16 v[64:79], v[20:23], v[144:147], v[64:79]
    v_smfmac_f32_16x16x64_bf16 v[80:83], v[84:87], v[16:23], v103
    s_setprio 1
    ds_read_b64_tr_b16 v[28:29], v10 offset:16384
    ds_read_b64_tr_b16 v[30:31], v10 offset:16896
    v_max_f32 v114, v54, v127
    v_max_f32 v115, v55, v127
    v_exp_f32 v116, v116 clamp
    v_exp_f32 v117, v117 clamp
    s_waitcnt lgkmcnt(2)
    v_mfma_f32_32x32x16_bf16 v[64:79], v[24:27], v[148:151], v[64:79]
    ds_read_b64_tr_b16 v[108:109], v11 offset:16384
    ds_read_b64_tr_b16 v[110:111], v11 offset:16896
    v_exp_f32 v118, v118 clamp
    v_exp_f32 v119, v119 clamp
    s_waitcnt lgkmcnt(2)
    v_mfma_f32_32x32x16_bf16 v[64:79], v[28:31], v[152:155], v[64:79]
    s_barrier
    ds_read_b64_tr_b16 v[16:17], v8 offset:24576
    ds_read_b64_tr_b16 v[18:19], v8 offset:25088
    v_fma_f32 v112, v112, v120, v116
    v_fma_f32 v113, v113, v120, v117
    v_fma_f32 v114, v114, v120, v118
    s_waitcnt lgkmcnt(2)
    v_mfma_f32_32x32x16_bf16 v[64:79], v[108:111], v[156:159], v[64:79]
    ds_read_b64_tr_b16 v[24:25], v9 offset:24576
    ds_read_b64_tr_b16 v[26:27], v9 offset:25088
    v_fma_f32 v115, v115, v120, v119
    v_cvt_pk_bf16_f32 v106, v112, v113
    v_cvt_pk_bf16_f32 v107, v114, v115
    buffer_store_dwordx4 v[104:107], v7, s[28:31], s61 offen offset:0 sc1
    s_waitcnt lgkmcnt(2)
    v_mfma_f32_32x32x16_bf16 v[64:79], v[16:19], v[224:227], v[64:79]
    s_setprio 0
    s_add_u32 m0, s51, 49152
    s_lshl4_add_u32 s62, s63, 917504
    buffer_load_dwordx4 v6, s[20:23], s62 offen lds
    ds_read_b64_tr_b16 v[28:29], v10 offset:24576
    ds_read_b64_tr_b16 v[30:31], v10 offset:25088
    v_mul_f32 v116, v56, v95
    v_mul_f32 v117, v57, v95
    s_waitcnt lgkmcnt(2)
    v_mfma_f32_32x32x16_bf16 v[64:79], v[24:27], v[228:231], v[64:79]
    ds_read_b64_tr_b16 v[108:109], v11 offset:24576
    ds_read_b64_tr_b16 v[110:111], v11 offset:25088
    v_mul_f32 v118, v58, v95
    v_mul_f32 v119, v59, v95
    v_max_f32 v112, v56, v127
    v_max_f32 v113, v57, v127
    v_max_f32 v114, v58, v127
    s_waitcnt lgkmcnt(2)
    v_mfma_f32_32x32x16_bf16 v[64:79], v[28:31], v[232:235], v[64:79]
    s_add_u32 m0, s51, 57344
    s_lshl4_add_u32 s62, s63, 1376256
    buffer_load_dwordx4 v6, s[20:23], s62 offen lds
    ds_read_b64_tr_b16 v[20:21], v8 offset:32768
    ds_read_b64_tr_b16 v[22:23], v8 offset:33280
    v_max_f32 v115, v59, v127
    v_exp_f32 v116, v116 clamp
    v_exp_f32 v117, v117 clamp
    s_waitcnt lgkmcnt(2)
    v_mfma_f32_32x32x16_bf16 v[64:79], v[108:111], v[236:239], v[64:79]
    ds_read_b64_tr_b16 v[24:25], v9 offset:32768
    ds_read_b64_tr_b16 v[26:27], v9 offset:33280
    v_exp_f32 v118, v118 clamp
    v_exp_f32 v119, v119 clamp
    s_waitcnt lgkmcnt(2)
    v_mfma_f32_32x32x16_bf16 v[64:79], v[20:23], v[160:163], v[64:79]
    v_smfmac_f32_16x16x64_bf16 v[80:83], v[84:87], v[16:23], v103
    s_setprio 1
    ds_read_b64_tr_b16 v[28:29], v10 offset:32768
    ds_read_b64_tr_b16 v[30:31], v10 offset:33280
    v_fma_f32 v112, v112, v120, v116
    v_fma_f32 v113, v113, v120, v117
    v_fma_f32 v114, v114, v120, v118
    s_waitcnt lgkmcnt(2)
    v_mfma_f32_32x32x16_bf16 v[64:79], v[24:27], v[164:167], v[64:79]
    ds_read_b64_tr_b16 v[108:109], v11 offset:32768
    ds_read_b64_tr_b16 v[110:111], v11 offset:33280
    v_fma_f32 v115, v115, v120, v119
    v_cvt_pk_bf16_f32 v104, v112, v113
    v_cvt_pk_bf16_f32 v105, v114, v115
    v_mul_f32 v116, v60, v95
    v_mul_f32 v117, v61, v95
    s_waitcnt lgkmcnt(2)
    v_mfma_f32_32x32x16_bf16 v[64:79], v[28:31], v[168:171], v[64:79]
    s_barrier
    ds_read_b64_tr_b16 v[16:17], v8 offset:40960
    ds_read_b64_tr_b16 v[18:19], v8 offset:41472
    v_mul_f32 v118, v62, v95
    v_mul_f32 v119, v63, v95
    v_max_f32 v112, v60, v127
    v_max_f32 v113, v61, v127
    v_max_f32 v114, v62, v127
    s_waitcnt lgkmcnt(2)
    v_mfma_f32_32x32x16_bf16 v[64:79], v[108:111], v[172:175], v[64:79]
    s_cmp_lg_u32 s50, 0
    s_cbranch_scc1 L_pi_6
    s_load_dwordx8 s[76:83], s[44:45], 0 glc
    s_load_dwordx8 s[84:91], s[44:45], 32 glc
L_pi_6:
    ds_read_b64_tr_b16 v[24:25], v9 offset:40960
    ds_read_b64_tr_b16 v[26:27], v9 offset:41472
    v_max_f32 v115, v63, v127
    v_exp_f32 v116, v116 clamp
    v_exp_f32 v117, v117 clamp
    s_waitcnt lgkmcnt(2)
    v_mfma_f32_32x32x16_bf16 v[64:79], v[16:19], v[240:243], v[64:79]
    s_setprio 0
    s_add_u32 m0, s51, 65536
    s_lshl4_add_u32 s62, s54, 0
    buffer_load_dwordx4 v6, s[20:23], s62 offen lds
    ds_read_b64_tr_b16 v[28:29], v10 offset:40960
    ds_read_b64_tr_b16 v[30:31], v10 offset:41472
    v_exp_f32 v118, v118 clamp
    v_exp_f32 v119, v119 clamp
    s_waitcnt lgkmcnt(2)
    v_mfma_f32_32x32x16_bf16 v[64:79], v[24:27], v[244:247], v[64:79]
    ds_read_b64_tr_b16 v[108:109], v11 offset:40960
    ds_read_b64_tr_b16 v[110:111], v11 offset:41472
    v_fma_f32 v112, v112, v120, v116
    v_fma_f32 v113, v113, v120, v117
    v_fma_f32 v114, v114, v120, v118
    v_fma_f32 v115, v115, v120, v119
    s_waitcnt lgkmcnt(2)
    v_mfma_f32_32x32x16_bf16 v[64:79], v[28:31], v[248:251], v[64:79]
    s_add_u32 m0, s51, 73728
    s_lshl4_add_u32 s62, s54, 458752
    buffer_load_dwordx4 v6, s[20:23], s62 offen lds
    ds_read_b64_tr_b16 v[20:21], v8 offset:49152
    ds_read_b64_tr_b16 v[22:23], v8 offset:49664
    v_cvt_pk_bf16_f32 v106, v112, v113
    v_cvt_pk_bf16_f32 v107, v114, v115
    buffer_store_dwordx4 v[104:107], v7, s[28:31], s61 offen offset:1024 sc1
    s_waitcnt lgkmcnt(2)
    v_mfma_f32_32x32x16_bf16 v[64:79], v[108:111], v[252:255], v[64:79]
    ds_read_b64_tr_b16 v[24:25], v9 offset:49152
    ds_read_b64_tr_b16 v[26:27], v9 offset:49664
    s_waitcnt lgkmcnt(2)
    v_mfma_f32_32x32x16_bf16 v[64:79], v[20:23], v[176:179], v[64:79]
    v_smfmac_f32_16x16x64_bf16 v[80:83], v[84:87], v[16:23], v103
    s_setprio 1
    ds_read_b64_tr_b16 v[28:29], v10 offset:49152
    ds_read_b64_tr_b16 v[30:31], v10 offset:49664
    s_waitcnt lgkmcnt(2)
    v_mfma_f32_32x32x16_bf16 v[64:79], v[24:27], v[180:183], v[64:79]
    ds_read_b64_tr_b16 v[108:109], v11 offset:49152
    ds_read_b64_tr_b16 v[110:111], v11 offset:49664
    s_waitcnt lgkmcnt(2)
    v_mfma_f32_32x32x16_bf16 v[64:79], v[28:31], v[184:187], v[64:79]
    s_nop 2
    v_add_f32 v82, v80, v81
    ds_write_b32 v2, v82 offset:512
    v_mov_b32 v80, 0
    v_mov_b32 v81, 0
    s_cmp_lg_u32 s50, 0
    s_cbranch_scc1 L_pc_7
    s_mov_b32 s69, 0
L_pl_8:
    s_waitcnt lgkmcnt(0)
    s_min_u32 s76, s76, s80
    s_min_u32 s77, s77, s81
    s_min_u32 s78, s78, s82
    s_min_u32 s79, s79, s83
    s_min_u32 s76, s76, s78
    s_min_u32 s77, s77, s79
    s_min_u32 s76, s76, s77
    s_min_u32 s84, s84, s88
    s_min_u32 s85, s85, s89
    s_min_u32 s86, s86, s90
    s_min_u32 s87, s87, s91
    s_min_u32 s84, s84, s86
    s_min_u32 s85, s85, s87
    s_min_u32 s84, s84, s85
    s_cmp_ge_u32 s84, 1
    s_cselect_b32 s76, s76, 0
    s_cmp_ge_u32 s76, 1
    s_cbranch_scc1 L_pc_7
    s_add_u32 s69, s69, 1
    s_cmp_ge_u32 s69, 0x40000
    s_cbranch_scc1 L_pc_7
    s_load_dwordx8 s[76:83], s[44:45], 0 glc
    s_load_dwordx8 s[84:91], s[44:45], 32 glc
    s_branch L_pl_8
L_pc_7:
    s_waitcnt lgkmcnt(0)
    s_barrier
    v_lshlrev_b32 v3, 4, v1
    v_add_u32 v12, 114688, v12
    v_add_u32 v13, 114688, v13
    v_add_u32 v14, 114688, v14
    v_add_u32 v15, 114688, v15
    ds_read_b64_tr_b16 v[16:17], v12 offset:0
    ds_read_b64_tr_b16 v[18:19], v12 offset:256
    v_mfma_f32_32x32x16_bf16 v[64:79], v[108:111], v[188:191], v[64:79]
    s_add_u32 s62, s70, s75
    buffer_load_dwordx4 v[128:131], v3, s[28:31], s62 offen offset:0 sc1
    v_lshrrev_b32 v8, 5, v1
    v_lshlrev_b32 v8, 9, v8
    v_bfe_u32 v125, v1, 2, 2
    v_lshl_add_u32 v8, v125, 7, v8
    v_bfe_u32 v125, v1, 3, 1
    v_lshl_add_u32 v8, v125, 6, v8
    v_bfe_u32 v125, v1, 4, 1
    v_lshl_add_u32 v8, v125, 5, v8
    v_bfe_u32 v125, v1, 0, 2
    v_lshl_add_u32 v8, v125, 3, v8
    s_and_b32 s72, s50, 3
    s_lshl_b32 s72, s72, 13
    v_add_u32 v8, s72, v8
    v_xor_b32 v9, 64, v8
    v_add_u32 v10, 0x10000, v8
    v_add_u32 v11, 0x10000, v9
    ds_read_b64_tr_b16 v[24:25], v13 offset:0
    ds_read_b64_tr_b16 v[26:27], v13 offset:256
    ds_read2st64_b32 v[88:89], v126 offset0:34 offset1:42
    ds_read2st64_b32 v[90:91], v126 offset0:50 offset1:58
    v_mov_b32 v102, v93
    v_lshlrev_b32 v113, 16, v93
    s_waitcnt lgkmcnt(0)
    v_add_f32 v88, v88, v89
    v_add_f32 v90, v90, v91
    v_add_f32 v88, v88, v90
    v_and_b32 v112, 0xffff0000, v88
    v_sub_f32 v88, v88, v112
    v_cvt_pk_bf16_f32 v101, v112, v113
    v_cvt_pk_bf16_f32 v100, v112, v88
    v_mfma_f32_32x32x16_bf16 v[32:47], v[16:19], v[192:195], 0
    s_setprio 0
    s_add_u32 m0, s51, 81920
    s_lshl4_add_u32 s62, s54, 917504
    buffer_load_dwordx4 v6, s[20:23], s62 offen lds
    ds_read_b64_tr_b16 v[28:29], v14 offset:0
    ds_read_b64_tr_b16 v[30:31], v14 offset:256
    v_mfma_f32_32x32x16_bf16 v[64:79], v[100:103], v[96:99], v[64:79]
    s_nop 11
    v_mul_f32 v116, v64, v64
    v_mfma_f32_32x32x16_bf16 v[32:47], v[24:27], v[196:199], v[32:47]
    s_add_u32 s62, s70, s75
    buffer_load_dwordx4 v[132:135], v3, s[28:31], s62 offen offset:1024 sc1
    ds_read_b64_tr_b16 v[108:109], v15 offset:0
    ds_read_b64_tr_b16 v[110:111], v15 offset:256
    v_mul_f32 v117, v65, v65
    v_mul_f32 v118, v66, v66
    v_mul_f32 v119, v67, v67
    v_fma_f32 v116, v116, v123, v122
    v_fma_f32 v117, v117, v123, v122
    v_fma_f32 v118, v118, v123, v122
    v_fma_f32 v119, v119, v123, v122
    v_mul_f32 v116, v64, v116
    v_mul_f32 v117, v65, v117
    v_mul_f32 v118, v66, v118
    s_waitcnt lgkmcnt(2)
    v_mfma_f32_32x32x16_bf16 v[32:47], v[28:31], v[200:203], v[32:47]
    s_add_u32 s62, s70, s75
    buffer_load_dwordx4 v[136:139], v3, s[28:31], s62 offen offset:2048 sc1
    ds_read_b64_tr_b16 v[20:21], v12 offset:4096
    ds_read_b64_tr_b16 v[22:23], v12 offset:4352
    v_mul_f32 v119, v67, v119
    v_exp_f32 v116, v116
    v_exp_f32 v117, v117
    v_exp_f32 v118, v118
    v_exp_f32 v119, v119
    v_fma_f32 v116, v116, v121, v121
    v_fma_f32 v117, v117, v121, v121
    s_waitcnt lgkmcnt(2)
    v_mfma_f32_32x32x16_bf16 v[32:47], v[108:111], v[204:207], v[32:47]
    s_add_u32 m0, s51, 90112
    s_lshl4_add_u32 s62, s54, 1376256
    buffer_load_dwordx4 v6, s[20:23], s62 offen lds
    ds_read_b64_tr_b16 v[24:25], v13 offset:4096
    ds_read_b64_tr_b16 v[26:27], v13 offset:4352
    v_fma_f32 v118, v118, v121, v121
    v_fma_f32 v119, v119, v121, v121
    v_rcp_f32 v116, v116
    v_rcp_f32 v117, v117
    v_rcp_f32 v118, v118
    v_rcp_f32 v119, v119
    v_mul_f32 v112, v64, v116
    v_mul_f32 v113, v65, v117
    s_waitcnt lgkmcnt(2)
    v_mfma_f32_32x32x16_bf16 v[32:47], v[20:23], v[208:211], v[32:47]
    v_smfmac_f32_16x16x64_bf16 v[80:83], v[84:87], v[16:23], v103
    s_setprio 1
    s_add_u32 s62, s70, s75
    buffer_load_dwordx4 v[140:143], v3, s[28:31], s62 offen offset:3072 sc1
    ds_read_b64_tr_b16 v[28:29], v14 offset:4096
    ds_read_b64_tr_b16 v[30:31], v14 offset:4352
    v_mul_f32 v114, v66, v118
    v_mul_f32 v115, v67, v119
    v_cvt_pk_bf16_f32 v104, v112, v113
    v_cvt_pk_bf16_f32 v105, v114, v115
    v_mul_f32 v116, v68, v68
    v_mul_f32 v117, v69, v69
    v_mul_f32 v118, v70, v70
    v_mul_f32 v119, v71, v71
    v_fma_f32 v116, v116, v123, v122
    v_fma_f32 v117, v117, v123, v122
    v_fma_f32 v118, v118, v123, v122
    s_waitcnt lgkmcnt(2)
    v_mfma_f32_32x32x16_bf16 v[32:47], v[24:27], v[212:215], v[32:47]
    s_add_u32 s62, s70, s63
    buffer_load_dwordx4 v[144:147], v3, s[28:31], s62 offen offset:0 sc1
    ds_read_b64_tr_b16 v[108:109], v15 offset:4096
    ds_read_b64_tr_b16 v[110:111], v15 offset:4352
    v_fma_f32 v119, v119, v123, v122
    v_mul_f32 v116, v68, v116
    v_mul_f32 v117, v69, v117
    v_mul_f32 v118, v70, v118
    v_mul_f32 v119, v71, v119
    v_exp_f32 v116, v116
    v_exp_f32 v117, v117
    v_exp_f32 v118, v118
    v_exp_f32 v119, v119
    s_waitcnt lgkmcnt(2)
    v_mfma_f32_32x32x16_bf16 v[32:47], v[28:31], v[216:219], v[32:47]
    s_add_u32 s62, s70, s63
    buffer_load_dwordx4 v[148:151], v3, s[28:31], s62 offen offset:1024 sc1
    s_waitcnt vmcnt(8)
    s_barrier
    s_cmp_lg_u32 s50, 1
    s_cbranch_scc1 L_pub_9
    v_mov_b32 v124, 2
    s_mov_b64 exec, 1
    buffer_store_dword v124, off, s[28:31], s68 sc1
    s_mov_b64 exec, -1
L_pub_9:
    ds_read_b64_tr_b16 v[16:17], v12 offset:16384
    ds_read_b64_tr_b16 v[18:19], v12 offset:16640
    v_fma_f32 v116, v116, v121, v121
    v_fma_f32 v117, v117, v121, v121
    v_fma_f32 v118, v118, v121, v121
    v_fma_f32 v119, v119, v121, v121
    v_rcp_f32 v116, v116
    v_rcp_f32 v117, v117
    v_rcp_f32 v118, v118
    s_waitcnt lgkmcnt(2)
    v_mfma_f32_32x32x16_bf16 v[32:47], v[108:111], v[220:223], v[32:47]
    s_add_u32 s62, s70, s63
    buffer_load_dwordx4 v[152:155], v3, s[28:31], s62 offen offset:2048 sc1
    ds_read_b64_tr_b16 v[24:25], v13 offset:16384
    ds_read_b64_tr_b16 v[26:27], v13 offset:16640
    v_rcp_f32 v119, v119
    v_mul_f32 v112, v68, v116
    v_mul_f32 v113, v69, v117
    v_mul_f32 v114, v70, v118
    v_mul_f32 v115, v71, v119
    v_cvt_pk_bf16_f32 v106, v112, v113
    v_cvt_pk_bf16_f32 v107, v114, v115
    buffer_store_dwordx4 v[104:107], v7, s[28:31], s59 offen offset:0 sc1
    v_mul_f32 v116, v72, v72
    v_mul_f32 v117, v73, v73
    s_waitcnt lgkmcnt(2)
    v_mfma_f32_32x32x16_bf16 v[32:47], v[16:19], v[224:227], v[32:47]
    s_setprio 0
    s_add_u32 s62, s70, s63
    buffer_load_dwordx4 v[156:159], v3, s[28:31], s62 offen offset:3072 sc1
    ds_read_b64_tr_b16 v[28:29], v14 offset:16384
    ds_read_b64_tr_b16 v[30:31], v14 offset:16640
    v_mul_f32 v118, v74, v74
    v_mul_f32 v119, v75, v75
    v_fma_f32 v116, v116, v123, v122
    v_fma_f32 v117, v117, v123, v122
    v_fma_f32 v118, v118, v123, v122
    v_fma_f32 v119, v119, v123, v122
    v_mul_f32 v116, v72, v116
    v_mul_f32 v117, v73, v117
    v_mul_f32 v118, v74, v118
    v_mul_f32 v119, v75, v119
    v_exp_f32 v116, v116
    s_waitcnt lgkmcnt(2)
    v_mfma_f32_32x32x16_bf16 v[32:47], v[24:27], v[228:231], v[32:47]
    s_add_u32 m0, s51, 98304
    s_lshl4_add_u32 s62, s53, 0
    buffer_load_dwordx4 v6, s[20:23], s62 offen lds
    ds_read_b64_tr_b16 v[108:109], v15 offset:16384
    ds_read_b64_tr_b16 v[110:111], v15 offset:16640
    v_exp_f32 v117, v117
    v_exp_f32 v118, v118
    v_exp_f32 v119, v119
    v_fma_f32 v116, v116, v121, v121
    v_fma_f32 v117, v117, v121, v121
    v_fma_f32 v118, v118, v121, v121
    v_fma_f32 v119, v119, v121, v121
    s_waitcnt lgkmcnt(2)
    v_mfma_f32_32x32x16_bf16 v[32:47], v[28:31], v[232:235], v[32:47]
    s_add_u32 s62, s70, s54
    buffer_load_dwordx4 v[160:163], v3, s[28:31], s62 offen offset:0 sc1
    ds_read_b64_tr_b16 v[20:21], v12 offset:20480
    ds_read_b64_tr_b16 v[22:23], v12 offset:20736
    v_rcp_f32 v116, v116
    v_rcp_f32 v117, v117
    v_rcp_f32 v118, v118
    v_rcp_f32 v119, v119
    v_mul_f32 v112, v72, v116
    v_mul_f32 v113, v73, v117
    v_mul_f32 v114, v74, v118
    v_mul_f32 v115, v75, v119
    v_cvt_pk_bf16_f32 v104, v112, v113
    v_cvt_pk_bf16_f32 v105, v114, v115
    s_waitcnt lgkmcnt(2)
    v_mfma_f32_32x32x16_bf16 v[32:47], v[108:111], v[236:239], v[32:47]
    s_add_u32 s62, s70, s54
    buffer_load_dwordx4 v[164:167], v3, s[28:31], s62 offen offset:1024 sc1
    ds_read_b64_tr_b16 v[24:25], v13 offset:20480
    ds_read_b64_tr_b16 v[26:27], v13 offset:20736
    v_mul_f32 v116, v76, v76
    v_mul_f32 v117, v77, v77
    v_mul_f32 v118, v78, v78
    v_mul_f32 v119, v79, v79
    v_fma_f32 v116, v116, v123, v122
    v_fma_f32 v117, v117, v123, v122
    v_fma_f32 v118, v118, v123, v122
    v_fma_f32 v119, v119, v123, v122
    v_mul_f32 v116, v76, v116
    v_mul_f32 v117, v77, v117
    v_mul_f32 v118, v78, v118
    v_mul_f32 v119, v79, v119
    s_waitcnt lgkmcnt(2)
    v_mfma_f32_32x32x16_bf16 v[32:47], v[20:23], v[240:243], v[32:47]
    v_smfmac_f32_16x16x64_bf16 v[80:83], v[84:87], v[16:23], v103
    s_setprio 1
    s_add_u32 m0, s51, 106496
    s_lshl4_add_u32 s62, s53, 458752
    buffer_load_dwordx4 v6, s[20:23], s62 offen lds
    ds_read_b64_tr_b16 v[28:29], v14 offset:20480
    ds_read_b64_tr_b16 v[30:31], v14 offset:20736
    v_exp_f32 v116, v116
    v_exp_f32 v117, v117
    v_exp_f32 v118, v118
    v_exp_f32 v119, v119
    v_fma_f32 v116, v116, v121, v121
    v_fma_f32 v117, v117, v121, v121
    v_fma_f32 v118, v118, v121, v121
    v_fma_f32 v119, v119, v121, v121
    s_waitcnt lgkmcnt(2)
    v_mfma_f32_32x32x16_bf16 v[32:47], v[24:27], v[244:247], v[32:47]
    s_add_u32 s62, s70, s54
    buffer_load_dwordx4 v[168:171], v3, s[28:31], s62 offen offset:2048 sc1
    ds_read_b64_tr_b16 v[108:109], v15 offset:20480
    ds_read_b64_tr_b16 v[110:111], v15 offset:20736
    v_rcp_f32 v116, v116
    v_rcp_f32 v117, v117
    v_rcp_f32 v118, v118
    v_rcp_f32 v119, v119
    v_mul_f32 v112, v76, v116
    v_mul_f32 v113, v77, v117
    v_mul_f32 v114, v78, v118
    v_mul_f32 v115, v79, v119
    v_cvt_pk_bf16_f32 v106, v112, v113
    v_cvt_pk_bf16_f32 v107, v114, v115
    buffer_store_dwordx4 v[104:107], v7, s[28:31], s59 offen offset:1024 sc1
    s_waitcnt lgkmcnt(2)
    v_mfma_f32_32x32x16_bf16 v[32:47], v[28:31], v[248:251], v[32:47]
    s_add_u32 s62, s70, s54
    buffer_load_dwordx4 v[172:175], v3, s[28:31], s62 offen offset:3072 sc1
    v_add_f32 v82, v80, v81
    ds_write_b32 v2, v82 offset:1024
    v_mov_b32 v80, 0
    v_mov_b32 v81, 0
    s_waitcnt lgkmcnt(0)
    s_barrier
    v_lshlrev_b32 v124, 4, v0
    v_add_u32 v124, 114688, v124
    v_xor_b32 v125, 4096, v124
    ds_read2st64_b32 v[88:89], v126 offset0:36 offset1:44
    ds_read2st64_b32 v[90:91], v126 offset0:52 offset1:60
    v_xor_b32 v112, 64, v126
    ds_read2st64_b32 v[116:117], v112 offset0:37 offset1:45
    ds_read2st64_b32 v[118:119], v112 offset0:53 offset1:61
    v_mov_b32 v102, v94
    v_lshlrev_b32 v113, 16, v94
    ds_read_b64_tr_b16 v[16:17], v8 offset:0
    ds_read_b64_tr_b16 v[18:19], v8 offset:1024
    ds_read_b64_tr_b16 v[20:21], v9 offset:0
    ds_read_b64_tr_b16 v[22:23], v9 offset:1024
    v_mfma_f32_32x32x16_bf16 v[32:47], v[108:111], v[252:255], v[32:47]
    s_add_u32 s62, s70, s53
    buffer_load_dwordx4 v[176:179], v3, s[28:31], s62 offen offset:0 sc1
    s_setprio 0
    s_add_u32 s62, s70, s53
    buffer_load_dwordx4 v[180:183], v3, s[28:31], s62 offen offset:1024 sc1
    s_add_u32 s62, s70, s53
    buffer_load_dwordx4 v[184:187], v3, s[28:31], s62 offen offset:2048 sc1
    s_add_u32 s62, s70, s53
    buffer_load_dwordx4 v[188:191], v3, s[28:31], s62 offen offset:3072 sc1
    s_branch L_p2q
.p2align 6
L_q1:
    ds_read_b128 v[128:131], v12 offset:16384
    ds_read_b128 v[132:135], v13 offset:16384
    ds_read_b128 v[136:139], v14 offset:16384
    ds_read_b128 v[140:143], v15 offset:16384
    ds_read_b64_tr_b16 v[16:17], v8 offset:8192
    ds_read_b64_tr_b16 v[18:19], v8 offset:8704
    ds_read_b64_tr_b16 v[24:25], v9 offset:8192
    ds_read_b64_tr_b16 v[26:27], v9 offset:8704
    s_mov_b32 s38, 256
    s_mov_b32 s39, 0x20000
    s_add_u32 s7, s3, 32
    s_and_b32 s7, s7, 63
    s_add_u32 s32, s3, 40
    s_and_b32 s32, s32, 63
    s_add_u32 s33, s3, 48
    s_and_b32 s33, s33, 63
    s_add_u32 s34, s3, 56
    s_and_b32 s34, s34, 63
    s_waitcnt lgkmcnt(2)
    v_mfma_f32_32x32x16_bf16 v[32:47], v[16:19], v[128:131], 0
    s_setprio 1
    s_add_u32 m0, s51, 114688
    s_mul_i32 s62, s5, 28672
    s_add_u32 s62, s62, s54
    buffer_load_dwordx4 v4, s[16:19], s62 offen lds
    ds_read_b64_tr_b16 v[28:29], v10 offset:8192
    ds_read_b64_tr_b16 v[30:31], v10 offset:8704
    s_mov_b32 s14, 1572864
    s_mov_b32 s15, 0x20000
    s_mov_b32 s42, 3584
    s_mov_b32 s43, 0x20000
    s_waitcnt lgkmcnt(2)
    v_mfma_f32_32x32x16_bf16 v[32:47], v[24:27], v[132:135], v[32:47]
    s_add_u32 m0, s51, 131072
    s_lshl4_add_u32 s62, s5, s69
    buffer_load_dwordx4 v2, s[8:11], s62 offen lds
    v_smfmac_f32_16x16x64_bf16 v[88:91], v[84:87], v[128:135], v103
    v_smfmac_f32_16x16x64_bf16 v[88:91], v[84:87], v[136:143], v103
    ds_read_b64_tr_b16 v[108:109], v11 offset:8192
    ds_read_b64_tr_b16 v[110:111], v11 offset:8704
    s_mov_b32 s22, 1835008
    s_mov_b32 s23, 0x20000
    s_movk_i32 s76, 3072
    v_mad_u32_u24 v3, v112, s76, v113
    s_waitcnt lgkmcnt(2)
    v_mfma_f32_32x32x16_bf16 v[32:47], v[28:31], v[136:139], v[32:47]
    s_add_u32 m0, s51, 139264
    s_mul_i32 s62, s6, 28672
    s_add_u32 s62, s62, s54
    buffer_load_dwordx4 v4, s[16:19], s62 offen lds
    s_waitcnt vmcnt(5)
    s_barrier
    ds_read_b128 v[192:195], v12 offset:40960
    ds_read_b128 v[196:199], v13 offset:40960
    ds_read_b128 v[200:203], v14 offset:40960
    ds_read_b128 v[204:207], v15 offset:40960
    ds_read_b64_tr_b16 v[20:21], v8 offset:32768
    ds_read_b64_tr_b16 v[22:23], v8 offset:33280
    v_lshl_add_u32 v6, v112, 10, v113
    s_waitcnt lgkmcnt(6)
    v_mfma_f32_32x32x16_bf16 v[32:47], v[108:111], v[140:143], v[32:47]
    s_add_u32 m0, s51, 0
    s_lshl4_add_u32 s62, s6, s53
    buffer_load_dwordx4 v2, s[8:11], s62 offen lds
    ds_read_b64_tr_b16 v[24:25], v9 offset:32768
    ds_read_b64_tr_b16 v[26:27], v9 offset:33280
    s_lshl_b32 s76, s67, 7
    v_add_u32 v6, s76, v6
    v_and_b32 v117, 31, v0
    s_waitcnt lgkmcnt(2)
    v_mfma_f32_32x32x16_bf16 v[32:47], v[20:23], v[192:195], v[32:47]
    v_smfmac_f32_16x16x64_bf16 v[80:83], v[84:87], v[16:23], v103
    s_setprio 0
    s_add_u32 m0, s51, 8192
    s_lshl4_add_u32 s62, s6, s69
    buffer_load_dwordx4 v2, s[8:11], s62 offen lds
    ds_read_b64_tr_b16 v[28:29], v10 offset:32768
    ds_read_b64_tr_b16 v[30:31], v10 offset:33280
    v_lshlrev_b32 v116, 1, v117
    s_waitcnt lgkmcnt(2)
    v_mfma_f32_32x32x16_bf16 v[32:47], v[24:27], v[196:199], v[32:47]
    s_add_u32 m0, s51, 16384
    s_mul_i32 s62, s7, 28672
    s_add_u32 s62, s62, s54
    buffer_load_dwordx4 v4, s[16:19], s62 offen lds
    v_smfmac_f32_16x16x64_bf16 v[88:91], v[84:87], v[192:199], v103
    v_smfmac_f32_16x16x64_bf16 v[88:91], v[84:87], v[200:207], v103
    ds_read_b64_tr_b16 v[108:109], v11 offset:32768
    ds_read_b64_tr_b16 v[110:111], v11 offset:33280
    v_lshlrev_b32 v117, 2, v117
    v_add_u32 v126, 147456, v117
    s_waitcnt lgkmcnt(2)
    v_mfma_f32_32x32x16_bf16 v[32:47], v[28:31], v[200:203], v[32:47]
    s_add_u32 m0, s51, 24576
    s_lshl4_add_u32 s62, s7, s53
    buffer_load_dwordx4 v2, s[8:11], s62 offen lds
    s_waitcnt vmcnt(5)
    s_barrier
    s_cmp_lg_u32 s50, 1
    s_cbranch_scc1 L_ini_10
    s_cmp_ge_u32 s2, 8
    s_cbranch_scc1 L_ini_10
    v_mov_b32 v104, 1
    s_mov_b64 exec, 1
    buffer_atomic_add v104, off, s[36:39], 0
    s_mov_b64 exec, -1
L_ini_10:
    v_add_u32 v12, 57344, v12
    v_add_u32 v13, 57344, v13
    v_add_u32 v14, 57344, v14
    v_add_u32 v15, 57344, v15
    ds_read_b128 v[144:147], v12 offset:8192
    ds_read_b128 v[148:151], v13 offset:8192
    ds_read_b128 v[152:155], v14 offset:8192
    ds_read_b128 v[156:159], v15 offset:8192
    v_add_u32 v8, 57344, v8
    v_add_u32 v9, 57344, v9
    v_add_u32 v10, 57344, v10
    v_add_u32 v11, 57344, v11
    ds_read_b64_tr_b16 v[16:17], v8 offset:0
    ds_read_b64_tr_b16 v[18:19], v8 offset:512
    s_mul_i32 s73, s75, 589824
    s_add_u32 s72, s73, 2048
    s_lshr_b32 s76, s52, 1
    s_lshl_b32 s80, s76, 7
    s_lshl_b32 s78, s54, 5
    s_add_u32 s78, s78, s72
    s_waitcnt lgkmcnt(6)
    v_mfma_f32_32x32x16_bf16 v[32:47], v[108:111], v[204:207], v[32:47]
    s_add_u32 m0, s51, 32768
    s_lshl4_add_u32 s62, s7, s69
    buffer_load_dwordx4 v2, s[8:11], s62 offen lds
    ds_read_b64_tr_b16 v[24:25], v9 offset:0
    ds_read_b64_tr_b16 v[26:27], v9 offset:512
    s_add_u32 s55, s54, 128
    s_lshl_b32 s56, s35, 1
    s_mov_b32 s57, s80
    s_mov_b32 s58, s78
    s_add_u32 s59, s78, 4096
    s_lshl_b32 s60, s35, 6
    s_add_u32 s60, s60, s73
    s_waitcnt lgkmcnt(2)
    v_mfma_f32_32x32x16_bf16 v[32:47], v[16:19], v[144:147], v[32:47]
    s_setprio 1
    s_add_u32 m0, s51, 40960
    s_mul_i32 s62, s32, 28672
    s_add_u32 s62, s62, s54
    buffer_load_dwordx4 v4, s[16:19], s62 offen lds
    ds_read_b64_tr_b16 v[28:29], v10 offset:0
    ds_read_b64_tr_b16 v[30:31], v10 offset:512
    s_add_u32 s60, s60, 1024
    s_lshl_b32 s61, s76, 12
    s_add_u32 s61, s61, s72
    s_add_u32 s61, s61, 114688
    v_bfe_u32 v117, v0, 2, 6
    s_waitcnt lgkmcnt(2)
    v_mfma_f32_32x32x16_bf16 v[32:47], v[24:27], v[148:151], v[32:47]
    s_add_u32 m0, s51, 49152
    s_lshl4_add_u32 s62, s32, s53
    buffer_load_dwordx4 v2, s[8:11], s62 offen lds
    v_smfmac_f32_16x16x64_bf16 v[88:91], v[84:87], v[144:151], v103
    v_smfmac_f32_16x16x64_bf16 v[88:91], v[84:87], v[152:159], v103
    ds_read_b64_tr_b16 v[108:109], v11 offset:0
    ds_read_b64_tr_b16 v[110:111], v11 offset:512
    v_and_b32 v118, 3, v0
    v_lshlrev_b32 v118, 4, v118
    s_movk_i32 s80, 3584
    v_mad_u32_u24 v5, v117, s80, v118
    s_waitcnt lgkmcnt(2)
    v_mfma_f32_32x32x16_bf16 v[32:47], v[28:31], v[152:155], v[32:47]
    s_add_u32 m0, s51, 57344
    s_lshl4_add_u32 s62, s32, s69
    buffer_load_dwordx4 v2, s[8:11], s62 offen lds
    s_waitcnt vmcnt(6)
    s_barrier
    v_subrev_u32 v12, 114688, v12
    v_subrev_u32 v13, 114688, v13
    v_subrev_u32 v14, 114688, v14
    v_subrev_u32 v15, 114688, v15
    ds_read_b128 v[208:211], v12 offset:0
    ds_read_b128 v[212:215], v13 offset:0
    ds_read_b128 v[216:219], v14 offset:0
    ds_read_b128 v[220:223], v15 offset:0
    ds_read_b64_tr_b16 v[20:21], v8 offset:24576
    ds_read_b64_tr_b16 v[22:23], v8 offset:25088
    buffer_load_ushort v92, v116, s[40:43], s54 offen offset:64
    s_waitcnt lgkmcnt(6)
    v_mfma_f32_32x32x16_bf16 v[32:47], v[108:111], v[156:159], v[32:47]
    s_add_u32 m0, s51, 73728
    s_lshl4_add_u32 s62, s33, s53
    buffer_load_dwordx4 v2, s[8:11], s62 offen lds
    ds_read_b64_tr_b16 v[24:25], v9 offset:24576
    ds_read_b64_tr_b16 v[26:27], v9 offset:25088
    buffer_load_ushort v93, v116, s[40:43], s55 offen offset:64
    v_xor_b32 v116, 32, v116
    buffer_load_ushort v94, v116, s[40:43], s56 offen offset:0
    s_waitcnt lgkmcnt(2)
    v_mfma_f32_32x32x16_bf16 v[32:47], v[20:23], v[208:211], v[32:47]
    v_smfmac_f32_16x16x64_bf16 v[80:83], v[84:87], v[16:23], v103
    s_setprio 0
    s_add_u32 m0, s51, 81920
    s_lshl4_add_u32 s62, s33, s69
    buffer_load_dwordx4 v2, s[8:11], s62 offen lds
    ds_read_b64_tr_b16 v[28:29], v10 offset:24576
    ds_read_b64_tr_b16 v[30:31], v10 offset:25088
    s_mov_b32 s64, 0x3fb8aa3b
    s_mov_b32 s65, 0x358637bd
    s_mov_b32 s48, 0x0000ffff
    s_mov_b32 s49, 0x0000ffff
    s_waitcnt lgkmcnt(2)
    v_mfma_f32_32x32x16_bf16 v[32:47], v[24:27], v[212:215], v[32:47]
    s_add_u32 m0, s51, 65536
    s_mul_i32 s62, s33, 28672
    s_add_u32 s62, s62, s54
    buffer_load_dwordx4 v4, s[16:19], s62 offen lds
    v_smfmac_f32_16x16x64_bf16 v[88:91], v[84:87], v[208:215], v103
    v_smfmac_f32_16x16x64_bf16 v[88:91], v[84:87], v[216:223], v103
    ds_read_b64_tr_b16 v[108:109], v11 offset:24576
    ds_read_b64_tr_b16 v[110:111], v11 offset:25088
    s_mul_i32 s79, s77, 147456
    v_lshlrev_b32 v7, 4, v1
    v_add_u32 v7, s79, v7
    s_lshr_b32 s79, s66, 1
    s_lshl_b32 s79, s79, 11
    s_add_u32 s79, s79, 10486912
    s_add_u32 s44, s28, s79
    s_addc_u32 s45, s29, 0
    s_lshl_b32 s68, s75, 11
    s_lshl2_add_u32 s68, s76, s68
    s_add_u32 s68, s68, 10486912
    s_lshl_b32 s79, s66, 1
    s_add_u32 s79, s79, 1
    s_mul_i32 s79, s79, 147456
    s_mul_i32 s70, s77, 28672
    s_add_u32 s70, s70, s79
    s_lshl_b32 s74, s77, 13
    s_add_u32 s74, s74, s79
    s_add_u32 s74, s74, 114688
    s_waitcnt lgkmcnt(2)
    v_mfma_f32_32x32x16_bf16 v[32:47], v[28:31], v[216:219], v[32:47]
    s_add_u32 m0, s51, 98304
    s_lshl4_add_u32 s62, s34, s53
    buffer_load_dwordx4 v2, s[8:11], s62 offen lds
    s_waitcnt vmcnt(10)
    s_barrier
    ds_read_b128 v[160:163], v12 offset:24576
    ds_read_b128 v[164:167], v13 offset:24576
    ds_read_b128 v[168:171], v14 offset:24576
    ds_read_b128 v[172:175], v15 offset:24576
    v_subrev_u32 v8, 114688, v8
    v_subrev_u32 v9, 114688, v9
    v_subrev_u32 v10, 114688, v10
    v_subrev_u32 v11, 114688, v11
    ds_read_b64_tr_b16 v[16:17], v8 offset:16384
    ds_read_b64_tr_b16 v[18:19], v8 offset:16896
    s_waitcnt lgkmcnt(6)
    v_mfma_f32_32x32x16_bf16 v[32:47], v[108:111], v[220:223], v[32:47]
    s_add_u32 m0, s51, 106496
    s_lshl4_add_u32 s62, s34, s69
    buffer_load_dwordx4 v2, s[8:11], s62 offen lds
    ds_read_b64_tr_b16 v[24:25], v9 offset:16384
    ds_read_b64_tr_b16 v[26:27], v9 offset:16896
    s_waitcnt lgkmcnt(2)
    v_mfma_f32_32x32x16_bf16 v[32:47], v[16:19], v[160:163], v[32:47]
    s_setprio 1
    s_add_u32 m0, s51, 90112
    s_mul_i32 s62, s34, 28672
    s_add_u32 s62, s62, s54
    buffer_load_dwordx4 v4, s[16:19], s62 offen lds
    ds_read_b64_tr_b16 v[28:29], v10 offset:16384
    ds_read_b64_tr_b16 v[30:31], v10 offset:16896
    s_waitcnt lgkmcnt(2)
    v_mfma_f32_32x32x16_bf16 v[32:47], v[24:27], v[164:167], v[32:47]
    s_add_u32 m0, s51, 122880
    s_mul_i32 s62, s4, 24576
    s_add_u32 s62, s62, s57
    buffer_load_dwordx4 v3, s[12:15], s62 offen lds
    v_smfmac_f32_16x16x64_bf16 v[88:91], v[84:87], v[160:167], v103
    v_smfmac_f32_16x16x64_bf16 v[88:91], v[84:87], v[168:175], v103
    ds_read_b64_tr_b16 v[108:109], v11 offset:16384
    ds_read_b64_tr_b16 v[110:111], v11 offset:16896
    s_waitcnt lgkmcnt(2)
    v_mfma_f32_32x32x16_bf16 v[32:47], v[28:31], v[168:171], v[32:47]
    s_add_u32 m0, s51, 131072
    s_mul_i32 s62, s5, 24576
    s_add_u32 s62, s62, s57
    buffer_load_dwordx4 v3, s[12:15], s62 offen lds
    s_waitcnt vmcnt(11)
    s_barrier
    ds_read_b128 v[224:227], v12 offset:49152
    ds_read_b128 v[228:231], v13 offset:49152
    ds_read_b128 v[232:235], v14 offset:49152
    ds_read_b128 v[236:239], v15 offset:49152
    ds_read_b64_tr_b16 v[20:21], v8 offset:40960
    ds_read_b64_tr_b16 v[22:23], v8 offset:41472
    s_waitcnt lgkmcnt(6)
    v_mfma_f32_32x32x16_bf16 v[32:47], v[108:111], v[172:175], v[32:47]
    s_add_u32 m0, s51, 114688
    s_mul_i32 s62, s3, 24576
    s_add_u32 s62, s62, s57
    buffer_load_dwordx4 v3, s[12:15], s62 offen lds
    ds_read_b64_tr_b16 v[24:25], v9 offset:40960
    ds_read_b64_tr_b16 v[26:27], v9 offset:41472
    s_waitcnt lgkmcnt(2)
    v_mfma_f32_32x32x16_bf16 v[32:47], v[20:23], v[224:227], v[32:47]
    v_smfmac_f32_16x16x64_bf16 v[80:83], v[84:87], v[16:23], v103
    s_setprio 0
    s_add_u32 m0, s51, 0
    s_mul_i32 s62, s7, 24576
    s_add_u32 s62, s62, s57
    buffer_load_dwordx4 v3, s[12:15], s62 offen lds
    ds_read_b64_tr_b16 v[28:29], v10 offset:40960
    ds_read_b64_tr_b16 v[30:31], v10 offset:41472
    s_waitcnt lgkmcnt(2)
    v_mfma_f32_32x32x16_bf16 v[32:47], v[24:27], v[228:231], v[32:47]
    s_add_u32 m0, s51, 8192
    s_mul_i32 s62, s32, 24576
    s_add_u32 s62, s62, s57
    buffer_load_dwordx4 v3, s[12:15], s62 offen lds
    v_smfmac_f32_16x16x64_bf16 v[88:91], v[84:87], v[224:231], v103
    v_smfmac_f32_16x16x64_bf16 v[88:91], v[84:87], v[232:239], v103
    s_and_b32 s72, s50, 3
    s_lshl_b32 s72, s72, 11
    s_add_u32 s72, s72, 155648
    v_lshlrev_b32 v2, 2, v1
    v_add_u32 v2, s72, v2
    ds_read_b64_tr_b16 v[108:109], v11 offset:40960
    ds_read_b64_tr_b16 v[110:111], v11 offset:41472
    s_waitcnt lgkmcnt(2)
    v_mfma_f32_32x32x16_bf16 v[32:47], v[28:31], v[232:235], v[32:47]
    s_add_u32 m0, s51, 139264
    s_mul_i32 s62, s6, 24576
    s_add_u32 s62, s62, s57
    buffer_load_dwordx4 v3, s[12:15], s62 offen lds
    s_waitcnt vmcnt(9)
    s_barrier
    s_cmp_lg_u32 s50, 0
    s_cbranch_scc1 L_ip_11
    buffer_load_dword v107, off, s[36:39], 0 sc1
L_ip_11:
    v_add_u32 v12, 57344, v12
    v_add_u32 v13, 57344, v13
    v_add_u32 v14, 57344, v14
    v_add_u32 v15, 57344, v15
    ds_read_b128 v[176:179], v12 offset:16384
    ds_read_b128 v[180:183], v13 offset:16384
    ds_read_b128 v[184:187], v14 offset:16384
    ds_read_b128 v[188:191], v15 offset:16384
    v_add_u32 v8, 57344, v8
    v_add_u32 v9, 57344, v9
    v_add_u32 v10, 57344, v10
    v_add_u32 v11, 57344, v11
    ds_read_b64_tr_b16 v[16:17], v8 offset:8192
    ds_read_b64_tr_b16 v[18:19], v8 offset:8704
    s_waitcnt lgkmcnt(6)
    v_mfma_f32_32x32x16_bf16 v[32:47], v[108:111], v[236:239], v[32:47]
    s_add_u32 m0, s51, 24576
    s_mul_i32 s62, s34, 24576
    s_add_u32 s62, s62, s57
    buffer_load_dwordx4 v3, s[12:15], s62 offen lds
    ds_read_b64_tr_b16 v[24:25], v9 offset:8192
    ds_read_b64_tr_b16 v[26:27], v9 offset:8704
    s_waitcnt lgkmcnt(2)
    v_mfma_f32_32x32x16_bf16 v[32:47], v[16:19], v[176:179], v[32:47]
    s_setprio 1
    s_add_u32 m0, s51, 16384
    s_mul_i32 s62, s33, 24576
    s_add_u32 s62, s62, s57
    buffer_load_dwordx4 v3, s[12:15], s62 offen lds
    ds_read_b64_tr_b16 v[28:29], v10 offset:8192
    ds_read_b64_tr_b16 v[30:31], v10 offset:8704
    s_waitcnt lgkmcnt(2)
    v_mfma_f32_32x32x16_bf16 v[32:47], v[24:27], v[180:183], v[32:47]
    s_add_u32 m0, s51, 49152
    s_mul_i32 s62, s3, 28672
    s_add_u32 s62, s62, s55
    buffer_load_dwordx4 v4, s[16:19], s62 offen lds
    v_smfmac_f32_16x16x64_bf16 v[88:91], v[84:87], v[176:183], v103
    v_smfmac_f32_16x16x64_bf16 v[88:91], v[84:87], v[184:191], v103
    ds_read_b64_tr_b16 v[108:109], v11 offset:8192
    ds_read_b64_tr_b16 v[110:111], v11 offset:8704
    s_waitcnt lgkmcnt(2)
    v_mfma_f32_32x32x16_bf16 v[32:47], v[28:31], v[184:187], v[32:47]
    s_add_u32 m0, s51, 57344
    s_mul_i32 s62, s4, 28672
    s_add_u32 s62, s62, s55
    buffer_load_dwordx4 v4, s[16:19], s62 offen lds
    s_waitcnt vmcnt(10)
    s_barrier
    ds_read_b128 v[240:243], v12 offset:40960
    ds_read_b128 v[244:247], v13 offset:40960
    ds_read_b128 v[248:251], v14 offset:40960
    ds_read_b128 v[252:255], v15 offset:40960
    ds_read_b64_tr_b16 v[20:21], v8 offset:32768
    ds_read_b64_tr_b16 v[22:23], v8 offset:33280
    s_waitcnt lgkmcnt(6)
    v_mfma_f32_32x32x16_bf16 v[32:47], v[108:111], v[188:191], v[32:47]
    s_add_u32 m0, s51, 73728
    s_mul_i32 s62, s6, 28672
    s_add_u32 s62, s62, s55
    buffer_load_dwordx4 v4, s[16:19], s62 offen lds
    s_waitcnt lgkmcnt(2)
    v_smfmac_f32_16x16x64_bf16 v[88:91], v[84:87], v[240:247], v103
    v_smfmac_f32_16x16x64_bf16 v[88:91], v[84:87], v[248:255], v103
    ds_read_b64_tr_b16 v[24:25], v9 offset:32768
    ds_read_b64_tr_b16 v[26:27], v9 offset:33280
    s_waitcnt lgkmcnt(2)
    v_mfma_f32_32x32x16_bf16 v[32:47], v[20:23], v[240:243], v[32:47]
    v_smfmac_f32_16x16x64_bf16 v[80:83], v[84:87], v[16:23], v103
    s_setprio 0
    s_add_u32 m0, s51, 81920
    s_mul_i32 s62, s7, 28672
    s_add_u32 s62, s62, s55
    buffer_load_dwordx4 v4, s[16:19], s62 offen lds
    ds_read_b64_tr_b16 v[28:29], v10 offset:32768
    ds_read_b64_tr_b16 v[30:31], v10 offset:33280
    s_waitcnt lgkmcnt(2)
    v_mfma_f32_32x32x16_bf16 v[32:47], v[24:27], v[244:247], v[32:47]
    v_add_f32 v124, v124, v125
    v_add_f32 v88, v88, v89
    v_lshlrev_b32 v125, 2, v0
    v_add_u32 v125, 147456, v125
    ds_write2st64_b32 v125, v124, v88 offset0:0 offset1:16
    v_and_b32 v124, 0xdf, v0
    v_lshlrev_b32 v124, 2, v124
    v_add_u32 v125, 147584, v124
    v_add_u32 v124, 147456, v124
    ds_read_b64_tr_b16 v[108:109], v11 offset:32768
    ds_read_b64_tr_b16 v[110:111], v11 offset:33280
    s_waitcnt lgkmcnt(3)
    v_mfma_f32_32x32x16_bf16 v[32:47], v[28:31], v[248:251], v[32:47]
    v_add_f32 v82, v80, v81
    ds_write_b32 v2, v82 offset:256
    v_mov_b32 v80, 0
    v_mov_b32 v81, 0
    s_waitcnt vmcnt(9) lgkmcnt(0)
    s_barrier
    v_add_u32 v8, 57344, v8
    v_add_u32 v9, 57344, v9
    v_add_u32 v10, 57344, v10
    v_add_u32 v11, 57344, v11
    ds_read_b64_tr_b16 v[16:17], v8 offset:0
    ds_read_b64_tr_b16 v[18:19], v8 offset:512
    v_mfma_f32_32x32x16_bf16 v[32:47], v[108:111], v[252:255], v[32:47]
    s_add_u32 m0, s51, 65536
    s_mul_i32 s62, s5, 28672
    s_add_u32 s62, s62, s55
    buffer_load_dwordx4 v4, s[16:19], s62 offen lds
    v_lshrrev_b32 v112, 5, v1
    v_lshlrev_b32 v112, 9, v112
    v_bfe_u32 v113, v1, 2, 2
    v_lshl_add_u32 v112, v113, 6, v112
    v_bfe_u32 v113, v1, 4, 1
    v_lshl_add_u32 v112, v113, 5, v112
    v_and_b32 v113, 3, v1
    v_lshl_add_u32 v112, v113, 3, v112
    v_xor_b32 v112, 32, v112
    s_and_b32 s72, s50, 3
    s_xor_b32 s73, s72, 0
    s_lshl_b32 s73, s73, 10
    v_add_u32 v12, s73, v112
    s_xor_b32 s73, s72, 1
    s_lshl_b32 s73, s73, 10
    v_add_u32 v13, s73, v112
    s_xor_b32 s73, s72, 2
    s_lshl_b32 s73, s73, 10
    v_add_u32 v14, s73, v112
    s_xor_b32 s73, s72, 3
    s_lshl_b32 s73, s73, 10
    v_add_u32 v15, s73, v112
    ds_read_b64_tr_b16 v[24:25], v9 offset:0
    ds_read_b64_tr_b16 v[26:27], v9 offset:512
    ds_read2st64_b32 v[112:113], v124 offset0:16 offset1:20
    ds_read2st64_b32 v[116:117], v124 offset0:0 offset1:4
    ds_read2st64_b32 v[118:119], v125 offset0:0 offset1:4
    v_mov_b32 v99, 0
    v_cmp_gt_u32 vcc, 32, v1
    s_waitcnt lgkmcnt(0)
    v_add_f32 v116, v116, v118
    v_add_f32 v117, v117, v119
    v_add_f32 v112, v112, v113
    v_mfma_f32_32x32x16_bf16 v[48:63], v[16:19], v[128:131], 0
    s_setprio 1
    ds_read_b64_tr_b16 v[28:29], v10 offset:0
    ds_read_b64_tr_b16 v[30:31], v10 offset:512
    v_add_f32 v116, v116, v117
    v_mul_f32 v112, 0xbb000000, v112
    v_mul_f32 v116, 0x3b000000, v116
    v_fma_f32 v116, -v112, v112, v116
    v_and_b32 v113, 0xffff0000, v112
    v_max_f32 v116, 0, v116
    v_sub_f32 v112, v112, v113
    v_add_f32 v116, 0x3727c5ac, v116
    v_mfma_f32_32x32x16_bf16 v[48:63], v[24:27], v[132:135], v[48:63]
    s_add_u32 m0, s51, 98304
    s_mul_i32 s62, s33, 28672
    s_add_u32 s62, s62, s55
    buffer_load_dwordx4 v4, s[16:19], s62 offen lds
    s_lshr_b32 s73, s2, 6
    s_add_u32 s73, s73, s67
    s_and_b32 s73, s73, 3
    s_lshl_b32 s73, s73, 2
    s_lshr_b32 s73, 0x60416041, s73
    s_bfe_u32 s75, s73, 0x40000
    s_lshl_b32 s75, s75, 12
    s_bfe_u32 s63, s73, 0x40004
    s_lshl_b32 s63, s63, 12
    s_bfe_u32 s54, s73, 0x40008
    s_lshl_b32 s54, s54, 12
    s_bfe_u32 s53, s73, 0x4000c
    s_lshl_b32 s53, s53, 12
    ds_read_b64_tr_b16 v[108:109], v11 offset:0
    ds_read_b64_tr_b16 v[110:111], v11 offset:512
    v_cvt_pk_bf16_f32 v96, v113, v113
    v_rsq_f32 v120, v116
    v_sqrt_f32 v121, v116
    v_cndmask_b32 v96, 0, v96, vcc
    v_mul_f32 v116, v120, v120
    v_and_b32 v114, 0xffff0000, v121
    s_waitcnt lgkmcnt(2)
    v_mfma_f32_32x32x16_bf16 v[48:63], v[28:31], v[136:139], v[48:63]
    ds_read_b64_tr_b16 v[20:21], v8 offset:8192
    ds_read_b64_tr_b16 v[22:23], v8 offset:8704
    v_mul_f32 v122, 0xc0135761, v120
    v_sub_f32 v115, v121, v114
    v_cvt_pk_bf16_f32 v97, v112, v114
    v_mul_f32 v123, v122, v116
    v_cvt_pk_bf16_f32 v98, v115, v99
    v_mul_f32 v123, 0x3d372713, v123
    v_cndmask_b32 v97, 0, v97, vcc
    v_cndmask_b32 v98, 0, v98, vcc
    ds_read2st64_b32 v[88:89], v126 offset0:33 offset1:41
    ds_read2st64_b32 v[90:91], v126 offset0:49 offset1:57
    s_waitcnt lgkmcnt(4)
    v_mfma_f32_32x32x16_bf16 v[48:63], v[108:111], v[140:143], v[48:63]
    s_add_u32 m0, s51, 106496
    s_mul_i32 s62, s34, 28672
    s_add_u32 s62, s62, s55
    buffer_load_dwordx4 v4, s[16:19], s62 offen lds
    ds_read_b64_tr_b16 v[24:25], v9 offset:8192
    ds_read_b64_tr_b16 v[26:27], v9 offset:8704
    v_mov_b32 v102, v92
    v_lshlrev_b32 v113, 16, v92
    s_waitcnt lgkmcnt(2)
    v_add_f32 v88, v88, v89
    v_add_f32 v90, v90, v91
    v_mfma_f32_32x32x16_bf16 v[48:63], v[20:23], v[192:195], v[48:63]
    v_smfmac_f32_16x16x64_bf16 v[80:83], v[84:87], v[16:23], v103
    s_setprio 0
    ds_read_b64_tr_b16 v[28:29], v10 offset:8192
    ds_read_b64_tr_b16 v[30:31], v10 offset:8704
    v_add_f32 v88, v88, v90
    v_and_b32 v112, 0xffff0000, v88
    v_sub_f32 v88, v88, v112
    v_cvt_pk_bf16_f32 v101, v112, v113
    v_cvt_pk_bf16_f32 v100, v112, v88
    s_nop 1
    v_mfma_f32_32x32x16_bf16 v[32:47], v[100:103], v[96:99], v[32:47]
    s_waitcnt lgkmcnt(2)
    v_mfma_f32_32x32x16_bf16 v[48:63], v[24:27], v[196:199], v[48:63]
    ds_read_b64_tr_b16 v[108:109], v11 offset:8192
    ds_read_b64_tr_b16 v[110:111], v11 offset:8704
    s_waitcnt lgkmcnt(2)
    v_mfma_f32_32x32x16_bf16 v[48:63], v[28:31], v[200:203], v[48:63]
    s_cmp_lg_u32 s50, 0
    s_cbranch_scc1 L_ic_12
    s_mov_b32 s69, 0
    s_waitcnt vmcnt(9)
L_il_13:
    v_readfirstlane_b32 s72, v107
    s_nop 1
    s_cmp_ge_u32 s72, 8
    s_cbranch_scc1 L_ic_12
    s_add_u32 s69, s69, 1
    s_cmp_ge_u32 s69, 0x40000
    s_cbranch_scc1 L_ic_12
    buffer_load_dword v107, off, s[36:39], 0 sc1
    s_waitcnt vmcnt(0)
    s_branch L_il_13
L_ic_12:
    s_waitcnt vmcnt(9)
    s_barrier
    ds_read_b64_tr_b16 v[16:17], v8 offset:16384
    ds_read_b64_tr_b16 v[18:19], v8 offset:16896
    v_mul_f32 v116, v32, v32
    v_mul_f32 v117, v33, v33
    v_mul_f32 v118, v34, v34
    v_mul_f32 v119, v35, v35
    v_fma_f32 v116, v116, v123, v122
    v_fma_f32 v117, v117, v123, v122
    v_fma_f32 v118, v118, v123, v122
    s_waitcnt lgkmcnt(2)
    v_mfma_f32_32x32x16_bf16 v[48:63], v[108:111], v[204:207], v[48:63]
    s_add_u32 m0, s51, 90112
    s_mul_i32 s62, s32, 28672
    s_add_u32 s62, s62, s55
    buffer_load_dwordx4 v4, s[16:19], s62 offen lds
    ds_read_b64_tr_b16 v[24:25], v9 offset:16384
    ds_read_b64_tr_b16 v[26:27], v9 offset:16896
    v_fma_f32 v119, v119, v123, v122
    v_mul_f32 v116, v32, v116
    v_mul_f32 v117, v33, v117
    v_mul_f32 v118, v34, v118
    v_mul_f32 v119, v35, v119
    v_exp_f32 v116, v116
    s_waitcnt lgkmcnt(2)
    v_mfma_f32_32x32x16_bf16 v[48:63], v[16:19], v[144:147], v[48:63]
    s_setprio 1
    ds_read_b64_tr_b16 v[28:29], v10 offset:16384
    ds_read_b64_tr_b16 v[30:31], v10 offset:16896
    v_exp_f32 v117, v117
    v_exp_f32 v118, v118
    v_exp_f32 v119, v119
    v_fma_f32 v116, v116, v121, v121
    s_waitcnt lgkmcnt(2)
    v_mfma_f32_32x32x16_bf16 v[48:63], v[24:27], v[148:151], v[48:63]
    s_lshl3_add_u32 s35, s2, s50
    s_mul_i32 s62, s35, 896
    v_lshlrev_b32 v125, 6, v1
    s_mov_b64 exec, 0x3fff
    buffer_load_dword v92, v125, s[20:23], s62 offen sc1
    s_lshl_b32 s62, s35, 8
    v_add_u32 v125, s62, v125
    s_mov_b64 exec, 15
    global_load_dword v92, v125, s[24:25] sc1
    s_mov_b64 exec, -1
    ds_read_b64_tr_b16 v[108:109], v11 offset:16384
    ds_read_b64_tr_b16 v[110:111], v11 offset:16896
    v_fma_f32 v117, v117, v121, v121
    v_fma_f32 v118, v118, v121, v121
    v_fma_f32 v119, v119, v121, v121
    v_rcp_f32 v116, v116
    v_rcp_f32 v117, v117
    s_waitcnt lgkmcnt(2)
    v_mfma_f32_32x32x16_bf16 v[48:63], v[28:31], v[152:155], v[48:63]
    ds_read_b64_tr_b16 v[20:21], v8 offset:24576
    ds_read_b64_tr_b16 v[22:23], v8 offset:25088
    v_rcp_f32 v118, v118
    v_rcp_f32 v119, v119
    v_mul_f32 v112, v32, v116
    v_mul_f32 v113, v33, v117
    v_mul_f32 v114, v34, v118
    v_mul_f32 v115, v35, v119
    s_waitcnt lgkmcnt(2)
    v_mfma_f32_32x32x16_bf16 v[48:63], v[108:111], v[156:159], v[48:63]
    ds_read_b64_tr_b16 v[24:25], v9 offset:24576
    ds_read_b64_tr_b16 v[26:27], v9 offset:25088
    v_cvt_pk_bf16_f32 v104, v112, v113
    v_cvt_pk_bf16_f32 v105, v114, v115
    v_mul_f32 v116, v36, v36
    v_mul_f32 v117, v37, v37
    v_mul_f32 v118, v38, v38
    v_mul_f32 v119, v39, v39
    v_fma_f32 v116, v116, v123, v122
    v_fma_f32 v117, v117, v123, v122
    s_waitcnt lgkmcnt(2)
    v_mfma_f32_32x32x16_bf16 v[48:63], v[20:23], v[208:211], v[48:63]
    v_smfmac_f32_16x16x64_bf16 v[80:83], v[84:87], v[16:23], v103
    s_setprio 0
    ds_read_b64_tr_b16 v[28:29], v10 offset:24576
    ds_read_b64_tr_b16 v[30:31], v10 offset:25088
    v_fma_f32 v118, v118, v123, v122
    v_fma_f32 v119, v119, v123, v122
    v_mul_f32 v116, v36, v116
    v_mul_f32 v117, v37, v117
    v_mul_f32 v118, v38, v118
    v_mul_f32 v119, v39, v119
    v_exp_f32 v116, v116
    s_waitcnt lgkmcnt(2)
    v_mfma_f32_32x32x16_bf16 v[48:63], v[24:27], v[212:215], v[48:63]
    ds_read_b64_tr_b16 v[108:109], v11 offset:24576
    ds_read_b64_tr_b16 v[110:111], v11 offset:25088
    v_exp_f32 v117, v117
    v_exp_f32 v118, v118
    v_exp_f32 v119, v119
    v_fma_f32 v116, v116, v121, v121
    s_waitcnt lgkmcnt(2)
    v_mfma_f32_32x32x16_bf16 v[48:63], v[28:31], v[216:219], v[48:63]
    s_barrier
    v_subrev_u32 v8, 114688, v8
    v_subrev_u32 v9, 114688, v9
    v_subrev_u32 v10, 114688, v10
    v_subrev_u32 v11, 114688, v11
    ds_read_b64_tr_b16 v[16:17], v8 offset:0
    ds_read_b64_tr_b16 v[18:19], v8 offset:512
    v_fma_f32 v117, v117, v121, v121
    v_fma_f32 v118, v118, v121, v121
    v_fma_f32 v119, v119, v121, v121
    v_rcp_f32 v116, v116
    v_rcp_f32 v117, v117
    s_waitcnt lgkmcnt(2)
    v_mfma_f32_32x32x16_bf16 v[48:63], v[108:111], v[220:223], v[48:63]
    s_add_u32 m0, s51, 114688
    s_mul_i32 s62, s5, 28672
    s_add_u32 s62, s62, s56
    buffer_load_dwordx4 v5, s[16:19], s62 offen lds
    ds_read_b64_tr_b16 v[24:25], v9 offset:0
    ds_read_b64_tr_b16 v[26:27], v9 offset:512
    v_rcp_f32 v118, v118
    v_rcp_f32 v119, v119
    v_mul_f32 v112, v36, v116
    v_mul_f32 v113, v37, v117
    v_mul_f32 v114, v38, v118
    s_waitcnt lgkmcnt(2)
    v_mfma_f32_32x32x16_bf16 v[48:63], v[16:19], v[160:163], v[48:63]
    s_setprio 1
    ds_read_b64_tr_b16 v[28:29], v10 offset:0
    ds_read_b64_tr_b16 v[30:31], v10 offset:512
    v_mul_f32 v115, v39, v119
    v_cvt_pk_bf16_f32 v106, v112, v113
    v_cvt_pk_bf16_f32 v107, v114, v115
    buffer_store_dwordx4 v[104:107], v7, s[28:31], s58 offen offset:0 sc1
    v_mul_f32 v116, v40, v40
    v_mul_f32 v117, v41, v41
    s_waitcnt lgkmcnt(2)
    v_mfma_f32_32x32x16_bf16 v[48:63], v[24:27], v[164:167], v[48:63]
    s_add_u32 m0, s51, 122880
    s_mul_i32 s62, s6, 28672
    s_add_u32 s62, s62, s56
    buffer_load_dwordx4 v5, s[16:19], s62 offen lds
    ds_read_b64_tr_b16 v[108:109], v11 offset:0
    ds_read_b64_tr_b16 v[110:111], v11 offset:512
    v_mul_f32 v118, v42, v42
    v_mul_f32 v119, v43, v43
    v_fma_f32 v116, v116, v123, v122
    v_fma_f32 v117, v117, v123, v122
    v_fma_f32 v118, v118, v123, v122
    v_fma_f32 v119, v119, v123, v122
    s_waitcnt lgkmcnt(2)
    v_mfma_f32_32x32x16_bf16 v[48:63], v[28:31], v[168:171], v[48:63]
    ds_read_b64_tr_b16 v[20:21], v8 offset:8192
    ds_read_b64_tr_b16 v[22:23], v8 offset:8704
    v_mul_f32 v116, v40, v116
    v_mul_f32 v117, v41, v117
    v_mul_f32 v118, v42, v118
    v_mul_f32 v119, v43, v119
    v_exp_f32 v116, v116
    v_exp_f32 v117, v117
    s_waitcnt lgkmcnt(2)
    v_mfma_f32_32x32x16_bf16 v[48:63], v[108:111], v[172:175], v[48:63]
    ds_read_b64_tr_b16 v[24:25], v9 offset:8192
    ds_read_b64_tr_b16 v[26:27], v9 offset:8704
    v_exp_f32 v118, v118
    v_exp_f32 v119, v119
    v_fma_f32 v116, v116, v121, v121
    v_fma_f32 v117, v117, v121, v121
    v_fma_f32 v118, v118, v121, v121
    s_waitcnt lgkmcnt(2)
    v_mfma_f32_32x32x16_bf16 v[48:63], v[20:23], v[224:227], v[48:63]
    v_smfmac_f32_16x16x64_bf16 v[80:83], v[84:87], v[16:23], v103
    s_setprio 0
    ds_read_b64_tr_b16 v[28:29], v10 offset:8192
    ds_read_b64_tr_b16 v[30:31], v10 offset:8704
    v_fma_f32 v119, v119, v121, v121
    v_rcp_f32 v116, v116
    v_rcp_f32 v117, v117
    v_rcp_f32 v118, v118
    v_rcp_f32 v119, v119
    s_waitcnt lgkmcnt(2)
    v_mfma_f32_32x32x16_bf16 v[48:63], v[24:27], v[228:231], v[48:63]
    ds_read_b64_tr_b16 v[108:109], v11 offset:8192
    ds_read_b64_tr_b16 v[110:111], v11 offset:8704
    v_mul_f32 v112, v40, v116
    v_mul_f32 v113, v41, v117
    v_mul_f32 v114, v42, v118
    v_mul_f32 v115, v43, v119
    v_cvt_pk_bf16_f32 v104, v112, v113
    v_cvt_pk_bf16_f32 v105, v114, v115
    v_mul_f32 v116, v44, v44
    v_mul_f32 v117, v45, v45
    s_waitcnt lgkmcnt(2)
    v_mfma_f32_32x32x16_bf16 v[48:63], v[28:31], v[232:235], v[48:63]
    s_waitcnt vmcnt(13)
    s_barrier
    ds_read_b64_tr_b16 v[16:17], v8 offset:16384
    ds_read_b64_tr_b16 v[18:19], v8 offset:16896
    v_mul_f32 v118, v46, v46
    v_mul_f32 v119, v47, v47
    v_fma_f32 v116, v116, v123, v122
    v_fma_f32 v117, v117, v123, v122
    v_fma_f32 v118, v118, v123, v122
    v_fma_f32 v119, v119, v123, v122
    s_waitcnt lgkmcnt(2)
    v_mfma_f32_32x32x16_bf16 v[48:63], v[108:111], v[236:239], v[48:63]
    s_add_u32 m0, s51, 131072
    s_mul_i32 s62, s33, 28672
    s_add_u32 s62, s62, s56
    buffer_load_dwordx4 v5, s[16:19], s62 offen lds
    ds_read_b64_tr_b16 v[24:25], v9 offset:16384
    ds_read_b64_tr_b16 v[26:27], v9 offset:16896
    v_mul_f32 v116, v44, v116
    v_mul_f32 v117, v45, v117
    v_mul_f32 v118, v46, v118
    v_mul_f32 v119, v47, v119
    v_exp_f32 v116, v116
    v_exp_f32 v117, v117
    s_waitcnt lgkmcnt(2)
    v_mfma_f32_32x32x16_bf16 v[48:63], v[16:19], v[176:179], v[48:63]
    s_setprio 1
    ds_read_b64_tr_b16 v[28:29], v10 offset:16384
    ds_read_b64_tr_b16 v[30:31], v10 offset:16896
    v_exp_f32 v118, v118
    v_exp_f32 v119, v119
    v_fma_f32 v116, v116, v121, v121
    v_fma_f32 v117, v117, v121, v121
    v_fma_f32 v118, v118, v121, v121
    s_waitcnt lgkmcnt(2)
    v_mfma_f32_32x32x16_bf16 v[48:63], v[24:27], v[180:183], v[48:63]
    s_add_u32 m0, s51, 139264
    s_mul_i32 s62, s34, 28672
    s_add_u32 s62, s62, s56
    buffer_load_dwordx4 v5, s[16:19], s62 offen lds
    ds_read_b64_tr_b16 v[108:109], v11 offset:16384
    ds_read_b64_tr_b16 v[110:111], v11 offset:16896
    v_fma_f32 v119, v119, v121, v121
    v_rcp_f32 v116, v116
    v_rcp_f32 v117, v117
    v_rcp_f32 v118, v118
    v_rcp_f32 v119, v119
    s_waitcnt lgkmcnt(2)
    v_mfma_f32_32x32x16_bf16 v[48:63], v[28:31], v[184:187], v[48:63]
    ds_read_b64_tr_b16 v[20:21], v8 offset:24576
    ds_read_b64_tr_b16 v[22:23], v8 offset:25088
    v_mul_f32 v112, v44, v116
    v_mul_f32 v113, v45, v117
    v_mul_f32 v114, v46, v118
    v_mul_f32 v115, v47, v119
    v_cvt_pk_bf16_f32 v106, v112, v113
    v_cvt_pk_bf16_f32 v107, v114, v115
    buffer_store_dwordx4 v[104:107], v7, s[28:31], s58 offen offset:1024 sc1
    s_waitcnt lgkmcnt(2)
    v_mfma_f32_32x32x16_bf16 v[48:63], v[108:111], v[188:191], v[48:63]
    s_add_u32 m0, s51, 32768
    s_lshl4_add_u32 s62, s63, 0
    buffer_load_dwordx4 v6, s[20:23], s62 offen lds
    ds_read_b64_tr_b16 v[24:25], v9 offset:24576
    ds_read_b64_tr_b16 v[26:27], v9 offset:25088
    s_waitcnt lgkmcnt(2)
    v_mfma_f32_32x32x16_bf16 v[48:63], v[20:23], v[240:243], v[48:63]
    v_smfmac_f32_16x16x64_bf16 v[80:83], v[84:87], v[16:23], v103
    s_setprio 0
    ds_read_b64_tr_b16 v[28:29], v10 offset:24576
    ds_read_b64_tr_b16 v[30:31], v10 offset:25088
    s_waitcnt lgkmcnt(2)
    v_mfma_f32_32x32x16_bf16 v[48:63], v[24:27], v[244:247], v[48:63]
    s_add_u32 m0, s51, 40960
    s_lshl4_add_u32 s62, s63, 458752
    buffer_load_dwordx4 v6, s[20:23], s62 offen lds
    ds_read_b64_tr_b16 v[108:109], v11 offset:24576
    ds_read_b64_tr_b16 v[110:111], v11 offset:25088
    s_waitcnt lgkmcnt(2)
    v_mfma_f32_32x32x16_bf16 v[48:63], v[28:31], v[248:251], v[48:63]
    v_add_f32 v82, v80, v81
    ds_write_b32 v2, v82 offset:1792
    v_mov_b32 v80, 0
    v_mov_b32 v81, 0
    s_waitcnt vmcnt(16) lgkmcnt(0)
    s_barrier
    ds_read_b64_tr_b16 v[16:17], v8 offset:49152
    ds_read_b64_tr_b16 v[18:19], v8 offset:49664
    v_mfma_f32_32x32x16_bf16 v[48:63], v[108:111], v[252:255], v[48:63]
    s_add_u32 m0, s51, 0
    s_lshl4_add_u32 s62, s75, 0
    buffer_load_dwordx4 v6, s[20:23], s62 offen lds
    ds_read_b64_tr_b16 v[24:25], v9 offset:49152
    ds_read_b64_tr_b16 v[26:27], v9 offset:49664
    v_mul_f32 v95, s64, v120
    v_mul_f32 v127, s65, v121
    ds_read2st64_b32 v[88:89], v126 offset0:39 offset1:47
    ds_read2st64_b32 v[90:91], v126 offset0:55 offset1:63
    v_mov_b32 v102, 0x3586
    v_mov_b32 v113, 0x35860000
    s_waitcnt lgkmcnt(4)
    v_mfma_f32_32x32x16_bf16 v[64:79], v[16:19], v[128:131], 0
    s_setprio 1
    ds_read_b64_tr_b16 v[28:29], v10 offset:49152
    ds_read_b64_tr_b16 v[30:31], v10 offset:49664
    s_waitcnt lgkmcnt(2)
    v_add_f32 v88, v88, v89
    v_mfma_f32_32x32x16_bf16 v[64:79], v[24:27], v[132:135], v[64:79]
    s_add_u32 m0, s51, 8192
    s_lshl4_add_u32 s62, s75, 458752
    buffer_load_dwordx4 v6, s[20:23], s62 offen lds
    ds_read_b64_tr_b16 v[108:109], v11 offset:49152
    ds_read_b64_tr_b16 v[110:111], v11 offset:49664
    v_add_f32 v90, v90, v91
    v_add_f32 v88, v88, v90
    v_and_b32 v112, 0xffff0000, v88
    v_sub_f32 v88, v88, v112
    s_waitcnt lgkmcnt(2)
    v_mfma_f32_32x32x16_bf16 v[64:79], v[28:31], v[136:139], v[64:79]
    v_add_u32 v8, 57344, v8
    v_add_u32 v9, 57344, v9
    v_add_u32 v10, 57344, v10
    v_add_u32 v11, 57344, v11
    ds_read_b64_tr_b16 v[20:21], v8 offset:0
    ds_read_b64_tr_b16 v[22:23], v8 offset:512
    v_cvt_pk_bf16_f32 v101, v112, v113
    v_cvt_pk_bf16_f32 v100, v112, v88
    s_nop 1
    v_mfma_f32_32x32x16_bf16 v[48:63], v[100:103], v[96:99], v[48:63]
    s_waitcnt lgkmcnt(2)
    v_mfma_f32_32x32x16_bf16 v[64:79], v[108:111], v[140:143], v[64:79]
    ds_read_b64_tr_b16 v[24:25], v9 offset:0
    ds_read_b64_tr_b16 v[26:27], v9 offset:512
    s_waitcnt lgkmcnt(2)
    v_mfma_f32_32x32x16_bf16 v[64:79], v[20:23], v[192:195], v[64:79]
    v_smfmac_f32_16x16x64_bf16 v[80:83], v[84:87], v[16:23], v103
    s_setprio 0
    ds_read_b64_tr_b16 v[28:29], v10 offset:0
    ds_read_b64_tr_b16 v[30:31], v10 offset:512
    s_waitcnt lgkmcnt(2)
    v_mfma_f32_32x32x16_bf16 v[64:79], v[24:27], v[196:199], v[64:79]
    ds_read_b64_tr_b16 v[108:109], v11 offset:0
    ds_read_b64_tr_b16 v[110:111], v11 offset:512
    v_mul_f32 v116, v48, v95
    v_mul_f32 v117, v49, v95
    v_mul_f32 v118, v50, v95
    v_mul_f32 v119, v51, v95
    s_waitcnt lgkmcnt(2)
    v_mfma_f32_32x32x16_bf16 v[64:79], v[28:31], v[200:203], v[64:79]
    s_waitcnt vmcnt(4)
    s_barrier
    s_cmp_lg_u32 s50, 1
    s_cbranch_scc1 L_pub_14
    v_mov_b32 v124, 1
    s_mov_b64 exec, 1
    buffer_store_dword v124, off, s[28:31], s68 sc1
    s_mov_b64 exec, -1
L_pub_14:
    ds_read_b64_tr_b16 v[16:17], v8 offset:8192
    ds_read_b64_tr_b16 v[18:19], v8 offset:8704
    v_max_f32 v112, v48, v127
    v_max_f32 v113, v49, v127
    v_max_f32 v114, v50, v127
    v_max_f32 v115, v51, v127
    v_exp_f32 v116, v116 clamp
    s_waitcnt lgkmcnt(2)
    v_mfma_f32_32x32x16_bf16 v[64:79], v[108:111], v[204:207], v[64:79]
    s_add_u32 m0, s51, 16384
    s_lshl4_add_u32 s62, s75, 917504
    buffer_load_dwordx4 v6, s[20:23], s62 offen lds
    ds_read_b64_tr_b16 v[24:25], v9 offset:8192
    ds_read_b64_tr_b16 v[26:27], v9 offset:8704
    v_exp_f32 v117, v117 clamp
    v_exp_f32 v118, v118 clamp
    s_waitcnt lgkmcnt(2)
    v_mfma_f32_32x32x16_bf16 v[64:79], v[16:19], v[144:147], v[64:79]
    s_setprio 1
    ds_read_b64_tr_b16 v[28:29], v10 offset:8192
    ds_read_b64_tr_b16 v[30:31], v10 offset:8704
    v_exp_f32 v119, v119 clamp
    v_fma_f32 v112, v112, v120, v116
    s_waitcnt lgkmcnt(2)
    v_mfma_f32_32x32x16_bf16 v[64:79], v[24:27], v[148:151], v[64:79]
    s_add_u32 m0, s51, 24576
    s_lshl4_add_u32 s62, s75, 1376256
    buffer_load_dwordx4 v6, s[20:23], s62 offen lds
    ds_read_b64_tr_b16 v[108:109], v11 offset:8192
    ds_read_b64_tr_b16 v[110:111], v11 offset:8704
    v_fma_f32 v113, v113, v120, v117
    v_fma_f32 v114, v114, v120, v118
    s_waitcnt lgkmcnt(2)
    v_mfma_f32_32x32x16_bf16 v[64:79], v[28:31], v[152:155], v[64:79]
    ds_read_b64_tr_b16 v[20:21], v8 offset:16384
    ds_read_b64_tr_b16 v[22:23], v8 offset:16896
    v_fma_f32 v115, v115, v120, v119
    v_cvt_pk_bf16_f32 v104, v112, v113
    v_cvt_pk_bf16_f32 v105, v114, v115
    v_mul_f32 v116, v52, v95
    v_mul_f32 v117, v53, v95
    s_waitcnt lgkmcnt(2)
    v_mfma_f32_32x32x16_bf16 v[64:79], v[108:111], v[156:159], v[64:79]
    ds_read_b64_tr_b16 v[24:25], v9 offset:16384
    ds_read_b64_tr_b16 v[26:27], v9 offset:16896
    v_mul_f32 v118, v54, v95
    v_mul_f32 v119, v55, v95
    v_max_f32 v112, v52, v127
    v_max_f32 v113, v53, v127
    s_waitcnt lgkmcnt(2)
    v_mfma_f32_32x32x16_bf16 v[64:79], v[20:23], v[208:211], v[64:79]
    v_smfmac_f32_16x16x64_bf16 v[80:83], v[84:87], v[16:23], v103
    s_setprio 0
    ds_read_b64_tr_b16 v[28:29], v10 offset:16384
    ds_read_b64_tr_b16 v[30:31], v10 offset:16896
    v_max_f32 v114, v54, v127
    v_max_f32 v115, v55, v127
    v_exp_f32 v116, v116 clamp
    v_exp_f32 v117, v117 clamp
    s_waitcnt lgkmcnt(2)
    v_mfma_f32_32x32x16_bf16 v[64:79], v[24:27], v[212:215], v[64:79]
    ds_read_b64_tr_b16 v[108:109], v11 offset:16384
    ds_read_b64_tr_b16 v[110:111], v11 offset:16896
    v_exp_f32 v118, v118 clamp
    v_exp_f32 v119, v119 clamp
    s_waitcnt lgkmcnt(2)
    v_mfma_f32_32x32x16_bf16 v[64:79], v[28:31], v[216:219], v[64:79]
    s_barrier
    ds_read_b64_tr_b16 v[16:17], v8 offset:24576
    ds_read_b64_tr_b16 v[18:19], v8 offset:25088
    v_fma_f32 v112, v112, v120, v116
    v_fma_f32 v113, v113, v120, v117
    v_fma_f32 v114, v114, v120, v118
    s_waitcnt lgkmcnt(2)
    v_mfma_f32_32x32x16_bf16 v[64:79], v[108:111], v[220:223], v[64:79]
    s_add_u32 m0, s51, 49152
    s_lshl4_add_u32 s62, s63, 917504
    buffer_load_dwordx4 v6, s[20:23], s62 offen lds
    ds_read_b64_tr_b16 v[24:25], v9 offset:24576
    ds_read_b64_tr_b16 v[26:27], v9 offset:25088
    v_fma_f32 v115, v115, v120, v119
    v_cvt_pk_bf16_f32 v106, v112, v113
    v_cvt_pk_bf16_f32 v107, v114, v115
    s_waitcnt lgkmcnt(2)
    v_mfma_f32_32x32x16_bf16 v[64:79], v[16:19], v[160:163], v[64:79]
    s_setprio 1
    ds_read_b64_tr_b16 v[28:29], v10 offset:24576
    ds_read_b64_tr_b16 v[30:31], v10 offset:25088
    buffer_store_dwordx4 v[104:107], v7, s[28:31], s61 offen offset:0 sc1
    v_mul_f32 v116, v56, v95
    v_mul_f32 v117, v57, v95
    s_waitcnt lgkmcnt(2)
    v_mfma_f32_32x32x16_bf16 v[64:79], v[24:27], v[164:167], v[64:79]
    s_add_u32 m0, s51, 57344
    s_lshl4_add_u32 s62, s63, 1376256
    buffer_load_dwordx4 v6, s[20:23], s62 offen lds
    ds_read_b64_tr_b16 v[108:109], v11 offset:24576
    ds_read_b64_tr_b16 v[110:111], v11 offset:25088
    v_mul_f32 v118, v58, v95
    v_mul_f32 v119, v59, v95
    v_max_f32 v112, v56, v127
    v_max_f32 v113, v57, v127
    s_waitcnt lgkmcnt(2)
    v_mfma_f32_32x32x16_bf16 v[64:79], v[28:31], v[168:171], v[64:79]
    ds_read_b64_tr_b16 v[20:21], v8 offset:32768
    ds_read_b64_tr_b16 v[22:23], v8 offset:33280
    v_max_f32 v114, v58, v127
    v_max_f32 v115, v59, v127
    v_exp_f32 v116, v116 clamp
    v_exp_f32 v117, v117 clamp
    s_waitcnt lgkmcnt(2)
    v_mfma_f32_32x32x16_bf16 v[64:79], v[108:111], v[172:175], v[64:79]
    ds_read_b64_tr_b16 v[24:25], v9 offset:32768
    ds_read_b64_tr_b16 v[26:27], v9 offset:33280
    v_exp_f32 v118, v118 clamp
    v_exp_f32 v119, v119 clamp
    s_waitcnt lgkmcnt(2)
    v_mfma_f32_32x32x16_bf16 v[64:79], v[20:23], v[224:227], v[64:79]
    v_smfmac_f32_16x16x64_bf16 v[80:83], v[84:87], v[16:23], v103
    s_setprio 0
    ds_read_b64_tr_b16 v[28:29], v10 offset:32768
    ds_read_b64_tr_b16 v[30:31], v10 offset:33280
    v_fma_f32 v112, v112, v120, v116
    v_fma_f32 v113, v113, v120, v117
    v_fma_f32 v114, v114, v120, v118
    s_waitcnt lgkmcnt(2)
    v_mfma_f32_32x32x16_bf16 v[64:79], v[24:27], v[228:231], v[64:79]
    ds_read_b64_tr_b16 v[108:109], v11 offset:32768
    ds_read_b64_tr_b16 v[110:111], v11 offset:33280
    v_fma_f32 v115, v115, v120, v119
    v_cvt_pk_bf16_f32 v104, v112, v113
    v_cvt_pk_bf16_f32 v105, v114, v115
    v_mul_f32 v116, v60, v95
    v_mul_f32 v117, v61, v95
    s_waitcnt lgkmcnt(2)
    v_mfma_f32_32x32x16_bf16 v[64:79], v[28:31], v[232:235], v[64:79]
    s_barrier
    ds_read_b64_tr_b16 v[16:17], v8 offset:40960
    ds_read_b64_tr_b16 v[18:19], v8 offset:41472
    v_mul_f32 v118, v62, v95
    v_mul_f32 v119, v63, v95
    v_max_f32 v112, v60, v127
    v_max_f32 v113, v61, v127
    v_max_f32 v114, v62, v127
    s_waitcnt lgkmcnt(2)
    v_mfma_f32_32x32x16_bf16 v[64:79], v[108:111], v[236:239], v[64:79]
    s_add_u32 m0, s51, 65536
    s_lshl4_add_u32 s62, s54, 0
    buffer_load_dwordx4 v6, s[20:23], s62 offen lds
    s_cmp_lg_u32 s50, 0
    s_cbranch_scc1 L_pi_15
    s_load_dwordx8 s[76:83], s[44:45], 0 glc
    s_load_dwordx8 s[84:91], s[44:45], 32 glc
L_pi_15:
    ds_read_b64_tr_b16 v[24:25], v9 offset:40960
    ds_read_b64_tr_b16 v[26:27], v9 offset:41472
    v_max_f32 v115, v63, v127
    v_exp_f32 v116, v116 clamp
    v_exp_f32 v117, v117 clamp
    s_waitcnt lgkmcnt(2)
    v_mfma_f32_32x32x16_bf16 v[64:79], v[16:19], v[176:179], v[64:79]
    s_setprio 1
    ds_read_b64_tr_b16 v[28:29], v10 offset:40960
    ds_read_b64_tr_b16 v[30:31], v10 offset:41472
    v_exp_f32 v118, v118 clamp
    v_exp_f32 v119, v119 clamp
    s_waitcnt lgkmcnt(2)
    v_mfma_f32_32x32x16_bf16 v[64:79], v[24:27], v[180:183], v[64:79]
    s_add_u32 m0, s51, 73728
    s_lshl4_add_u32 s62, s54, 458752
    buffer_load_dwordx4 v6, s[20:23], s62 offen lds
    ds_read_b64_tr_b16 v[108:109], v11 offset:40960
    ds_read_b64_tr_b16 v[110:111], v11 offset:41472
    v_fma_f32 v112, v112, v120, v116
    v_fma_f32 v113, v113, v120, v117
    v_fma_f32 v114, v114, v120, v118
    s_waitcnt lgkmcnt(2)
    v_mfma_f32_32x32x16_bf16 v[64:79], v[28:31], v[184:187], v[64:79]
    ds_read_b64_tr_b16 v[20:21], v8 offset:49152
    ds_read_b64_tr_b16 v[22:23], v8 offset:49664
    v_fma_f32 v115, v115, v120, v119
    v_cvt_pk_bf16_f32 v106, v112, v113
    v_cvt_pk_bf16_f32 v107, v114, v115
    buffer_store_dwordx4 v[104:107], v7, s[28:31], s61 offen offset:1024 sc1
    s_waitcnt lgkmcnt(2)
    v_mfma_f32_32x32x16_bf16 v[64:79], v[108:111], v[188:191], v[64:79]
    ds_read_b64_tr_b16 v[24:25], v9 offset:49152
    ds_read_b64_tr_b16 v[26:27], v9 offset:49664
    s_waitcnt lgkmcnt(2)
    v_mfma_f32_32x32x16_bf16 v[64:79], v[20:23], v[240:243], v[64:79]
    v_smfmac_f32_16x16x64_bf16 v[80:83], v[84:87], v[16:23], v103
    s_setprio 0
    ds_read_b64_tr_b16 v[28:29], v10 offset:49152
    ds_read_b64_tr_b16 v[30:31], v10 offset:49664
    s_waitcnt lgkmcnt(2)
    v_mfma_f32_32x32x16_bf16 v[64:79], v[24:27], v[244:247], v[64:79]
    ds_read_b64_tr_b16 v[108:109], v11 offset:49152
    ds_read_b64_tr_b16 v[110:111], v11 offset:49664
    s_waitcnt lgkmcnt(2)
    v_mfma_f32_32x32x16_bf16 v[64:79], v[28:31], v[248:251], v[64:79]
    s_nop 2
    v_add_f32 v82, v80, v81
    ds_write_b32 v2, v82 offset:768
    v_mov_b32 v80, 0
    v_mov_b32 v81, 0
    s_cmp_lg_u32 s50, 0
    s_cbranch_scc1 L_pc_16
    s_mov_b32 s69, 0
L_pl_17:
    s_waitcnt lgkmcnt(0)
    s_min_u32 s76, s76, s80
    s_min_u32 s77, s77, s81
    s_min_u32 s78, s78, s82
    s_min_u32 s79, s79, s83
    s_min_u32 s76, s76, s78
    s_min_u32 s77, s77, s79
    s_min_u32 s76, s76, s77
    s_min_u32 s84, s84, s88
    s_min_u32 s85, s85, s89
    s_min_u32 s86, s86, s90
    s_min_u32 s87, s87, s91
    s_min_u32 s84, s84, s86
    s_min_u32 s85, s85, s87
    s_min_u32 s84, s84, s85
    s_cmp_ge_u32 s84, 1
    s_cselect_b32 s76, s76, 0
    s_cmp_ge_u32 s76, 1
    s_cbranch_scc1 L_pc_16
    s_add_u32 s69, s69, 1
    s_cmp_ge_u32 s69, 0x40000
    s_cbranch_scc1 L_pc_16
    s_load_dwordx8 s[76:83], s[44:45], 0 glc
    s_load_dwordx8 s[84:91], s[44:45], 32 glc
    s_branch L_pl_17
L_pc_16:
    s_waitcnt lgkmcnt(0)
    s_barrier
    v_lshlrev_b32 v3, 4, v1
    v_add_u32 v12, 114688, v12
    v_add_u32 v13, 114688, v13
    v_add_u32 v14, 114688, v14
    v_add_u32 v15, 114688, v15
    ds_read_b64_tr_b16 v[16:17], v12 offset:8192
    ds_read_b64_tr_b16 v[18:19], v12 offset:8448
    v_mfma_f32_32x32x16_bf16 v[64:79], v[108:111], v[252:255], v[64:79]
    s_add_u32 m0, s51, 81920
    s_lshl4_add_u32 s62, s54, 917504
    buffer_load_dwordx4 v6, s[20:23], s62 offen lds
    v_lshrrev_b32 v8, 5, v1
    v_lshlrev_b32 v8, 9, v8
    v_bfe_u32 v125, v1, 2, 2
    v_lshl_add_u32 v8, v125, 7, v8
    v_bfe_u32 v125, v1, 3, 1
    v_lshl_add_u32 v8, v125, 6, v8
    v_bfe_u32 v125, v1, 4, 1
    v_lshl_add_u32 v8, v125, 5, v8
    v_bfe_u32 v125, v1, 0, 2
    v_lshl_add_u32 v8, v125, 3, v8
    s_and_b32 s72, s50, 3
    s_lshl_b32 s72, s72, 13
    v_add_u32 v8, s72, v8
    v_xor_b32 v9, 64, v8
    v_add_u32 v10, 0x10000, v8
    v_add_u32 v11, 0x10000, v9
    ds_read_b64_tr_b16 v[24:25], v13 offset:8192
    ds_read_b64_tr_b16 v[26:27], v13 offset:8448
    ds_read2st64_b32 v[88:89], v126 offset0:35 offset1:43
    ds_read2st64_b32 v[90:91], v126 offset0:51 offset1:59
    v_mov_b32 v102, v93
    v_lshlrev_b32 v113, 16, v93
    s_waitcnt lgkmcnt(0)
    v_add_f32 v88, v88, v89
    v_add_f32 v90, v90, v91
    v_add_f32 v88, v88, v90
    v_and_b32 v112, 0xffff0000, v88
    v_sub_f32 v88, v88, v112
    v_cvt_pk_bf16_f32 v101, v112, v113
    v_cvt_pk_bf16_f32 v100, v112, v88
    v_mfma_f32_32x32x16_bf16 v[32:47], v[16:19], v[192:195], 0
    s_setprio 1
    s_add_u32 s62, s70, s75
    buffer_load_dwordx4 v[128:131], v3, s[28:31], s62 offen offset:0 sc1
    ds_read_b64_tr_b16 v[28:29], v14 offset:8192
    ds_read_b64_tr_b16 v[30:31], v14 offset:8448
    v_mfma_f32_32x32x16_bf16 v[64:79], v[100:103], v[96:99], v[64:79]
    s_nop 11
    v_mul_f32 v116, v64, v64
    v_mfma_f32_32x32x16_bf16 v[32:47], v[24:27], v[196:199], v[32:47]
    s_add_u32 s62, s70, s75
    buffer_load_dwordx4 v[132:135], v3, s[28:31], s62 offen offset:1024 sc1
    ds_read_b64_tr_b16 v[108:109], v15 offset:8192
    ds_read_b64_tr_b16 v[110:111], v15 offset:8448
    v_mul_f32 v117, v65, v65
    v_mul_f32 v118, v66, v66
    v_mul_f32 v119, v67, v67
    v_fma_f32 v116, v116, v123, v122
    v_fma_f32 v117, v117, v123, v122
    v_fma_f32 v118, v118, v123, v122
    v_fma_f32 v119, v119, v123, v122
    v_mul_f32 v116, v64, v116
    v_mul_f32 v117, v65, v117
    v_mul_f32 v118, v66, v118
    s_waitcnt lgkmcnt(2)
    v_mfma_f32_32x32x16_bf16 v[32:47], v[28:31], v[200:203], v[32:47]
    s_add_u32 m0, s51, 90112
    s_lshl4_add_u32 s62, s54, 1376256
    buffer_load_dwordx4 v6, s[20:23], s62 offen lds
    ds_read_b64_tr_b16 v[20:21], v12 offset:12288
    ds_read_b64_tr_b16 v[22:23], v12 offset:12544
    v_mul_f32 v119, v67, v119
    v_exp_f32 v116, v116
    v_exp_f32 v117, v117
    v_exp_f32 v118, v118
    v_exp_f32 v119, v119
    v_fma_f32 v116, v116, v121, v121
    v_fma_f32 v117, v117, v121, v121
    s_waitcnt lgkmcnt(2)
    v_mfma_f32_32x32x16_bf16 v[32:47], v[108:111], v[204:207], v[32:47]
    s_add_u32 s62, s70, s75
    buffer_load_dwordx4 v[136:139], v3, s[28:31], s62 offen offset:2048 sc1
    ds_read_b64_tr_b16 v[24:25], v13 offset:12288
    ds_read_b64_tr_b16 v[26:27], v13 offset:12544
    v_fma_f32 v118, v118, v121, v121
    v_fma_f32 v119, v119, v121, v121
    v_rcp_f32 v116, v116
    v_rcp_f32 v117, v117
    v_rcp_f32 v118, v118
    v_rcp_f32 v119, v119
    v_mul_f32 v112, v64, v116
    v_mul_f32 v113, v65, v117
    s_waitcnt lgkmcnt(2)
    v_mfma_f32_32x32x16_bf16 v[32:47], v[20:23], v[208:211], v[32:47]
    v_smfmac_f32_16x16x64_bf16 v[80:83], v[84:87], v[16:23], v103
    s_setprio 0
    s_add_u32 s62, s70, s75
    buffer_load_dwordx4 v[140:143], v3, s[28:31], s62 offen offset:3072 sc1
    ds_read_b64_tr_b16 v[28:29], v14 offset:12288
    ds_read_b64_tr_b16 v[30:31], v14 offset:12544
    v_mul_f32 v114, v66, v118
    v_mul_f32 v115, v67, v119
    v_cvt_pk_bf16_f32 v104, v112, v113
    v_cvt_pk_bf16_f32 v105, v114, v115
    v_mul_f32 v116, v68, v68
    v_mul_f32 v117, v69, v69
    v_mul_f32 v118, v70, v70
    v_mul_f32 v119, v71, v71
    v_fma_f32 v116, v116, v123, v122
    v_fma_f32 v117, v117, v123, v122
    v_fma_f32 v118, v118, v123, v122
    s_waitcnt lgkmcnt(2)
    v_mfma_f32_32x32x16_bf16 v[32:47], v[24:27], v[212:215], v[32:47]
    s_add_u32 s62, s70, s63
    buffer_load_dwordx4 v[144:147], v3, s[28:31], s62 offen offset:0 sc1
    ds_read_b64_tr_b16 v[108:109], v15 offset:12288
    ds_read_b64_tr_b16 v[110:111], v15 offset:12544
    v_fma_f32 v119, v119, v123, v122
    v_mul_f32 v116, v68, v116
    v_mul_f32 v117, v69, v117
    v_mul_f32 v118, v70, v118
    v_mul_f32 v119, v71, v119
    v_exp_f32 v116, v116
    v_exp_f32 v117, v117
    v_exp_f32 v118, v118
    v_exp_f32 v119, v119
    s_waitcnt lgkmcnt(2)
    v_mfma_f32_32x32x16_bf16 v[32:47], v[28:31], v[216:219], v[32:47]
    s_add_u32 s62, s70, s63
    buffer_load_dwordx4 v[148:151], v3, s[28:31], s62 offen offset:1024 sc1
    s_waitcnt vmcnt(8)
    s_barrier
    s_cmp_lg_u32 s50, 1
    s_cbranch_scc1 L_pub_18
    v_mov_b32 v124, 2
    s_mov_b64 exec, 1
    buffer_store_dword v124, off, s[28:31], s68 sc1
    s_mov_b64 exec, -1
L_pub_18:
    ds_read_b64_tr_b16 v[16:17], v12 offset:24576
    ds_read_b64_tr_b16 v[18:19], v12 offset:24832
    v_fma_f32 v116, v116, v121, v121
    v_fma_f32 v117, v117, v121, v121
    v_fma_f32 v118, v118, v121, v121
    v_fma_f32 v119, v119, v121, v121
    v_rcp_f32 v116, v116
    v_rcp_f32 v117, v117
    v_rcp_f32 v118, v118
    s_waitcnt lgkmcnt(2)
    v_mfma_f32_32x32x16_bf16 v[32:47], v[108:111], v[220:223], v[32:47]
    s_add_u32 s62, s70, s63
    buffer_load_dwordx4 v[152:155], v3, s[28:31], s62 offen offset:2048 sc1
    ds_read_b64_tr_b16 v[24:25], v13 offset:24576
    ds_read_b64_tr_b16 v[26:27], v13 offset:24832
    v_rcp_f32 v119, v119
    v_mul_f32 v112, v68, v116
    v_mul_f32 v113, v69, v117
    v_mul_f32 v114, v70, v118
    v_mul_f32 v115, v71, v119
    v_cvt_pk_bf16_f32 v106, v112, v113
    v_cvt_pk_bf16_f32 v107, v114, v115
    buffer_store_dwordx4 v[104:107], v7, s[28:31], s59 offen offset:0 sc1
    v_mul_f32 v116, v72, v72
    v_mul_f32 v117, v73, v73
    s_waitcnt lgkmcnt(2)
    v_mfma_f32_32x32x16_bf16 v[32:47], v[16:19], v[224:227], v[32:47]
    s_setprio 1
    s_add_u32 m0, s51, 98304
    s_lshl4_add_u32 s62, s53, 0
    buffer_load_dwordx4 v6, s[20:23], s62 offen lds
    ds_read_b64_tr_b16 v[28:29], v14 offset:24576
    ds_read_b64_tr_b16 v[30:31], v14 offset:24832
    v_mul_f32 v118, v74, v74
    v_mul_f32 v119, v75, v75
    v_fma_f32 v116, v116, v123, v122
    v_fma_f32 v117, v117, v123, v122
    v_fma_f32 v118, v118, v123, v122
    v_fma_f32 v119, v119, v123, v122
    v_mul_f32 v116, v72, v116
    v_mul_f32 v117, v73, v117
    v_mul_f32 v118, v74, v118
    v_mul_f32 v119, v75, v119
    v_exp_f32 v116, v116
    s_waitcnt lgkmcnt(2)
    v_mfma_f32_32x32x16_bf16 v[32:47], v[24:27], v[228:231], v[32:47]
    s_add_u32 s62, s70, s63
    buffer_load_dwordx4 v[156:159], v3, s[28:31], s62 offen offset:3072 sc1
    ds_read_b64_tr_b16 v[108:109], v15 offset:24576
    ds_read_b64_tr_b16 v[110:111], v15 offset:24832
    v_exp_f32 v117, v117
    v_exp_f32 v118, v118
    v_exp_f32 v119, v119
    v_fma_f32 v116, v116, v121, v121
    v_fma_f32 v117, v117, v121, v121
    v_fma_f32 v118, v118, v121, v121
    v_fma_f32 v119, v119, v121, v121
    s_waitcnt lgkmcnt(2)
    v_mfma_f32_32x32x16_bf16 v[32:47], v[28:31], v[232:235], v[32:47]
    s_add_u32 s62, s70, s54
    buffer_load_dwordx4 v[160:163], v3, s[28:31], s62 offen offset:0 sc1
    ds_read_b64_tr_b16 v[20:21], v12 offset:28672
    ds_read_b64_tr_b16 v[22:23], v12 offset:28928
    v_rcp_f32 v116, v116
    v_rcp_f32 v117, v117
    v_rcp_f32 v118, v118
    v_rcp_f32 v119, v119
    v_mul_f32 v112, v72, v116
    v_mul_f32 v113, v73, v117
    v_mul_f32 v114, v74, v118
    v_mul_f32 v115, v75, v119
    v_cvt_pk_bf16_f32 v104, v112, v113
    v_cvt_pk_bf16_f32 v105, v114, v115
    s_waitcnt lgkmcnt(2)
    v_mfma_f32_32x32x16_bf16 v[32:47], v[108:111], v[236:239], v[32:47]
    s_add_u32 m0, s51, 106496
    s_lshl4_add_u32 s62, s53, 458752
    buffer_load_dwordx4 v6, s[20:23], s62 offen lds
    ds_read_b64_tr_b16 v[24:25], v13 offset:28672
    ds_read_b64_tr_b16 v[26:27], v13 offset:28928
    v_mul_f32 v116, v76, v76
    v_mul_f32 v117, v77, v77
    v_mul_f32 v118, v78, v78
    v_mul_f32 v119, v79, v79
    v_fma_f32 v116, v116, v123, v122
    v_fma_f32 v117, v117, v123, v122
    v_fma_f32 v118, v118, v123, v122
    v_fma_f32 v119, v119, v123, v122
    v_mul_f32 v116, v76, v116
    v_mul_f32 v117, v77, v117
    v_mul_f32 v118, v78, v118
    v_mul_f32 v119, v79, v119
    s_waitcnt lgkmcnt(2)
    v_mfma_f32_32x32x16_bf16 v[32:47], v[20:23], v[240:243], v[32:47]
    v_smfmac_f32_16x16x64_bf16 v[80:83], v[84:87], v[16:23], v103
    s_setprio 0
    s_add_u32 s62, s70, s54
    buffer_load_dwordx4 v[164:167], v3, s[28:31], s62 offen offset:1024 sc1
    ds_read_b64_tr_b16 v[28:29], v14 offset:28672
    ds_read_b64_tr_b16 v[30:31], v14 offset:28928
    v_exp_f32 v116, v116
    v_exp_f32 v117, v117
    v_exp_f32 v118, v118
    v_exp_f32 v119, v119
    v_fma_f32 v116, v116, v121, v121
    v_fma_f32 v117, v117, v121, v121
    v_fma_f32 v118, v118, v121, v121
    v_fma_f32 v119, v119, v121, v121
    s_waitcnt lgkmcnt(2)
    v_mfma_f32_32x32x16_bf16 v[32:47], v[24:27], v[244:247], v[32:47]
    s_add_u32 s62, s70, s54
    buffer_load_dwordx4 v[168:171], v3, s[28:31], s62 offen offset:2048 sc1
    ds_read_b64_tr_b16 v[108:109], v15 offset:28672
    ds_read_b64_tr_b16 v[110:111], v15 offset:28928
    v_rcp_f32 v116, v116
    v_rcp_f32 v117, v117
    v_rcp_f32 v118, v118
    v_rcp_f32 v119, v119
    v_mul_f32 v112, v76, v116
    v_mul_f32 v113, v77, v117
    v_mul_f32 v114, v78, v118
    v_mul_f32 v115, v79, v119
    v_cvt_pk_bf16_f32 v106, v112, v113
    v_cvt_pk_bf16_f32 v107, v114, v115
    buffer_store_dwordx4 v[104:107], v7, s[28:31], s59 offen offset:1024 sc1
    s_waitcnt lgkmcnt(2)
    v_mfma_f32_32x32x16_bf16 v[32:47], v[28:31], v[248:251], v[32:47]
    s_add_u32 s62, s70, s54
    buffer_load_dwordx4 v[172:175], v3, s[28:31], s62 offen offset:3072 sc1
    v_add_f32 v82, v80, v81
    ds_write_b32 v2, v82 offset:1280
    v_mov_b32 v80, 0
    v_mov_b32 v81, 0
    s_waitcnt lgkmcnt(0)
    s_barrier
    v_lshlrev_b32 v124, 4, v0
    v_add_u32 v124, 114688, v124
    v_xor_b32 v125, 4096, v124
    ds_read2st64_b32 v[88:89], v126 offset0:37 offset1:45
    ds_read2st64_b32 v[90:91], v126 offset0:53 offset1:61
    v_xor_b32 v112, 64, v126
    ds_read2st64_b32 v[116:117], v112 offset0:36 offset1:44
    ds_read2st64_b32 v[118:119], v112 offset0:52 offset1:60
    v_mov_b32 v102, v94
    v_lshlrev_b32 v113, 16, v94
    ds_read_b64_tr_b16 v[16:17], v8 offset:0
    ds_read_b64_tr_b16 v[18:19], v8 offset:1024
    ds_read_b64_tr_b16 v[20:21], v9 offset:0
    ds_read_b64_tr_b16 v[22:23], v9 offset:1024
    v_mfma_f32_32x32x16_bf16 v[32:47], v[108:111], v[252:255], v[32:47]
    s_add_u32 s62, s70, s53
    buffer_load_dwordx4 v[176:179], v3, s[28:31], s62 offen offset:0 sc1
    s_setprio 0
    s_add_u32 s62, s70, s53
    buffer_load_dwordx4 v[180:183], v3, s[28:31], s62 offen offset:1024 sc1
    s_add_u32 s62, s70, s53
    buffer_load_dwordx4 v[184:187], v3, s[28:31], s62 offen offset:2048 sc1
    s_add_u32 s62, s70, s53
    buffer_load_dwordx4 v[188:191], v3, s[28:31], s62 offen offset:3072 sc1
    s_branch L_p2q
.p2align 6
L_kv0:
    ds_read_b128 v[128:131], v12 offset:40960
    ds_read_b128 v[132:135], v13 offset:40960
    ds_read_b128 v[136:139], v14 offset:40960
    ds_read_b128 v[140:143], v15 offset:40960
    ds_read_b64_tr_b16 v[16:17], v8 offset:0
    ds_read_b64_tr_b16 v[18:19], v8 offset:512
    ds_read_b64_tr_b16 v[24:25], v9 offset:0
    ds_read_b64_tr_b16 v[26:27], v9 offset:512
    s_mov_b32 s38, 256
    s_mov_b32 s39, 0x20000
    s_add_u32 s7, s3, 32
    s_and_b32 s7, s7, 63
    s_add_u32 s32, s3, 40
    s_and_b32 s32, s32, 63
    s_add_u32 s33, s3, 48
    s_and_b32 s33, s33, 63
    s_add_u32 s34, s3, 56
    s_and_b32 s34, s34, 63
    s_waitcnt lgkmcnt(2)
    v_mfma_f32_32x32x16_bf16 v[32:47], v[16:19], v[128:131], 0
    s_setprio 0
    s_add_u32 m0, s51, 8192
    s_lshl4_add_u32 s62, s5, s69
    buffer_load_dwordx4 v2, s[8:11], s62 offen lds
    ds_read_b64_tr_b16 v[28:29], v10 offset:0
    ds_read_b64_tr_b16 v[30:31], v10 offset:512
    s_mov_b32 s14, 1572864
    s_mov_b32 s15, 0x20000
    s_waitcnt lgkmcnt(2)
    v_mfma_f32_32x32x16_bf16 v[32:47], v[24:27], v[132:135], v[32:47]
    s_add_u32 m0, s51, 16384
    s_mul_i32 s62, s5, 28672
    s_add_u32 s62, s62, s54
    buffer_load_dwordx4 v4, s[16:19], s62 offen lds
    v_dot2c_f32_bf16 v124, v128, v128
    v_dot2c_f32_bf16 v125, v129, v129
    v_dot2c_f32_bf16 v124, v130, v130
    v_dot2c_f32_bf16 v125, v131, v131
    v_dot2c_f32_bf16 v124, v132, v132
    v_dot2c_f32_bf16 v125, v133, v133
    v_dot2c_f32_bf16 v124, v134, v134
    v_dot2c_f32_bf16 v125, v135, v135
    v_dot2c_f32_bf16 v124, v136, v136
    v_dot2c_f32_bf16 v125, v137, v137
    v_dot2c_f32_bf16 v124, v138, v138
    v_dot2c_f32_bf16 v125, v139, v139
    v_dot2c_f32_bf16 v124, v140, v140
    v_dot2c_f32_bf16 v125, v141, v141
    v_dot2c_f32_bf16 v124, v142, v142
    v_dot2c_f32_bf16 v125, v143, v143
    ds_read_b64_tr_b16 v[108:109], v11 offset:0
    ds_read_b64_tr_b16 v[110:111], v11 offset:512
    s_mov_b32 s42, 3584
    s_mov_b32 s43, 0x20000
    s_mov_b32 s22, 1835008
    s_waitcnt lgkmcnt(2)
    v_mfma_f32_32x32x16_bf16 v[32:47], v[28:31], v[136:139], v[32:47]
    s_add_u32 m0, s51, 24576
    s_lshl4_add_u32 s62, s6, s53
    buffer_load_dwordx4 v2, s[8:11], s62 offen lds
    s_waitcnt vmcnt(5)
    s_barrier
    v_add_u32 v12, 57344, v12
    v_add_u32 v13, 57344, v13
    v_add_u32 v14, 57344, v14
    v_add_u32 v15, 57344, v15
    ds_read_b128 v[144:147], v12 offset:8192
    ds_read_b128 v[148:151], v13 offset:8192
    ds_read_b128 v[152:155], v14 offset:8192
    ds_read_b128 v[156:159], v15 offset:8192
    ds_read_b64_tr_b16 v[20:21], v8 offset:24576
    ds_read_b64_tr_b16 v[22:23], v8 offset:25088
    s_mov_b32 s23, 0x20000
    s_movk_i32 s76, 3072
    v_mad_u32_u24 v3, v112, s76, v113
    s_waitcnt lgkmcnt(6)
    v_mfma_f32_32x32x16_bf16 v[32:47], v[108:111], v[140:143], v[32:47]
    s_add_u32 m0, s51, 32768
    s_lshl4_add_u32 s62, s6, s69
    buffer_load_dwordx4 v2, s[8:11], s62 offen lds
    ds_read_b64_tr_b16 v[24:25], v9 offset:24576
    ds_read_b64_tr_b16 v[26:27], v9 offset:25088
    v_lshl_add_u32 v6, v112, 10, v113
    s_waitcnt lgkmcnt(2)
    v_mfma_f32_32x32x16_bf16 v[32:47], v[20:23], v[144:147], v[32:47]
    v_smfmac_f32_16x16x64_bf16 v[80:83], v[84:87], v[16:23], v103
    s_setprio 1
    s_add_u32 m0, s51, 40960
    s_mul_i32 s62, s6, 28672
    s_add_u32 s62, s62, s54
    buffer_load_dwordx4 v4, s[16:19], s62 offen lds
    ds_read_b64_tr_b16 v[28:29], v10 offset:24576
    ds_read_b64_tr_b16 v[30:31], v10 offset:25088
    s_lshl_b32 s76, s67, 7
    v_add_u32 v6, s76, v6
    s_waitcnt lgkmcnt(2)
    v_mfma_f32_32x32x16_bf16 v[32:47], v[24:27], v[148:151], v[32:47]
    s_add_u32 m0, s51, 49152
    s_lshl4_add_u32 s62, s7, s53
    buffer_load_dwordx4 v2, s[8:11], s62 offen lds
    v_dot2c_f32_bf16 v124, v144, v144
    v_dot2c_f32_bf16 v125, v145, v145
    v_dot2c_f32_bf16 v124, v146, v146
    v_dot2c_f32_bf16 v125, v147, v147
    v_dot2c_f32_bf16 v124, v148, v148
    v_dot2c_f32_bf16 v125, v149, v149
    v_dot2c_f32_bf16 v124, v150, v150
    v_dot2c_f32_bf16 v125, v151, v151
    v_dot2c_f32_bf16 v124, v152, v152
    v_dot2c_f32_bf16 v125, v153, v153
    v_dot2c_f32_bf16 v124, v154, v154
    v_dot2c_f32_bf16 v125, v155, v155
    v_dot2c_f32_bf16 v124, v156, v156
    v_dot2c_f32_bf16 v125, v157, v157
    v_dot2c_f32_bf16 v124, v158, v158
    v_dot2c_f32_bf16 v125, v159, v159
    ds_read_b64_tr_b16 v[108:109], v11 offset:24576
    ds_read_b64_tr_b16 v[110:111], v11 offset:25088
    v_and_b32 v117, 31, v0
    s_waitcnt lgkmcnt(2)
    v_mfma_f32_32x32x16_bf16 v[32:47], v[28:31], v[152:155], v[32:47]
    s_add_u32 m0, s51, 57344
    s_lshl4_add_u32 s62, s7, s69
    buffer_load_dwordx4 v2, s[8:11], s62 offen lds
    s_waitcnt vmcnt(5)
    s_barrier
    s_cmp_lg_u32 s50, 1
    s_cbranch_scc1 L_ini_19
    s_cmp_ge_u32 s2, 8
    s_cbranch_scc1 L_ini_19
    v_mov_b32 v104, 1
    s_mov_b64 exec, 1
    buffer_atomic_add v104, off, s[36:39], 0
    s_mov_b64 exec, -1
L_ini_19:
    v_subrev_u32 v12, 114688, v12
    v_subrev_u32 v13, 114688, v13
    v_subrev_u32 v14, 114688, v14
    v_subrev_u32 v15, 114688, v15
    ds_read_b128 v[160:163], v12 offset:0
    ds_read_b128 v[164:167], v13 offset:0
    ds_read_b128 v[168:171], v14 offset:0
    ds_read_b128 v[172:175], v15 offset:0
    v_subrev_u32 v8, 114688, v8
    v_subrev_u32 v9, 114688, v9
    v_subrev_u32 v10, 114688, v10
    v_subrev_u32 v11, 114688, v11
    ds_read_b64_tr_b16 v[16:17], v8 offset:16384
    ds_read_b64_tr_b16 v[18:19], v8 offset:16896
    v_lshlrev_b32 v116, 1, v117
    s_waitcnt lgkmcnt(6)
    v_mfma_f32_32x32x16_bf16 v[32:47], v[108:111], v[156:159], v[32:47]
    s_add_u32 m0, s51, 65536
    s_mul_i32 s62, s7, 28672
    s_add_u32 s62, s62, s54
    buffer_load_dwordx4 v4, s[16:19], s62 offen lds
    ds_read_b64_tr_b16 v[24:25], v9 offset:16384
    ds_read_b64_tr_b16 v[26:27], v9 offset:16896
    v_lshlrev_b32 v117, 2, v117
    v_add_u32 v126, 147456, v117
    s_waitcnt lgkmcnt(2)
    v_mfma_f32_32x32x16_bf16 v[32:47], v[16:19], v[160:163], v[32:47]
    s_setprio 0
    s_add_u32 m0, s51, 73728
    s_lshl4_add_u32 s62, s32, s53
    buffer_load_dwordx4 v2, s[8:11], s62 offen lds
    ds_read_b64_tr_b16 v[28:29], v10 offset:16384
    ds_read_b64_tr_b16 v[30:31], v10 offset:16896
    s_mul_i32 s73, s75, 589824
    s_add_u32 s72, s73, 0
    s_lshr_b32 s76, s52, 1
    s_lshl_b32 s80, s76, 7
    s_waitcnt lgkmcnt(2)
    v_mfma_f32_32x32x16_bf16 v[32:47], v[24:27], v[164:167], v[32:47]
    s_add_u32 m0, s51, 81920
    s_lshl4_add_u32 s62, s32, s69
    buffer_load_dwordx4 v2, s[8:11], s62 offen lds
    v_dot2c_f32_bf16 v124, v160, v160
    v_dot2c_f32_bf16 v125, v161, v161
    v_dot2c_f32_bf16 v124, v162, v162
    v_dot2c_f32_bf16 v125, v163, v163
    v_dot2c_f32_bf16 v124, v164, v164
    v_dot2c_f32_bf16 v125, v165, v165
    v_dot2c_f32_bf16 v124, v166, v166
    v_dot2c_f32_bf16 v125, v167, v167
    v_dot2c_f32_bf16 v124, v168, v168
    v_dot2c_f32_bf16 v125, v169, v169
    v_dot2c_f32_bf16 v124, v170, v170
    v_dot2c_f32_bf16 v125, v171, v171
    v_dot2c_f32_bf16 v124, v172, v172
    v_dot2c_f32_bf16 v125, v173, v173
    v_dot2c_f32_bf16 v124, v174, v174
    v_dot2c_f32_bf16 v125, v175, v175
    ds_read_b64_tr_b16 v[108:109], v11 offset:16384
    ds_read_b64_tr_b16 v[110:111], v11 offset:16896
    s_lshl_b32 s78, s54, 5
    s_add_u32 s78, s78, s72
    s_add_u32 s55, s80, 1024
    s_add_u32 s56, s80, 2048
    s_mov_b32 s60, s78
    v_lshrrev_b32 v117, 5, v1
    s_waitcnt lgkmcnt(2)
    v_mfma_f32_32x32x16_bf16 v[32:47], v[28:31], v[168:171], v[32:47]
    s_add_u32 m0, s51, 90112
    s_mul_i32 s62, s32, 28672
    s_add_u32 s62, s62, s54
    buffer_load_dwordx4 v4, s[16:19], s62 offen lds
    s_waitcnt vmcnt(6)
    s_barrier
    ds_read_b128 v[176:179], v12 offset:24576
    ds_read_b128 v[180:183], v13 offset:24576
    ds_read_b128 v[184:187], v14 offset:24576
    ds_read_b128 v[188:191], v15 offset:24576
    ds_read_b64_tr_b16 v[20:21], v8 offset:40960
    ds_read_b64_tr_b16 v[22:23], v8 offset:41472
    v_lshlrev_b32 v127, 4, v117
    v_add_u32 v127, 147456, v127
    s_waitcnt lgkmcnt(6)
    v_mfma_f32_32x32x16_bf16 v[32:47], v[108:111], v[172:175], v[32:47]
    s_add_u32 m0, s51, 98304
    s_lshl4_add_u32 s62, s33, s53
    buffer_load_dwordx4 v2, s[8:11], s62 offen lds
    ds_read_b64_tr_b16 v[24:25], v9 offset:40960
    ds_read_b64_tr_b16 v[26:27], v9 offset:41472
    s_lshl_b32 s71, s76, 13
    s_add_u32 s71, s71, 10485760
    buffer_load_ushort v92, v116, s[40:43], s54 offen offset:0
    s_waitcnt lgkmcnt(2)
    v_mfma_f32_32x32x16_bf16 v[32:47], v[20:23], v[176:179], v[32:47]
    v_smfmac_f32_16x16x64_bf16 v[80:83], v[84:87], v[16:23], v103
    s_setprio 1
    s_add_u32 m0, s51, 106496
    s_lshl4_add_u32 s62, s33, s69
    buffer_load_dwordx4 v2, s[8:11], s62 offen lds
    ds_read_b64_tr_b16 v[28:29], v10 offset:40960
    ds_read_b64_tr_b16 v[30:31], v10 offset:41472
    s_mov_b32 s64, 0x3fb8aa3b
    s_mov_b32 s65, 0x358637bd
    s_mov_b32 s48, 0x0000ffff
    s_mov_b32 s49, 0x0000ffff
    s_mul_i32 s79, s77, 147456
    v_lshlrev_b32 v7, 4, v1
    s_waitcnt lgkmcnt(2)
    v_mfma_f32_32x32x16_bf16 v[32:47], v[24:27], v[180:183], v[32:47]
    s_add_u32 m0, s51, 114688
    s_mul_i32 s62, s33, 28672
    s_add_u32 s62, s62, s54
    buffer_load_dwordx4 v4, s[16:19], s62 offen lds
    v_dot2c_f32_bf16 v124, v176, v176
    v_dot2c_f32_bf16 v125, v177, v177
    v_dot2c_f32_bf16 v124, v178, v178
    v_dot2c_f32_bf16 v125, v179, v179
    v_dot2c_f32_bf16 v124, v180, v180
    v_dot2c_f32_bf16 v125, v181, v181
    v_dot2c_f32_bf16 v124, v182, v182
    v_dot2c_f32_bf16 v125, v183, v183
    v_dot2c_f32_bf16 v124, v184, v184
    v_dot2c_f32_bf16 v125, v185, v185
    v_dot2c_f32_bf16 v124, v186, v186
    v_dot2c_f32_bf16 v125, v187, v187
    v_dot2c_f32_bf16 v124, v188, v188
    v_dot2c_f32_bf16 v125, v189, v189
    v_dot2c_f32_bf16 v124, v190, v190
    v_dot2c_f32_bf16 v125, v191, v191
    ds_read_b64_tr_b16 v[108:109], v11 offset:40960
    ds_read_b64_tr_b16 v[110:111], v11 offset:41472
    v_add_u32 v7, s79, v7
    s_lshr_b32 s79, s66, 1
    s_lshl_b32 s79, s79, 11
    s_add_u32 s79, s79, 10486912
    s_add_u32 s44, s28, s79
    s_addc_u32 s45, s29, 0
    s_lshl_b32 s68, s75, 11
    s_lshl2_add_u32 s68, s76, s68
    s_add_u32 s68, s68, 10486944
    s_lshl_b32 s79, s66, 1
    s_add_u32 s79, s79, 0
    s_mul_i32 s79, s79, 147456
    s_mul_i32 s70, s77, 28672
    s_add_u32 s70, s70, s79
    s_lshl_b32 s74, s77, 13
    s_add_u32 s74, s74, s79
    s_add_u32 s74, s74, 114688
    s_waitcnt lgkmcnt(2)
    v_mfma_f32_32x32x16_bf16 v[32:47], v[28:31], v[184:187], v[32:47]
    s_add_u32 m0, s51, 122880
    s_lshl4_add_u32 s62, s34, s53
    buffer_load_dwordx4 v2, s[8:11], s62 offen lds
    s_waitcnt vmcnt(8)
    s_barrier
    ds_read_b128 v[192:195], v12 offset:49152
    ds_read_b128 v[196:199], v13 offset:49152
    ds_read_b128 v[200:203], v14 offset:49152
    ds_read_b128 v[204:207], v15 offset:49152
    v_add_u32 v8, 57344, v8
    v_add_u32 v9, 57344, v9
    v_add_u32 v10, 57344, v10
    v_add_u32 v11, 57344, v11
    ds_read_b64_tr_b16 v[16:17], v8 offset:8192
    ds_read_b64_tr_b16 v[18:19], v8 offset:8704
    s_waitcnt lgkmcnt(6)
    v_mfma_f32_32x32x16_bf16 v[32:47], v[108:111], v[188:191], v[32:47]
    s_add_u32 m0, s51, 131072
    s_lshl4_add_u32 s62, s34, s69
    buffer_load_dwordx4 v2, s[8:11], s62 offen lds
    ds_read_b64_tr_b16 v[24:25], v9 offset:8192
    ds_read_b64_tr_b16 v[26:27], v9 offset:8704
    s_waitcnt lgkmcnt(2)
    v_mfma_f32_32x32x16_bf16 v[32:47], v[16:19], v[192:195], v[32:47]
    s_setprio 0
    s_add_u32 m0, s51, 139264
    s_mul_i32 s62, s34, 28672
    s_add_u32 s62, s62, s54
    buffer_load_dwordx4 v4, s[16:19], s62 offen lds
    ds_read_b64_tr_b16 v[28:29], v10 offset:8192
    ds_read_b64_tr_b16 v[30:31], v10 offset:8704
    s_waitcnt lgkmcnt(2)
    v_mfma_f32_32x32x16_bf16 v[32:47], v[24:27], v[196:199], v[32:47]
    s_add_u32 m0, s51, 0
    s_mul_i32 s62, s3, 24576
    s_add_u32 s62, s62, s55
    buffer_load_dwordx4 v3, s[12:15], s62 offen lds
    v_dot2c_f32_bf16 v124, v192, v192
    v_dot2c_f32_bf16 v125, v193, v193
    v_dot2c_f32_bf16 v124, v194, v194
    v_dot2c_f32_bf16 v125, v195, v195
    v_dot2c_f32_bf16 v124, v196, v196
    v_dot2c_f32_bf16 v125, v197, v197
    v_dot2c_f32_bf16 v124, v198, v198
    v_dot2c_f32_bf16 v125, v199, v199
    v_dot2c_f32_bf16 v124, v200, v200
    v_dot2c_f32_bf16 v125, v201, v201
    v_dot2c_f32_bf16 v124, v202, v202
    v_dot2c_f32_bf16 v125, v203, v203
    v_dot2c_f32_bf16 v124, v204, v204
    v_dot2c_f32_bf16 v125, v205, v205
    v_dot2c_f32_bf16 v124, v206, v206
    v_dot2c_f32_bf16 v125, v207, v207
    ds_read_b64_tr_b16 v[108:109], v11 offset:8192
    ds_read_b64_tr_b16 v[110:111], v11 offset:8704
    s_waitcnt lgkmcnt(2)
    v_mfma_f32_32x32x16_bf16 v[32:47], v[28:31], v[200:203], v[32:47]
    s_add_u32 m0, s51, 8192
    s_mul_i32 s62, s4, 24576
    s_add_u32 s62, s62, s55
    buffer_load_dwordx4 v3, s[12:15], s62 offen lds
    s_waitcnt vmcnt(9)
    s_barrier
    v_add_u32 v12, 57344, v12
    v_add_u32 v13, 57344, v13
    v_add_u32 v14, 57344, v14
    v_add_u32 v15, 57344, v15
    ds_read_b128 v[208:211], v12 offset:16384
    ds_read_b128 v[212:215], v13 offset:16384
    ds_read_b128 v[216:219], v14 offset:16384
    ds_read_b128 v[220:223], v15 offset:16384
    ds_read_b64_tr_b16 v[20:21], v8 offset:32768
    ds_read_b64_tr_b16 v[22:23], v8 offset:33280
    s_waitcnt lgkmcnt(6)
    v_mfma_f32_32x32x16_bf16 v[32:47], v[108:111], v[204:207], v[32:47]
    s_add_u32 m0, s51, 16384
    s_mul_i32 s62, s5, 24576
    s_add_u32 s62, s62, s55
    buffer_load_dwordx4 v3, s[12:15], s62 offen lds
    ds_read_b64_tr_b16 v[24:25], v9 offset:32768
    ds_read_b64_tr_b16 v[26:27], v9 offset:33280
    s_waitcnt lgkmcnt(2)
    v_mfma_f32_32x32x16_bf16 v[32:47], v[20:23], v[208:211], v[32:47]
    v_smfmac_f32_16x16x64_bf16 v[80:83], v[84:87], v[16:23], v103
    s_setprio 1
    s_add_u32 m0, s51, 24576
    s_mul_i32 s62, s6, 24576
    s_add_u32 s62, s62, s55
    buffer_load_dwordx4 v3, s[12:15], s62 offen lds
    ds_read_b64_tr_b16 v[28:29], v10 offset:32768
    ds_read_b64_tr_b16 v[30:31], v10 offset:33280
    s_waitcnt lgkmcnt(2)
    v_mfma_f32_32x32x16_bf16 v[32:47], v[24:27], v[212:215], v[32:47]
    s_add_u32 m0, s51, 32768
    s_mul_i32 s62, s7, 24576
    s_add_u32 s62, s62, s55
    buffer_load_dwordx4 v3, s[12:15], s62 offen lds
    v_dot2c_f32_bf16 v124, v208, v208
    v_dot2c_f32_bf16 v125, v209, v209
    v_dot2c_f32_bf16 v124, v210, v210
    v_dot2c_f32_bf16 v125, v211, v211
    v_dot2c_f32_bf16 v124, v212, v212
    v_dot2c_f32_bf16 v125, v213, v213
    v_dot2c_f32_bf16 v124, v214, v214
    v_dot2c_f32_bf16 v125, v215, v215
    v_dot2c_f32_bf16 v124, v216, v216
    v_dot2c_f32_bf16 v125, v217, v217
    v_dot2c_f32_bf16 v124, v218, v218
    v_dot2c_f32_bf16 v125, v219, v219
    v_dot2c_f32_bf16 v124, v220, v220
    v_dot2c_f32_bf16 v125, v221, v221
    v_dot2c_f32_bf16 v124, v222, v222
    v_dot2c_f32_bf16 v125, v223, v223
    s_and_b32 s72, s50, 3
    s_lshl_b32 s72, s72, 11
    s_add_u32 s72, s72, 155648
    v_lshlrev_b32 v2, 2, v1
    v_add_u32 v2, s72, v2
    ds_read_b64_tr_b16 v[108:109], v11 offset:32768
    ds_read_b64_tr_b16 v[110:111], v11 offset:33280
    s_waitcnt lgkmcnt(2)
    v_mfma_f32_32x32x16_bf16 v[32:47], v[28:31], v[216:219], v[32:47]
    s_add_u32 m0, s51, 40960
    s_mul_i32 s62, s32, 24576
    s_add_u32 s62, s62, s55
    buffer_load_dwordx4 v3, s[12:15], s62 offen lds
    s_waitcnt vmcnt(9)
    s_barrier
    s_cmp_lg_u32 s50, 0
    s_cbranch_scc1 L_ip_20
    buffer_load_dword v107, off, s[36:39], 0 sc1
L_ip_20:
    ds_read_b128 v[224:227], v12 offset:40960
    ds_read_b128 v[228:231], v13 offset:40960
    ds_read_b128 v[232:235], v14 offset:40960
    ds_read_b128 v[236:239], v15 offset:40960
    v_add_u32 v8, 57344, v8
    v_add_u32 v9, 57344, v9
    v_add_u32 v10, 57344, v10
    v_add_u32 v11, 57344, v11
    ds_read_b64_tr_b16 v[16:17], v8 offset:0
    ds_read_b64_tr_b16 v[18:19], v8 offset:512
    s_waitcnt lgkmcnt(6)
    v_mfma_f32_32x32x16_bf16 v[32:47], v[108:111], v[220:223], v[32:47]
    s_add_u32 m0, s51, 49152
    s_mul_i32 s62, s33, 24576
    s_add_u32 s62, s62, s55
    buffer_load_dwordx4 v3, s[12:15], s62 offen lds
    ds_read_b64_tr_b16 v[24:25], v9 offset:0
    ds_read_b64_tr_b16 v[26:27], v9 offset:512
    s_waitcnt lgkmcnt(2)
    v_mfma_f32_32x32x16_bf16 v[32:47], v[16:19], v[224:227], v[32:47]
    s_setprio 0
    s_add_u32 m0, s51, 57344
    s_mul_i32 s62, s34, 24576
    s_add_u32 s62, s62, s55
    buffer_load_dwordx4 v3, s[12:15], s62 offen lds
    ds_read_b64_tr_b16 v[28:29], v10 offset:0
    ds_read_b64_tr_b16 v[30:31], v10 offset:512
    s_waitcnt lgkmcnt(2)
    v_mfma_f32_32x32x16_bf16 v[32:47], v[24:27], v[228:231], v[32:47]
    s_add_u32 m0, s51, 65536
    s_mul_i32 s62, s3, 24576
    s_add_u32 s62, s62, s56
    buffer_load_dwordx4 v3, s[12:15], s62 offen lds
    v_dot2c_f32_bf16 v124, v224, v224
    v_dot2c_f32_bf16 v125, v225, v225
    v_dot2c_f32_bf16 v124, v226, v226
    v_dot2c_f32_bf16 v125, v227, v227
    v_dot2c_f32_bf16 v124, v228, v228
    v_dot2c_f32_bf16 v125, v229, v229
    v_dot2c_f32_bf16 v124, v230, v230
    v_dot2c_f32_bf16 v125, v231, v231
    v_dot2c_f32_bf16 v124, v232, v232
    v_dot2c_f32_bf16 v125, v233, v233
    v_dot2c_f32_bf16 v124, v234, v234
    v_dot2c_f32_bf16 v125, v235, v235
    v_dot2c_f32_bf16 v124, v236, v236
    v_dot2c_f32_bf16 v125, v237, v237
    v_dot2c_f32_bf16 v124, v238, v238
    v_dot2c_f32_bf16 v125, v239, v239
    ds_read_b64_tr_b16 v[108:109], v11 offset:0
    ds_read_b64_tr_b16 v[110:111], v11 offset:512
    s_waitcnt lgkmcnt(2)
    v_mfma_f32_32x32x16_bf16 v[32:47], v[28:31], v[232:235], v[32:47]
    s_add_u32 m0, s51, 73728
    s_mul_i32 s62, s4, 24576
    s_add_u32 s62, s62, s56
    buffer_load_dwordx4 v3, s[12:15], s62 offen lds
    s_waitcnt vmcnt(10)
    s_barrier
    v_add_u32 v12, 57344, v12
    v_add_u32 v13, 57344, v13
    v_add_u32 v14, 57344, v14
    v_add_u32 v15, 57344, v15
    ds_read_b128 v[240:243], v12 offset:8192
    ds_read_b128 v[244:247], v13 offset:8192
    ds_read_b128 v[248:251], v14 offset:8192
    ds_read_b128 v[252:255], v15 offset:8192
    ds_read_b64_tr_b16 v[20:21], v8 offset:24576
    ds_read_b64_tr_b16 v[22:23], v8 offset:25088
    s_waitcnt lgkmcnt(6)
    v_mfma_f32_32x32x16_bf16 v[32:47], v[108:111], v[236:239], v[32:47]
    s_add_u32 m0, s51, 81920
    s_mul_i32 s62, s5, 24576
    s_add_u32 s62, s62, s56
    buffer_load_dwordx4 v3, s[12:15], s62 offen lds
    s_waitcnt lgkmcnt(2)
    v_dot2c_f32_bf16 v124, v240, v240
    v_dot2c_f32_bf16 v125, v241, v241
    v_dot2c_f32_bf16 v124, v242, v242
    v_dot2c_f32_bf16 v125, v243, v243
    v_dot2c_f32_bf16 v124, v244, v244
    v_dot2c_f32_bf16 v125, v245, v245
    v_dot2c_f32_bf16 v124, v246, v246
    v_dot2c_f32_bf16 v125, v247, v247
    v_dot2c_f32_bf16 v124, v248, v248
    v_dot2c_f32_bf16 v125, v249, v249
    v_dot2c_f32_bf16 v124, v250, v250
    v_dot2c_f32_bf16 v125, v251, v251
    v_dot2c_f32_bf16 v124, v252, v252
    v_dot2c_f32_bf16 v125, v253, v253
    v_dot2c_f32_bf16 v124, v254, v254
    v_dot2c_f32_bf16 v125, v255, v255
    ds_read_b64_tr_b16 v[24:25], v9 offset:24576
    ds_read_b64_tr_b16 v[26:27], v9 offset:25088
    s_waitcnt lgkmcnt(2)
    v_mfma_f32_32x32x16_bf16 v[32:47], v[20:23], v[240:243], v[32:47]
    v_smfmac_f32_16x16x64_bf16 v[80:83], v[84:87], v[16:23], v103
    s_setprio 1
    s_add_u32 m0, s51, 90112
    s_mul_i32 s62, s6, 24576
    s_add_u32 s62, s62, s56
    buffer_load_dwordx4 v3, s[12:15], s62 offen lds
    ds_read_b64_tr_b16 v[28:29], v10 offset:24576
    ds_read_b64_tr_b16 v[30:31], v10 offset:25088
    s_waitcnt lgkmcnt(2)
    v_mfma_f32_32x32x16_bf16 v[32:47], v[24:27], v[244:247], v[32:47]
    s_add_u32 m0, s51, 98304
    s_mul_i32 s62, s7, 24576
    s_add_u32 s62, s62, s56
    buffer_load_dwordx4 v3, s[12:15], s62 offen lds
    v_add_f32 v124, v124, v125
    v_add_f32 v88, v88, v89
    v_lshlrev_b32 v125, 2, v0
    v_add_u32 v125, 147456, v125
    ds_write2st64_b32 v125, v124, v88 offset0:0 offset1:16
    v_and_b32 v124, 0xdf, v0
    v_lshlrev_b32 v124, 2, v124
    v_add_u32 v125, 147584, v124
    v_add_u32 v124, 147456, v124
    ds_read_b64_tr_b16 v[108:109], v11 offset:24576
    ds_read_b64_tr_b16 v[110:111], v11 offset:25088
    s_waitcnt lgkmcnt(3)
    v_mfma_f32_32x32x16_bf16 v[32:47], v[28:31], v[248:251], v[32:47]
    s_add_u32 m0, s51, 106496
    s_mul_i32 s62, s32, 24576
    s_add_u32 s62, s62, s56
    buffer_load_dwordx4 v3, s[12:15], s62 offen lds
    v_add_f32 v82, v80, v81
    ds_write_b32 v2, v82 offset:1024
    v_mov_b32 v80, 0
    v_mov_b32 v81, 0
    s_waitcnt vmcnt(12) lgkmcnt(0)
    s_barrier
    v_subrev_u32 v8, 114688, v8
    v_subrev_u32 v9, 114688, v9
    v_subrev_u32 v10, 114688, v10
    v_subrev_u32 v11, 114688, v11
    ds_read_b64_tr_b16 v[16:17], v8 offset:0
    ds_read_b64_tr_b16 v[18:19], v8 offset:512
    v_mfma_f32_32x32x16_bf16 v[32:47], v[108:111], v[252:255], v[32:47]
    s_add_u32 m0, s51, 114688
    s_mul_i32 s62, s33, 24576
    s_add_u32 s62, s62, s56
    buffer_load_dwordx4 v3, s[12:15], s62 offen lds
    ds_read_b64_tr_b16 v[24:25], v9 offset:0
    ds_read_b64_tr_b16 v[26:27], v9 offset:512
    ds_read2st64_b32 v[112:113], v124 offset0:16 offset1:20
    ds_read2st64_b32 v[116:117], v124 offset0:0 offset1:4
    ds_read2st64_b32 v[118:119], v125 offset0:0 offset1:4
    v_mov_b32 v99, 0
    v_cmp_gt_u32 vcc, 32, v1
    s_waitcnt lgkmcnt(0)
    v_add_f32 v116, v116, v118
    v_add_f32 v117, v117, v119
    v_add_f32 v112, v112, v113
    v_mfma_f32_32x32x16_bf16 v[48:63], v[128:131], v[16:19], 0
    s_setprio 0
    s_add_u32 m0, s51, 122880
    s_mul_i32 s62, s34, 24576
    s_add_u32 s62, s62, s56
    buffer_load_dwordx4 v3, s[12:15], s62 offen lds
    ds_read_b64_tr_b16 v[28:29], v10 offset:0
    ds_read_b64_tr_b16 v[30:31], v10 offset:512
    v_add_f32 v116, v116, v117
    v_mul_f32 v112, 0xbb000000, v112
    v_mul_f32 v116, 0x3b000000, v116
    v_fma_f32 v116, -v112, v112, v116
    v_and_b32 v113, 0xffff0000, v112
    v_max_f32 v116, 0, v116
    v_sub_f32 v112, v112, v113
    v_mfma_f32_32x32x16_bf16 v[48:63], v[132:135], v[24:27], v[48:63]
    s_lshr_b32 s73, s2, 6
    s_add_u32 s73, s73, s67
    s_and_b32 s73, s73, 3
    s_lshl_b32 s73, s73, 2
    s_lshr_b32 s73, 0x60416041, s73
    s_bfe_u32 s75, s73, 0x40000
    s_lshl_b32 s75, s75, 12
    s_bfe_u32 s63, s73, 0x40004
    s_lshl_b32 s63, s63, 12
    s_bfe_u32 s54, s73, 0x40008
    s_lshl_b32 s54, s54, 12
    s_bfe_u32 s53, s73, 0x4000c
    s_lshl_b32 s53, s53, 12
    ds_read_b64_tr_b16 v[108:109], v11 offset:0
    ds_read_b64_tr_b16 v[110:111], v11 offset:512
    v_add_f32 v116, 0x3727c5ac, v116
    v_cvt_pk_bf16_f32 v96, v113, v113
    v_rsq_f32 v120, v116
    v_sqrt_f32 v121, v116
    v_cndmask_b32 v96, 0, v96, vcc
    v_mul_f32 v116, v120, v120
    v_and_b32 v114, 0xffff0000, v121
    s_waitcnt lgkmcnt(2)
    v_mfma_f32_32x32x16_bf16 v[48:63], v[136:139], v[28:31], v[48:63]
    ds_read_b64_tr_b16 v[20:21], v8 offset:8192
    ds_read_b64_tr_b16 v[22:23], v8 offset:8704
    v_mul_f32 v122, 0xc0135761, v120
    v_sub_f32 v115, v121, v114
    v_cvt_pk_bf16_f32 v97, v112, v114
    v_mul_f32 v123, v122, v116
    v_cvt_pk_bf16_f32 v98, v115, v99
    v_mul_f32 v123, 0x3d372713, v123
    v_cndmask_b32 v97, 0, v97, vcc
    v_cndmask_b32 v98, 0, v98, vcc
    s_and_b32 s72, s50, 3
    s_lshl_b32 s72, s72, 7
    v_add_u32 v112, s72, v126
    s_waitcnt lgkmcnt(2)
    v_mfma_f32_32x32x16_bf16 v[48:63], v[140:143], v[108:111], v[48:63]
    ds_read_b64_tr_b16 v[24:25], v9 offset:8192
    ds_read_b64_tr_b16 v[26:27], v9 offset:8704
    v_add_u32 v127, s72, v127
    ds_write_b32 v112, v120 offset:2048
    ds_read2st64_b32 v[88:89], v126 offset0:36 offset1:44
    ds_read2st64_b32 v[90:91], v126 offset0:52 offset1:60
    v_mov_b32 v102, v92
    v_lshlrev_b32 v113, 16, v92
    s_waitcnt lgkmcnt(0)
    v_add_f32 v88, v88, v89
    v_add_f32 v90, v90, v91
    v_mfma_f32_32x32x16_bf16 v[48:63], v[144:147], v[20:23], v[48:63]
    v_smfmac_f32_16x16x64_bf16 v[80:83], v[84:87], v[16:23], v103
    s_setprio 1
    ds_read_b64_tr_b16 v[28:29], v10 offset:8192
    ds_read_b64_tr_b16 v[30:31], v10 offset:8704
    v_add_f32 v88, v88, v90
    v_and_b32 v112, 0xffff0000, v88
    v_sub_f32 v88, v88, v112
    v_cvt_pk_bf16_f32 v101, v112, v113
    v_cvt_pk_bf16_f32 v100, v112, v88
    s_nop 1
    v_mfma_f32_32x32x16_bf16 v[32:47], v[100:103], v[96:99], v[32:47]
    v_mfma_f32_32x32x16_bf16 v[48:63], v[148:151], v[24:27], v[48:63]
    ds_read_b64_tr_b16 v[108:109], v11 offset:8192
    ds_read_b64_tr_b16 v[110:111], v11 offset:8704
    s_waitcnt lgkmcnt(2)
    v_mfma_f32_32x32x16_bf16 v[48:63], v[152:155], v[28:31], v[48:63]
    s_cmp_lg_u32 s50, 0
    s_cbranch_scc1 L_ic_21
    s_mov_b32 s69, 0
    s_waitcnt vmcnt(10)
L_il_22:
    v_readfirstlane_b32 s72, v107
    s_nop 1
    s_cmp_ge_u32 s72, 8
    s_cbranch_scc1 L_ic_21
    s_add_u32 s69, s69, 1
    s_cmp_ge_u32 s69, 0x40000
    s_cbranch_scc1 L_ic_21
    buffer_load_dword v107, off, s[36:39], 0 sc1
    s_waitcnt vmcnt(0)
    s_branch L_il_22
L_ic_21:
    s_waitcnt vmcnt(12)
    s_barrier
    ds_read_b64_tr_b16 v[16:17], v8 offset:16384
    ds_read_b64_tr_b16 v[18:19], v8 offset:16896
    s_nop 0
    v_mul_f32 v116, v32, v32
    v_mul_f32 v117, v33, v33
    v_mul_f32 v118, v34, v34
    v_mul_f32 v119, v35, v35
    v_fma_f32 v116, v116, v123, v122
    v_fma_f32 v117, v117, v123, v122
    v_fma_f32 v118, v118, v123, v122
    s_waitcnt lgkmcnt(2)
    v_mfma_f32_32x32x16_bf16 v[48:63], v[156:159], v[108:111], v[48:63]
    s_lshl3_add_u32 s35, s2, s50
    s_mul_i32 s62, s35, 896
    v_lshlrev_b32 v124, 6, v1
    s_mov_b64 exec, 0x3fff
    buffer_load_dword v5, v124, s[20:23], s62 offen sc1
    s_lshl_b32 s62, s35, 8
    v_add_u32 v124, s62, v124
    s_mov_b64 exec, 15
    global_load_dword v5, v124, s[24:25] sc1
    s_mov_b64 exec, -1
    ds_read_b64_tr_b16 v[24:25], v9 offset:16384
    ds_read_b64_tr_b16 v[26:27], v9 offset:16896
    v_fma_f32 v119, v119, v123, v122
    v_mul_f32 v116, v32, v116
    v_mul_f32 v117, v33, v117
    v_mul_f32 v118, v34, v118
    v_mul_f32 v119, v35, v119
    v_exp_f32 v116, v116
    s_waitcnt lgkmcnt(2)
    v_mfma_f32_32x32x16_bf16 v[48:63], v[160:163], v[16:19], v[48:63]
    s_setprio 0
    ds_read_b64_tr_b16 v[28:29], v10 offset:16384
    ds_read_b64_tr_b16 v[30:31], v10 offset:16896
    v_exp_f32 v117, v117
    v_exp_f32 v118, v118
    v_exp_f32 v119, v119
    v_fma_f32 v116, v116, v121, v121
    v_fma_f32 v117, v117, v121, v121
    s_waitcnt lgkmcnt(2)
    v_mfma_f32_32x32x16_bf16 v[48:63], v[164:167], v[24:27], v[48:63]
    ds_read_b64_tr_b16 v[108:109], v11 offset:16384
    ds_read_b64_tr_b16 v[110:111], v11 offset:16896
    v_fma_f32 v118, v118, v121, v121
    v_fma_f32 v119, v119, v121, v121
    v_rcp_f32 v116, v116
    v_rcp_f32 v117, v117
    s_waitcnt lgkmcnt(2)
    v_mfma_f32_32x32x16_bf16 v[48:63], v[168:171], v[28:31], v[48:63]
    ds_read_b64_tr_b16 v[20:21], v8 offset:24576
    ds_read_b64_tr_b16 v[22:23], v8 offset:25088
    v_rcp_f32 v118, v118
    v_rcp_f32 v119, v119
    v_mul_f32 v112, v32, v116
    v_mul_f32 v113, v33, v117
    v_mul_f32 v114, v34, v118
    v_mul_f32 v115, v35, v119
    v_cvt_pk_bf16_f32 v104, v112, v113
    s_waitcnt lgkmcnt(2)
    v_mfma_f32_32x32x16_bf16 v[48:63], v[172:175], v[108:111], v[48:63]
    ds_read_b64_tr_b16 v[24:25], v9 offset:24576
    ds_read_b64_tr_b16 v[26:27], v9 offset:25088
    v_cvt_pk_bf16_f32 v105, v114, v115
    v_mul_f32 v116, v36, v36
    v_mul_f32 v117, v37, v37
    v_mul_f32 v118, v38, v38
    v_mul_f32 v119, v39, v39
    v_fma_f32 v116, v116, v123, v122
    v_fma_f32 v117, v117, v123, v122
    s_waitcnt lgkmcnt(2)
    v_mfma_f32_32x32x16_bf16 v[48:63], v[176:179], v[20:23], v[48:63]
    v_smfmac_f32_16x16x64_bf16 v[80:83], v[84:87], v[16:23], v103
    s_setprio 1
    ds_read_b64_tr_b16 v[28:29], v10 offset:24576
    ds_read_b64_tr_b16 v[30:31], v10 offset:25088
    v_fma_f32 v118, v118, v123, v122
    v_fma_f32 v119, v119, v123, v122
    v_mul_f32 v116, v36, v116
    v_mul_f32 v117, v37, v117
    v_mul_f32 v118, v38, v118
    v_mul_f32 v119, v39, v119
    v_exp_f32 v116, v116
    s_waitcnt lgkmcnt(2)
    v_mfma_f32_32x32x16_bf16 v[48:63], v[180:183], v[24:27], v[48:63]
    ds_read_b64_tr_b16 v[108:109], v11 offset:24576
    ds_read_b64_tr_b16 v[110:111], v11 offset:25088
    v_exp_f32 v117, v117
    v_exp_f32 v118, v118
    v_exp_f32 v119, v119
    v_fma_f32 v116, v116, v121, v121
    s_waitcnt lgkmcnt(2)
    v_mfma_f32_32x32x16_bf16 v[48:63], v[184:187], v[28:31], v[48:63]
    s_waitcnt vmcnt(12)
    s_barrier
    ds_read_b64_tr_b16 v[16:17], v8 offset:32768
    ds_read_b64_tr_b16 v[18:19], v8 offset:33280
    v_fma_f32 v117, v117, v121, v121
    v_fma_f32 v118, v118, v121, v121
    v_fma_f32 v119, v119, v121, v121
    v_rcp_f32 v116, v116
    v_rcp_f32 v117, v117
    s_waitcnt lgkmcnt(2)
    v_mfma_f32_32x32x16_bf16 v[48:63], v[188:191], v[108:111], v[48:63]
    ds_read_b64_tr_b16 v[24:25], v9 offset:32768
    ds_read_b64_tr_b16 v[26:27], v9 offset:33280
    v_rcp_f32 v118, v118
    v_rcp_f32 v119, v119
    v_mul_f32 v112, v36, v116
    v_mul_f32 v113, v37, v117
    v_mul_f32 v114, v38, v118
    v_mul_f32 v115, v39, v119
    s_waitcnt lgkmcnt(2)
    v_mfma_f32_32x32x16_bf16 v[48:63], v[192:195], v[16:19], v[48:63]
    s_setprio 0
    s_add_u32 m0, s51, 0
    s_lshl4_add_u32 s62, s75, 0
    buffer_load_dwordx4 v6, s[20:23], s62 offen lds
    ds_read_b64_tr_b16 v[28:29], v10 offset:32768
    ds_read_b64_tr_b16 v[30:31], v10 offset:33280
    v_cvt_pk_bf16_f32 v106, v112, v113
    v_cvt_pk_bf16_f32 v107, v114, v115
    buffer_store_dwordx4 v[104:107], v7, s[28:31], s60 offen offset:0 sc1
    v_mul_f32 v116, v40, v40
    v_mul_f32 v117, v41, v41
    v_mul_f32 v118, v42, v42
    s_waitcnt lgkmcnt(2)
    v_mfma_f32_32x32x16_bf16 v[48:63], v[196:199], v[24:27], v[48:63]
    ds_read_b64_tr_b16 v[108:109], v11 offset:32768
    ds_read_b64_tr_b16 v[110:111], v11 offset:33280
    v_mul_f32 v119, v43, v43
    v_fma_f32 v116, v116, v123, v122
    v_fma_f32 v117, v117, v123, v122
    v_fma_f32 v118, v118, v123, v122
    v_fma_f32 v119, v119, v123, v122
    v_mul_f32 v116, v40, v116
    s_waitcnt lgkmcnt(2)
    v_mfma_f32_32x32x16_bf16 v[48:63], v[200:203], v[28:31], v[48:63]
    s_add_u32 m0, s51, 8192
    s_lshl4_add_u32 s62, s75, 458752
    buffer_load_dwordx4 v6, s[20:23], s62 offen lds
    ds_read_b64_tr_b16 v[20:21], v8 offset:40960
    ds_read_b64_tr_b16 v[22:23], v8 offset:41472
    v_mul_f32 v117, v41, v117
    v_mul_f32 v118, v42, v118
    v_mul_f32 v119, v43, v119
    v_exp_f32 v116, v116
    v_exp_f32 v117, v117
    s_waitcnt lgkmcnt(2)
    v_mfma_f32_32x32x16_bf16 v[48:63], v[204:207], v[108:111], v[48:63]
    ds_read_b64_tr_b16 v[24:25], v9 offset:40960
    ds_read_b64_tr_b16 v[26:27], v9 offset:41472
    v_exp_f32 v118, v118
    v_exp_f32 v119, v119
    v_fma_f32 v116, v116, v121, v121
    v_fma_f32 v117, v117, v121, v121
    v_fma_f32 v118, v118, v121, v121
    s_waitcnt lgkmcnt(2)
    v_mfma_f32_32x32x16_bf16 v[48:63], v[208:211], v[20:23], v[48:63]
    v_smfmac_f32_16x16x64_bf16 v[80:83], v[84:87], v[16:23], v103
    s_setprio 1
    ds_read_b64_tr_b16 v[28:29], v10 offset:40960
    ds_read_b64_tr_b16 v[30:31], v10 offset:41472
    v_fma_f32 v119, v119, v121, v121
    v_rcp_f32 v116, v116
    v_rcp_f32 v117, v117
    v_rcp_f32 v118, v118
    v_rcp_f32 v119, v119
    s_waitcnt lgkmcnt(2)
    v_mfma_f32_32x32x16_bf16 v[48:63], v[212:215], v[24:27], v[48:63]
    ds_read_b64_tr_b16 v[108:109], v11 offset:40960
    ds_read_b64_tr_b16 v[110:111], v11 offset:41472
    v_mul_f32 v112, v40, v116
    v_mul_f32 v113, v41, v117
    v_mul_f32 v114, v42, v118
    v_mul_f32 v115, v43, v119
    v_cvt_pk_bf16_f32 v104, v112, v113
    v_cvt_pk_bf16_f32 v105, v114, v115
    v_mul_f32 v116, v44, v44
    v_mul_f32 v117, v45, v45
    s_waitcnt lgkmcnt(2)
    v_mfma_f32_32x32x16_bf16 v[48:63], v[216:219], v[28:31], v[48:63]
    s_waitcnt vmcnt(13)
    s_barrier
    ds_read_b64_tr_b16 v[16:17], v8 offset:49152
    ds_read_b64_tr_b16 v[18:19], v8 offset:49664
    v_mul_f32 v118, v46, v46
    v_mul_f32 v119, v47, v47
    v_fma_f32 v116, v116, v123, v122
    v_fma_f32 v117, v117, v123, v122
    v_fma_f32 v118, v118, v123, v122
    v_fma_f32 v119, v119, v123, v122
    s_waitcnt lgkmcnt(2)
    v_mfma_f32_32x32x16_bf16 v[48:63], v[220:223], v[108:111], v[48:63]
    ds_read_b64_tr_b16 v[24:25], v9 offset:49152
    ds_read_b64_tr_b16 v[26:27], v9 offset:49664
    v_mul_f32 v116, v44, v116
    v_mul_f32 v117, v45, v117
    v_mul_f32 v118, v46, v118
    v_mul_f32 v119, v47, v119
    v_exp_f32 v116, v116
    v_exp_f32 v117, v117
    v_exp_f32 v118, v118
    s_waitcnt lgkmcnt(2)
    v_mfma_f32_32x32x16_bf16 v[48:63], v[224:227], v[16:19], v[48:63]
    s_setprio 0
    s_add_u32 m0, s51, 16384
    s_lshl4_add_u32 s62, s75, 917504
    buffer_load_dwordx4 v6, s[20:23], s62 offen lds
    ds_read_b64_tr_b16 v[28:29], v10 offset:49152
    ds_read_b64_tr_b16 v[30:31], v10 offset:49664
    v_exp_f32 v119, v119
    v_fma_f32 v116, v116, v121, v121
    v_fma_f32 v117, v117, v121, v121
    v_fma_f32 v118, v118, v121, v121
    s_waitcnt lgkmcnt(2)
    v_mfma_f32_32x32x16_bf16 v[48:63], v[228:231], v[24:27], v[48:63]
    ds_read_b64_tr_b16 v[108:109], v11 offset:49152
    ds_read_b64_tr_b16 v[110:111], v11 offset:49664
    v_fma_f32 v119, v119, v121, v121
    v_rcp_f32 v116, v116
    v_rcp_f32 v117, v117
    v_rcp_f32 v118, v118
    v_rcp_f32 v119, v119
    s_waitcnt lgkmcnt(2)
    v_mfma_f32_32x32x16_bf16 v[48:63], v[232:235], v[28:31], v[48:63]
    s_add_u32 m0, s51, 24576
    s_lshl4_add_u32 s62, s75, 1376256
    buffer_load_dwordx4 v6, s[20:23], s62 offen lds
    v_add_u32 v8, 57344, v8
    v_add_u32 v9, 57344, v9
    v_add_u32 v10, 57344, v10
    v_add_u32 v11, 57344, v11
    ds_read_b64_tr_b16 v[20:21], v8 offset:0
    ds_read_b64_tr_b16 v[22:23], v8 offset:512
    v_mul_f32 v112, v44, v116
    v_mul_f32 v113, v45, v117
    v_mul_f32 v114, v46, v118
    v_mul_f32 v115, v47, v119
    v_cvt_pk_bf16_f32 v106, v112, v113
    v_cvt_pk_bf16_f32 v107, v114, v115
    buffer_store_dwordx4 v[104:107], v7, s[28:31], s60 offen offset:1024 sc1
    s_waitcnt lgkmcnt(2)
    v_mfma_f32_32x32x16_bf16 v[48:63], v[236:239], v[108:111], v[48:63]
    ds_read_b64_tr_b16 v[24:25], v9 offset:0
    ds_read_b64_tr_b16 v[26:27], v9 offset:512
    s_waitcnt lgkmcnt(2)
    v_mfma_f32_32x32x16_bf16 v[48:63], v[240:243], v[20:23], v[48:63]
    v_smfmac_f32_16x16x64_bf16 v[80:83], v[84:87], v[16:23], v103
    s_setprio 1
    ds_read_b64_tr_b16 v[28:29], v10 offset:0
    ds_read_b64_tr_b16 v[30:31], v10 offset:512
    s_waitcnt lgkmcnt(2)
    v_mfma_f32_32x32x16_bf16 v[48:63], v[244:247], v[24:27], v[48:63]
    ds_read_b64_tr_b16 v[108:109], v11 offset:0
    ds_read_b64_tr_b16 v[110:111], v11 offset:512
    s_waitcnt lgkmcnt(2)
    v_mfma_f32_32x32x16_bf16 v[48:63], v[248:251], v[28:31], v[48:63]
    s_nop 2
    v_add_f32 v82, v80, v81
    ds_write_b32 v2, v82 offset:0
    v_mov_b32 v80, 0
    v_mov_b32 v81, 0
    s_waitcnt vmcnt(14) lgkmcnt(0)
    s_barrier
    ds_read_b64_tr_b16 v[16:17], v8 offset:8192
    ds_read_b64_tr_b16 v[18:19], v8 offset:8704
    v_mfma_f32_32x32x16_bf16 v[48:63], v[252:255], v[108:111], v[48:63]
    ds_read_b64_tr_b16 v[24:25], v9 offset:8192
    ds_read_b64_tr_b16 v[26:27], v9 offset:8704
    ds_read2st64_b32 v[88:89], v126 offset0:32 offset1:40
    ds_read2st64_b32 v[90:91], v126 offset0:48 offset1:56
    v_mov_b32 v102, 0x3586
    v_mov_b32 v113, 0x35860000
    s_waitcnt lgkmcnt(4)
    v_mfma_f32_32x32x16_bf16 v[32:47], v[128:131], v[16:19], 0
    s_setprio 0
    s_add_u32 m0, s51, 32768
    s_lshl4_add_u32 s62, s63, 0
    buffer_load_dwordx4 v6, s[20:23], s62 offen lds
    ds_read_b64_tr_b16 v[28:29], v10 offset:8192
    ds_read_b64_tr_b16 v[30:31], v10 offset:8704
    s_waitcnt lgkmcnt(2)
    v_add_f32 v88, v88, v89
    v_add_f32 v90, v90, v91
    v_add_f32 v88, v88, v90
    v_and_b32 v112, 0xffff0000, v88
    v_mfma_f32_32x32x16_bf16 v[32:47], v[132:135], v[24:27], v[32:47]
    ds_read_b64_tr_b16 v[108:109], v11 offset:8192
    ds_read_b64_tr_b16 v[110:111], v11 offset:8704
    v_sub_f32 v88, v88, v112
    v_cvt_pk_bf16_f32 v101, v112, v113
    v_cvt_pk_bf16_f32 v100, v112, v88
    s_waitcnt lgkmcnt(2)
    v_mfma_f32_32x32x16_bf16 v[32:47], v[136:139], v[28:31], v[32:47]
    s_add_u32 m0, s51, 40960
    s_lshl4_add_u32 s62, s63, 458752
    buffer_load_dwordx4 v6, s[20:23], s62 offen lds
    ds_read_b64_tr_b16 v[20:21], v8 offset:16384
    ds_read_b64_tr_b16 v[22:23], v8 offset:16896
    v_mfma_f32_32x32x16_bf16 v[48:63], v[96:99], v[100:103], v[48:63]
    s_waitcnt lgkmcnt(2)
    v_mfma_f32_32x32x16_bf16 v[32:47], v[140:143], v[108:111], v[32:47]
    ds_read_b64_tr_b16 v[24:25], v9 offset:16384
    ds_read_b64_tr_b16 v[26:27], v9 offset:16896
    ds_read_b128 v[92:95], v127 offset:2048
    ds_read_b128 v[88:91], v127 offset:2080
    s_waitcnt lgkmcnt(4)
    v_mfma_f32_32x32x16_bf16 v[32:47], v[144:147], v[20:23], v[32:47]
    v_smfmac_f32_16x16x64_bf16 v[80:83], v[84:87], v[16:23], v103
    s_setprio 1
    ds_read_b64_tr_b16 v[28:29], v10 offset:16384
    ds_read_b64_tr_b16 v[30:31], v10 offset:16896
    s_waitcnt lgkmcnt(3)
    v_mul_f32 v112, v48, v92
    v_mul_f32 v113, v49, v93
    v_mfma_f32_32x32x16_bf16 v[32:47], v[148:151], v[24:27], v[32:47]
    ds_read_b64_tr_b16 v[108:109], v11 offset:16384
    ds_read_b64_tr_b16 v[110:111], v11 offset:16896
    v_mul_f32 v114, v50, v94
    v_mul_f32 v115, v51, v95
    v_mul_f32 v116, s64, v112
    v_mul_f32 v117, s64, v113
    v_mul_f32 v118, s64, v114
    s_waitcnt lgkmcnt(2)
    v_mfma_f32_32x32x16_bf16 v[32:47], v[152:155], v[28:31], v[32:47]
    s_waitcnt vmcnt(2)
    s_barrier
    s_cmp_lg_u32 s50, 1
    s_cbranch_scc1 L_pub_23
    v_mov_b32 v104, 1
    s_mov_b64 exec, 1
    buffer_store_dword v104, off, s[28:31], s68 sc1
    s_mov_b64 exec, -1
L_pub_23:
    ds_read_b64_tr_b16 v[16:17], v8 offset:24576
    ds_read_b64_tr_b16 v[18:19], v8 offset:25088
    v_mul_f32 v119, s64, v115
    v_max_f32 v112, s65, v112
    v_max_f32 v113, s65, v113
    v_max_f32 v114, s65, v114
    v_max_f32 v115, s65, v115
    s_waitcnt lgkmcnt(2)
    v_mfma_f32_32x32x16_bf16 v[32:47], v[156:159], v[108:111], v[32:47]
    ds_read_b64_tr_b16 v[24:25], v9 offset:24576
    ds_read_b64_tr_b16 v[26:27], v9 offset:25088
    v_exp_f32 v116, v116 clamp
    v_exp_f32 v117, v117 clamp
    v_exp_f32 v118, v118 clamp
    s_waitcnt lgkmcnt(2)
    v_mfma_f32_32x32x16_bf16 v[32:47], v[160:163], v[16:19], v[32:47]
    s_setprio 0
    s_add_u32 m0, s51, 49152
    s_lshl4_add_u32 s62, s63, 917504
    buffer_load_dwordx4 v6, s[20:23], s62 offen lds
    ds_read_b64_tr_b16 v[28:29], v10 offset:24576
    ds_read_b64_tr_b16 v[30:31], v10 offset:25088
    v_exp_f32 v119, v119 clamp
    s_waitcnt lgkmcnt(2)
    v_mfma_f32_32x32x16_bf16 v[32:47], v[164:167], v[24:27], v[32:47]
    ds_read_b64_tr_b16 v[108:109], v11 offset:24576
    ds_read_b64_tr_b16 v[110:111], v11 offset:25088
    v_add_f32 v112, v112, v116
    v_add_f32 v113, v113, v117
    v_add_f32 v114, v114, v118
    v_add_f32 v115, v115, v119
    v_cvt_pk_bf16_f32 v64, v112, v113
    s_waitcnt lgkmcnt(2)
    v_mfma_f32_32x32x16_bf16 v[32:47], v[168:171], v[28:31], v[32:47]
    s_add_u32 m0, s51, 57344
    s_lshl4_add_u32 s62, s63, 1376256
    buffer_load_dwordx4 v6, s[20:23], s62 offen lds
    ds_read_b64_tr_b16 v[20:21], v8 offset:32768
    ds_read_b64_tr_b16 v[22:23], v8 offset:33280
    v_cvt_pk_bf16_f32 v65, v114, v115
    v_add_f32 v112, v112, v113
    v_add_f32 v114, v114, v115
    v_add_f32 v125, v112, v114
    ds_read_b128 v[92:95], v127 offset:2112
    s_waitcnt lgkmcnt(3)
    v_mfma_f32_32x32x16_bf16 v[32:47], v[172:175], v[108:111], v[32:47]
    ds_read_b64_tr_b16 v[24:25], v9 offset:32768
    ds_read_b64_tr_b16 v[26:27], v9 offset:33280
    v_mul_f32 v112, v52, v88
    v_mul_f32 v113, v53, v89
    v_mul_f32 v114, v54, v90
    v_mul_f32 v115, v55, v91
    v_mul_f32 v116, s64, v112
    s_waitcnt lgkmcnt(3)
    v_mfma_f32_32x32x16_bf16 v[32:47], v[176:179], v[20:23], v[32:47]
    v_smfmac_f32_16x16x64_bf16 v[80:83], v[84:87], v[16:23], v103
    s_setprio 1
    ds_read_b64_tr_b16 v[28:29], v10 offset:32768
    ds_read_b64_tr_b16 v[30:31], v10 offset:33280
    v_mul_f32 v117, s64, v113
    v_mul_f32 v118, s64, v114
    v_mul_f32 v119, s64, v115
    v_max_f32 v112, s65, v112
    s_waitcnt lgkmcnt(2)
    v_mfma_f32_32x32x16_bf16 v[32:47], v[180:183], v[24:27], v[32:47]
    ds_read_b64_tr_b16 v[108:109], v11 offset:32768
    ds_read_b64_tr_b16 v[110:111], v11 offset:33280
    v_max_f32 v113, s65, v113
    v_max_f32 v114, s65, v114
    v_max_f32 v115, s65, v115
    v_exp_f32 v116, v116 clamp
    s_waitcnt lgkmcnt(2)
    v_mfma_f32_32x32x16_bf16 v[32:47], v[184:187], v[28:31], v[32:47]
    s_barrier
    ds_read_b64_tr_b16 v[16:17], v8 offset:40960
    ds_read_b64_tr_b16 v[18:19], v8 offset:41472
    v_exp_f32 v117, v117 clamp
    v_exp_f32 v118, v118 clamp
    v_exp_f32 v119, v119 clamp
    s_waitcnt lgkmcnt(2)
    v_mfma_f32_32x32x16_bf16 v[32:47], v[188:191], v[108:111], v[32:47]
    ds_read_b64_tr_b16 v[24:25], v9 offset:40960
    ds_read_b64_tr_b16 v[26:27], v9 offset:41472
    v_add_f32 v112, v112, v116
    v_add_f32 v113, v113, v117
    v_add_f32 v114, v114, v118
    v_add_f32 v115, v115, v119
    s_waitcnt lgkmcnt(2)
    v_mfma_f32_32x32x16_bf16 v[32:47], v[192:195], v[16:19], v[32:47]
    s_setprio 0
    s_add_u32 m0, s51, 65536
    s_lshl4_add_u32 s62, s54, 0
    buffer_load_dwordx4 v6, s[20:23], s62 offen lds
    ds_read_b64_tr_b16 v[28:29], v10 offset:40960
    ds_read_b64_tr_b16 v[30:31], v10 offset:41472
    v_cvt_pk_bf16_f32 v66, v112, v113
    v_cvt_pk_bf16_f32 v67, v114, v115
    v_add_f32 v112, v112, v113
    v_add_f32 v114, v114, v115
    s_waitcnt lgkmcnt(2)
    v_mfma_f32_32x32x16_bf16 v[32:47], v[196:199], v[24:27], v[32:47]
    ds_read_b64_tr_b16 v[108:109], v11 offset:40960
    ds_read_b64_tr_b16 v[110:111], v11 offset:41472
    v_add_f32 v112, v112, v114
    v_add_f32 v125, v125, v112
    ds_read_b128 v[88:91], v127 offset:2144
    v_mul_f32 v112, v56, v92
    v_mul_f32 v113, v57, v93
    v_mul_f32 v114, v58, v94
    s_waitcnt lgkmcnt(3)
    v_mfma_f32_32x32x16_bf16 v[32:47], v[200:203], v[28:31], v[32:47]
    s_add_u32 m0, s51, 73728
    s_lshl4_add_u32 s62, s54, 458752
    buffer_load_dwordx4 v6, s[20:23], s62 offen lds
    ds_read_b64_tr_b16 v[20:21], v8 offset:49152
    ds_read_b64_tr_b16 v[22:23], v8 offset:49664
    v_mul_f32 v115, v59, v95
    v_mul_f32 v116, s64, v112
    v_mul_f32 v117, s64, v113
    v_mul_f32 v118, s64, v114
    s_waitcnt lgkmcnt(3)
    v_mfma_f32_32x32x16_bf16 v[32:47], v[204:207], v[108:111], v[32:47]
    ds_read_b64_tr_b16 v[24:25], v9 offset:49152
    ds_read_b64_tr_b16 v[26:27], v9 offset:49664
    v_mul_f32 v119, s64, v115
    v_max_f32 v112, s65, v112
    v_max_f32 v113, s65, v113
    v_max_f32 v114, s65, v114
    v_max_f32 v115, s65, v115
    s_waitcnt lgkmcnt(2)
    v_mfma_f32_32x32x16_bf16 v[32:47], v[208:211], v[20:23], v[32:47]
    v_smfmac_f32_16x16x64_bf16 v[80:83], v[84:87], v[16:23], v103
    s_setprio 1
    ds_read_b64_tr_b16 v[28:29], v10 offset:49152
    ds_read_b64_tr_b16 v[30:31], v10 offset:49664
    v_exp_f32 v116, v116 clamp
    v_exp_f32 v117, v117 clamp
    v_exp_f32 v118, v118 clamp
    s_waitcnt lgkmcnt(2)
    v_mfma_f32_32x32x16_bf16 v[32:47], v[212:215], v[24:27], v[32:47]
    ds_read_b64_tr_b16 v[108:109], v11 offset:49152
    ds_read_b64_tr_b16 v[110:111], v11 offset:49664
    v_exp_f32 v119, v119 clamp
    v_add_f32 v112, v112, v116
    s_waitcnt lgkmcnt(2)
    v_mfma_f32_32x32x16_bf16 v[32:47], v[216:219], v[28:31], v[32:47]
    s_barrier
    v_add_u32 v8, 57344, v8
    v_add_u32 v9, 57344, v9
    v_add_u32 v10, 57344, v10
    v_add_u32 v11, 57344, v11
    ds_read_b64_tr_b16 v[16:17], v8 offset:0
    ds_read_b64_tr_b16 v[18:19], v8 offset:512
    v_add_f32 v113, v113, v117
    v_add_f32 v114, v114, v118
    v_add_f32 v115, v115, v119
    v_cvt_pk_bf16_f32 v68, v112, v113
    v_cvt_pk_bf16_f32 v69, v114, v115
    s_waitcnt lgkmcnt(2)
    v_mfma_f32_32x32x16_bf16 v[32:47], v[220:223], v[108:111], v[32:47]
    ds_read_b64_tr_b16 v[24:25], v9 offset:0
    ds_read_b64_tr_b16 v[26:27], v9 offset:512
    v_add_f32 v112, v112, v113
    v_add_f32 v114, v114, v115
    v_add_f32 v112, v112, v114
    v_add_f32 v125, v125, v112
    v_mul_f32 v112, v60, v88
    s_waitcnt lgkmcnt(2)
    v_mfma_f32_32x32x16_bf16 v[32:47], v[224:227], v[16:19], v[32:47]
    s_setprio 0
    s_add_u32 m0, s51, 81920
    s_lshl4_add_u32 s62, s54, 917504
    buffer_load_dwordx4 v6, s[20:23], s62 offen lds
    ds_read_b64_tr_b16 v[28:29], v10 offset:0
    ds_read_b64_tr_b16 v[30:31], v10 offset:512
    v_mul_f32 v113, v61, v89
    v_mul_f32 v114, v62, v90
    v_mul_f32 v115, v63, v91
    v_mul_f32 v116, s64, v112
    s_waitcnt lgkmcnt(2)
    v_mfma_f32_32x32x16_bf16 v[32:47], v[228:231], v[24:27], v[32:47]
    ds_read_b64_tr_b16 v[108:109], v11 offset:0
    ds_read_b64_tr_b16 v[110:111], v11 offset:512
    v_mul_f32 v117, s64, v113
    v_mul_f32 v118, s64, v114
    v_mul_f32 v119, s64, v115
    v_max_f32 v112, s65, v112
    v_max_f32 v113, s65, v113
    v_max_f32 v114, s65, v114
    s_waitcnt lgkmcnt(2)
    v_mfma_f32_32x32x16_bf16 v[32:47], v[232:235], v[28:31], v[32:47]
    s_add_u32 m0, s51, 90112
    s_lshl4_add_u32 s62, s54, 1376256
    buffer_load_dwordx4 v6, s[20:23], s62 offen lds
    ds_read_b64_tr_b16 v[20:21], v8 offset:8192
    ds_read_b64_tr_b16 v[22:23], v8 offset:8704
    v_max_f32 v115, s65, v115
    v_exp_f32 v116, v116 clamp
    v_exp_f32 v117, v117 clamp
    s_waitcnt lgkmcnt(2)
    v_mfma_f32_32x32x16_bf16 v[32:47], v[236:239], v[108:111], v[32:47]
    ds_read_b64_tr_b16 v[24:25], v9 offset:8192
    ds_read_b64_tr_b16 v[26:27], v9 offset:8704
    v_exp_f32 v118, v118 clamp
    v_exp_f32 v119, v119 clamp
    s_waitcnt lgkmcnt(2)
    v_mfma_f32_32x32x16_bf16 v[32:47], v[240:243], v[20:23], v[32:47]
    v_smfmac_f32_16x16x64_bf16 v[80:83], v[84:87], v[16:23], v103
    s_setprio 1
    ds_read_b64_tr_b16 v[28:29], v10 offset:8192
    ds_read_b64_tr_b16 v[30:31], v10 offset:8704
    v_add_f32 v112, v112, v116
    v_add_f32 v113, v113, v117
    v_add_f32 v114, v114, v118
    v_add_f32 v115, v115, v119
    v_cvt_pk_bf16_f32 v70, v112, v113
    v_cvt_pk_bf16_f32 v71, v114, v115
    s_waitcnt lgkmcnt(2)
    v_mfma_f32_32x32x16_bf16 v[32:47], v[244:247], v[24:27], v[32:47]
    ds_read_b64_tr_b16 v[108:109], v11 offset:8192
    ds_read_b64_tr_b16 v[110:111], v11 offset:8704
    v_add_f32 v112, v112, v113
    v_add_f32 v114, v114, v115
    v_add_f32 v112, v112, v114
    v_add_f32 v125, v125, v112
    v_lshlrev_b32 v112, 2, v0
    v_add_u32 v112, 147456, v112
    ds_write_b32 v112, v125
    s_waitcnt lgkmcnt(3)
    v_mfma_f32_32x32x16_bf16 v[32:47], v[248:251], v[28:31], v[32:47]
    v_add_f32 v82, v80, v81
    ds_write_b32 v2, v82 offset:512
    v_mov_b32 v80, 0
    v_mov_b32 v81, 0
    s_waitcnt lgkmcnt(0)
    s_barrier
    ds_read2st64_b32 v[88:89], v126 offset0:34 offset1:42
    ds_read2st64_b32 v[90:91], v126 offset0:50 offset1:58
    v_mov_b32 v102, 0x0
    v_mov_b32 v113, 0x0
    v_mfma_f32_32x32x16_bf16 v[32:47], v[252:255], v[108:111], v[32:47]
    s_setprio 0
    s_waitcnt lgkmcnt(0)
    v_add_f32 v88, v88, v89
    v_add_f32 v90, v90, v91
    v_add_f32 v88, v88, v90
    v_and_b32 v112, 0xffff0000, v88
    v_sub_f32 v88, v88, v112
    v_cvt_pk_bf16_f32 v101, v112, v113
    v_cvt_pk_bf16_f32 v100, v112, v88
    s_nop 1
    v_mfma_f32_32x32x16_bf16 v[32:47], v[96:99], v[100:103], v[32:47]
    s_add_u32 m0, s51, 98304
    s_lshl4_add_u32 s62, s53, 0
    buffer_load_dwordx4 v6, s[20:23], s62 offen lds
    s_add_u32 m0, s51, 106496
    s_lshl4_add_u32 s62, s53, 458752
    buffer_load_dwordx4 v6, s[20:23], s62 offen lds
    v_lshrrev_b32 v8, 5, v1
    v_lshlrev_b32 v8, 9, v8
    v_bfe_u32 v112, v1, 2, 2
    v_lshl_add_u32 v8, v112, 7, v8
    v_bfe_u32 v112, v1, 3, 1
    v_lshl_add_u32 v8, v112, 6, v8
    v_bfe_u32 v112, v1, 4, 1
    v_lshl_add_u32 v8, v112, 5, v8
    v_bfe_u32 v112, v1, 0, 2
    v_lshl_add_u32 v8, v112, 3, v8
    s_and_b32 s72, s50, 3
    s_lshl_b32 s72, s72, 13
    v_add_u32 v8, s72, v8
    v_xor_b32 v9, 64, v8
    v_add_u32 v10, 0x10000, v8
    v_add_u32 v11, 0x10000, v9
    ds_read_b128 v[92:95], v127 offset:2048
    ds_read_b128 v[88:91], v127 offset:2080
    s_waitcnt lgkmcnt(1)
    v_mul_f32 v112, v32, v92
    v_mul_f32 v113, v33, v93
    v_mul_f32 v114, v34, v94
    v_mul_f32 v115, v35, v95
    v_cvt_pk_bf16_f32 v72, v112, v113
    v_cvt_pk_bf16_f32 v73, v114, v115
    ds_read_b128 v[92:95], v127 offset:2112
    s_waitcnt lgkmcnt(1)
    v_mul_f32 v112, v36, v88
    v_mul_f32 v113, v37, v89
    v_mul_f32 v114, v38, v90
    v_mul_f32 v115, v39, v91
    v_cvt_pk_bf16_f32 v74, v112, v113
    v_cvt_pk_bf16_f32 v75, v114, v115
    ds_read_b128 v[88:91], v127 offset:2144
    s_waitcnt lgkmcnt(1)
    v_mul_f32 v112, v40, v92
    v_mul_f32 v113, v41, v93
    v_mul_f32 v114, v42, v94
    v_mul_f32 v115, v43, v95
    v_cvt_pk_bf16_f32 v76, v112, v113
    v_cvt_pk_bf16_f32 v77, v114, v115
    s_waitcnt lgkmcnt(0)
    v_mul_f32 v112, v44, v88
    v_mul_f32 v113, v45, v89
    v_mul_f32 v114, v46, v90
    v_mul_f32 v115, v47, v91
    v_cvt_pk_bf16_f32 v78, v112, v113
    v_cvt_pk_bf16_f32 v79, v114, v115
    v_mfma_f32_32x32x16_bf16 v[88:103], v[64:67], v[72:75], 0
    s_nop 0
    v_mfma_f32_32x32x16_bf16 v[88:103], v[68:71], v[76:79], v[88:103]
    v_lshlrev_b32 v112, 2, v1
    s_lshl_b32 s72, s51, 1
    s_add_u32 s72, s72, 131072
    v_add_u32 v112, s72, v112
    s_lshr_b32 s72, s50, 1
    s_and_b32 s73, s50, 1
    v_and_b32 v116, 3, v1
    v_lshlrev_b32 v116, 8, v116
    v_and_b32 v117, 0x3c, v1
    v_add_u32 v116, v116, v117
    s_lshr_b32 s69, s50, 2
    s_lshl_b32 s69, s69, 13
    s_lshl_b32 s62, s73, 10
    s_add_u32 s69, s69, s62
    s_and_b32 s62, s72, 1
    s_lshl_b32 s62, s62, 6
    s_add_u32 s69, s69, s62
    s_add_u32 s69, s69, 131072
    v_add_u32 v116, s69, v116
    v_add_u32 v117, 128, v116
    v_and_b32 v118, 31, v1
    v_lshrrev_b32 v119, 5, v1
    v_lshl_add_u32 v118, v119, 8, v118
    v_lshlrev_b32 v118, 2, v118
    v_add_u32 v118, 147456, v118
    v_cndmask_b32 v88, v96, v88, s[48:49]
    v_cndmask_b32 v89, v97, v89, s[48:49]
    v_cndmask_b32 v90, v98, v90, s[48:49]
    v_cndmask_b32 v91, v99, v91, s[48:49]
    v_cndmask_b32 v92, v100, v92, s[48:49]
    v_cndmask_b32 v93, v101, v93, s[48:49]
    v_cndmask_b32 v94, v102, v94, s[48:49]
    v_cndmask_b32 v95, v103, v95, s[48:49]
    ds_write2st64_b32 v112, v88, v89 offset0:0 offset1:1
    ds_write2st64_b32 v112, v90, v91 offset0:2 offset1:3
    ds_write2st64_b32 v112, v92, v93 offset0:4 offset1:5
    ds_write2st64_b32 v112, v94, v95 offset0:6 offset1:7
    s_waitcnt lgkmcnt(0)
    s_barrier
    ds_read2st64_b32 v[48:49], v116 offset0:0 offset1:8
    ds_read2st64_b32 v[50:51], v116 offset0:16 offset1:24
    ds_read2st64_b32 v[52:53], v117 offset0:0 offset1:8
    ds_read2st64_b32 v[54:55], v117 offset0:16 offset1:24
    ds_read2_b32 v[56:57], v118 offset0:0 offset1:32
    ds_read2_b32 v[58:59], v118 offset0:64 offset1:96
    ds_read2_b32 v[60:61], v118 offset0:128 offset1:160
    ds_read2_b32 v[62:63], v118 offset0:192 offset1:224
    s_lshl_b32 s72, s72, 11
    s_lshl_b32 s73, s73, 9
    s_add_u32 s72, s72, s73
    s_add_u32 s72, s72, s71
    v_lshlrev_b32 v112, 2, v1
    v_lshrrev_b32 v114, 4, v1
    v_and_b32 v115, 15, v1
    v_lshlrev_b32 v115, 2, v115
    v_lshl_add_u32 v115, v114, 11, v115
    s_waitcnt lgkmcnt(4)
    v_add_f32 v48, v48, v49
    v_add_f32 v50, v50, v51
    v_add_f32 v48, v48, v50
    buffer_atomic_add_f32 v48, v112, s[28:31], s72 offen offset:0
    v_add_f32 v52, v52, v53
    v_add_f32 v54, v54, v55
    v_add_f32 v52, v52, v54
    buffer_atomic_add_f32 v52, v112, s[28:31], s72 offen offset:256
    s_waitcnt lgkmcnt(0)
    v_add_f32 v56, v56, v60
    v_add_f32 v57, v57, v61
    v_add_f32 v58, v58, v62
    v_add_f32 v59, v59, v63
    v_add_f32 v56, v56, v57
    v_add_f32 v58, v58, v59
    v_add_f32 v56, v56, v58
    s_cmp_eq_u32 s50, 2
    s_cselect_b32 s72, s71, 0x7ff00000
    buffer_atomic_add_f32 v56, v115, s[28:31], s72 offen offset:1024
    s_cmp_lg_u32 s50, 0
    s_cbranch_scc1 L_pi_24
    s_load_dwordx8 s[76:83], s[44:45], 0 glc
    s_load_dwordx8 s[84:91], s[44:45], 32 glc
L_pi_24:
    s_waitcnt vmcnt(0)
    s_barrier
    s_cmp_lg_u32 s50, 1
    s_cbranch_scc1 L_pk_25
    v_mov_b32 v112, 1
    v_lshlrev_b32 v113, 11, v1
    s_and_b32 s62, s2, 3
    s_lshl_b32 s62, s62, 7
    s_add_u32 s62, s62, 10487040
    s_mov_b64 exec, 0xffff
    buffer_atomic_add v112, v113, s[28:31], s62 offen
    s_mov_b64 exec, -1
L_pk_25:
    s_cmp_lg_u32 s50, 0
    s_cbranch_scc1 L_pc_26
    s_mov_b32 s69, 0
L_pl_27:
    s_waitcnt lgkmcnt(0)
    s_min_u32 s76, s76, s80
    s_min_u32 s77, s77, s81
    s_min_u32 s78, s78, s82
    s_min_u32 s79, s79, s83
    s_min_u32 s76, s76, s78
    s_min_u32 s77, s77, s79
    s_min_u32 s76, s76, s77
    s_min_u32 s84, s84, s88
    s_min_u32 s85, s85, s89
    s_min_u32 s86, s86, s90
    s_min_u32 s87, s87, s91
    s_min_u32 s84, s84, s86
    s_min_u32 s85, s85, s87
    s_min_u32 s84, s84, s85
    s_cmp_ge_u32 s84, 1
    s_cselect_b32 s76, s76, 0
    s_cmp_ge_u32 s76, 1
    s_cbranch_scc1 L_pc_26
    s_add_u32 s69, s69, 1
    s_cmp_ge_u32 s69, 0x40000
    s_cbranch_scc1 L_pc_26
    s_load_dwordx8 s[76:83], s[44:45], 0 glc
    s_load_dwordx8 s[84:91], s[44:45], 32 glc
    s_branch L_pl_27
L_pc_26:
    s_barrier
    v_lshlrev_b32 v3, 4, v1
    s_add_u32 s62, s70, s75
    buffer_load_dwordx4 v[128:131], v3, s[28:31], s62 offen offset:0 sc1
    s_add_u32 s62, s70, s75
    buffer_load_dwordx4 v[132:135], v3, s[28:31], s62 offen offset:1024 sc1
    s_add_u32 s62, s70, s75
    buffer_load_dwordx4 v[136:139], v3, s[28:31], s62 offen offset:2048 sc1
    s_add_u32 s62, s70, s75
    buffer_load_dwordx4 v[140:143], v3, s[28:31], s62 offen offset:3072 sc1
    s_add_u32 s62, s70, s63
    buffer_load_dwordx4 v[144:147], v3, s[28:31], s62 offen offset:0 sc1
    s_add_u32 s62, s70, s63
    buffer_load_dwordx4 v[148:151], v3, s[28:31], s62 offen offset:1024 sc1
    s_add_u32 s62, s70, s63
    buffer_load_dwordx4 v[152:155], v3, s[28:31], s62 offen offset:2048 sc1
    s_add_u32 s62, s70, s63
    buffer_load_dwordx4 v[156:159], v3, s[28:31], s62 offen offset:3072 sc1
    s_add_u32 s62, s70, s54
    buffer_load_dwordx4 v[160:163], v3, s[28:31], s62 offen offset:0 sc1
    s_add_u32 s62, s70, s54
    buffer_load_dwordx4 v[164:167], v3, s[28:31], s62 offen offset:1024 sc1
    s_add_u32 s62, s70, s54
    buffer_load_dwordx4 v[168:171], v3, s[28:31], s62 offen offset:2048 sc1
    s_add_u32 s62, s70, s54
    buffer_load_dwordx4 v[172:175], v3, s[28:31], s62 offen offset:3072 sc1
    s_add_u32 s62, s70, s53
    buffer_load_dwordx4 v[176:179], v3, s[28:31], s62 offen offset:0 sc1
    s_add_u32 s62, s70, s53
    buffer_load_dwordx4 v[180:183], v3, s[28:31], s62 offen offset:1024 sc1
    s_add_u32 s62, s70, s53
    buffer_load_dwordx4 v[184:187], v3, s[28:31], s62 offen offset:2048 sc1
    s_add_u32 s62, s70, s53
    buffer_load_dwordx4 v[188:191], v3, s[28:31], s62 offen offset:3072 sc1
    s_branch L_p2kv
.p2align 6
L_kv1:
    ds_read_b128 v[128:131], v12 offset:40960
    ds_read_b128 v[132:135], v13 offset:40960
    ds_read_b128 v[136:139], v14 offset:40960
    ds_read_b128 v[140:143], v15 offset:40960
    ds_read_b64_tr_b16 v[16:17], v8 offset:0
    ds_read_b64_tr_b16 v[18:19], v8 offset:512
    ds_read_b64_tr_b16 v[24:25], v9 offset:0
    ds_read_b64_tr_b16 v[26:27], v9 offset:512
    s_mov_b32 s38, 256
    s_mov_b32 s39, 0x20000
    s_add_u32 s7, s3, 32
    s_and_b32 s7, s7, 63
    s_add_u32 s32, s3, 40
    s_and_b32 s32, s32, 63
    s_add_u32 s33, s3, 48
    s_and_b32 s33, s33, 63
    s_add_u32 s34, s3, 56
    s_and_b32 s34, s34, 63
    s_waitcnt lgkmcnt(2)
    v_mfma_f32_32x32x16_bf16 v[32:47], v[16:19], v[128:131], 0
    s_setprio 1
    s_add_u32 m0, s51, 8192
    s_lshl4_add_u32 s62, s5, s69
    buffer_load_dwordx4 v2, s[8:11], s62 offen lds
    ds_read_b64_tr_b16 v[28:29], v10 offset:0
    ds_read_b64_tr_b16 v[30:31], v10 offset:512
    s_mov_b32 s14, 1572864
    s_mov_b32 s15, 0x20000
    s_waitcnt lgkmcnt(2)
    v_mfma_f32_32x32x16_bf16 v[32:47], v[24:27], v[132:135], v[32:47]
    s_add_u32 m0, s51, 16384
    s_mul_i32 s62, s5, 28672
    s_add_u32 s62, s62, s54
    buffer_load_dwordx4 v4, s[16:19], s62 offen lds
    v_smfmac_f32_16x16x64_bf16 v[88:91], v[84:87], v[128:135], v103
    v_smfmac_f32_16x16x64_bf16 v[88:91], v[84:87], v[136:143], v103
    ds_read_b64_tr_b16 v[108:109], v11 offset:0
    ds_read_b64_tr_b16 v[110:111], v11 offset:512
    s_mov_b32 s42, 3584
    s_mov_b32 s43, 0x20000
    s_mov_b32 s22, 1835008
    s_waitcnt lgkmcnt(2)
    v_mfma_f32_32x32x16_bf16 v[32:47], v[28:31], v[136:139], v[32:47]
    s_add_u32 m0, s51, 24576
    s_lshl4_add_u32 s62, s6, s53
    buffer_load_dwordx4 v2, s[8:11], s62 offen lds
    s_waitcnt vmcnt(5)
    s_barrier
    v_add_u32 v12, 57344, v12
    v_add_u32 v13, 57344, v13
    v_add_u32 v14, 57344, v14
    v_add_u32 v15, 57344, v15
    ds_read_b128 v[144:147], v12 offset:8192
    ds_read_b128 v[148:151], v13 offset:8192
    ds_read_b128 v[152:155], v14 offset:8192
    ds_read_b128 v[156:159], v15 offset:8192
    ds_read_b64_tr_b16 v[20:21], v8 offset:24576
    ds_read_b64_tr_b16 v[22:23], v8 offset:25088
    s_mov_b32 s23, 0x20000
    s_movk_i32 s76, 3072
    v_mad_u32_u24 v3, v112, s76, v113
    s_waitcnt lgkmcnt(6)
    v_mfma_f32_32x32x16_bf16 v[32:47], v[108:111], v[140:143], v[32:47]
    s_add_u32 m0, s51, 32768
    s_lshl4_add_u32 s62, s6, s69
    buffer_load_dwordx4 v2, s[8:11], s62 offen lds
    ds_read_b64_tr_b16 v[24:25], v9 offset:24576
    ds_read_b64_tr_b16 v[26:27], v9 offset:25088
    v_lshl_add_u32 v6, v112, 10, v113
    s_waitcnt lgkmcnt(2)
    v_mfma_f32_32x32x16_bf16 v[32:47], v[20:23], v[144:147], v[32:47]
    v_smfmac_f32_16x16x64_bf16 v[80:83], v[84:87], v[16:23], v103
    s_setprio 0
    s_add_u32 m0, s51, 40960
    s_mul_i32 s62, s6, 28672
    s_add_u32 s62, s62, s54
    buffer_load_dwordx4 v4, s[16:19], s62 offen lds
    ds_read_b64_tr_b16 v[28:29], v10 offset:24576
    ds_read_b64_tr_b16 v[30:31], v10 offset:25088
    s_lshl_b32 s76, s67, 7
    v_add_u32 v6, s76, v6
    s_waitcnt lgkmcnt(2)
    v_mfma_f32_32x32x16_bf16 v[32:47], v[24:27], v[148:151], v[32:47]
    s_add_u32 m0, s51, 49152
    s_lshl4_add_u32 s62, s7, s53
    buffer_load_dwordx4 v2, s[8:11], s62 offen lds
    v_smfmac_f32_16x16x64_bf16 v[88:91], v[84:87], v[144:151], v103
    v_smfmac_f32_16x16x64_bf16 v[88:91], v[84:87], v[152:159], v103
    ds_read_b64_tr_b16 v[108:109], v11 offset:24576
    ds_read_b64_tr_b16 v[110:111], v11 offset:25088
    v_and_b32 v117, 31, v0
    s_waitcnt lgkmcnt(2)
    v_mfma_f32_32x32x16_bf16 v[32:47], v[28:31], v[152:155], v[32:47]
    s_add_u32 m0, s51, 57344
    s_lshl4_add_u32 s62, s7, s69
    buffer_load_dwordx4 v2, s[8:11], s62 offen lds
    s_waitcnt vmcnt(5)
    s_barrier
    s_cmp_lg_u32 s50, 1
    s_cbranch_scc1 L_ini_28
    s_cmp_ge_u32 s2, 8
    s_cbranch_scc1 L_ini_28
    v_mov_b32 v104, 1
    s_mov_b64 exec, 1
    buffer_atomic_add v104, off, s[36:39], 0
    s_mov_b64 exec, -1
L_ini_28:
    v_subrev_u32 v12, 114688, v12
    v_subrev_u32 v13, 114688, v13
    v_subrev_u32 v14, 114688, v14
    v_subrev_u32 v15, 114688, v15
    ds_read_b128 v[160:163], v12 offset:0
    ds_read_b128 v[164:167], v13 offset:0
    ds_read_b128 v[168:171], v14 offset:0
    ds_read_b128 v[172:175], v15 offset:0
    v_subrev_u32 v8, 114688, v8
    v_subrev_u32 v9, 114688, v9
    v_subrev_u32 v10, 114688, v10
    v_subrev_u32 v11, 114688, v11
    ds_read_b64_tr_b16 v[16:17], v8 offset:16384
    ds_read_b64_tr_b16 v[18:19], v8 offset:16896
    v_lshlrev_b32 v116, 1, v117
    s_waitcnt lgkmcnt(6)
    v_mfma_f32_32x32x16_bf16 v[32:47], v[108:111], v[156:159], v[32:47]
    s_add_u32 m0, s51, 65536
    s_mul_i32 s62, s7, 28672
    s_add_u32 s62, s62, s54
    buffer_load_dwordx4 v4, s[16:19], s62 offen lds
    ds_read_b64_tr_b16 v[24:25], v9 offset:16384
    ds_read_b64_tr_b16 v[26:27], v9 offset:16896
    v_lshlrev_b32 v117, 2, v117
    v_add_u32 v126, 147456, v117
    s_waitcnt lgkmcnt(2)
    v_mfma_f32_32x32x16_bf16 v[32:47], v[16:19], v[160:163], v[32:47]
    s_setprio 1
    s_add_u32 m0, s51, 73728
    s_lshl4_add_u32 s62, s32, s53
    buffer_load_dwordx4 v2, s[8:11], s62 offen lds
    ds_read_b64_tr_b16 v[28:29], v10 offset:16384
    ds_read_b64_tr_b16 v[30:31], v10 offset:16896
    s_mul_i32 s73, s75, 589824
    s_add_u32 s72, s73, 2048
    s_lshr_b32 s76, s52, 1
    s_lshl_b32 s80, s76, 7
    s_waitcnt lgkmcnt(2)
    v_mfma_f32_32x32x16_bf16 v[32:47], v[24:27], v[164:167], v[32:47]
    s_add_u32 m0, s51, 81920
    s_lshl4_add_u32 s62, s32, s69
    buffer_load_dwordx4 v2, s[8:11], s62 offen lds
    v_smfmac_f32_16x16x64_bf16 v[88:91], v[84:87], v[160:167], v103
    v_smfmac_f32_16x16x64_bf16 v[88:91], v[84:87], v[168:175], v103
    ds_read_b64_tr_b16 v[108:109], v11 offset:16384
    ds_read_b64_tr_b16 v[110:111], v11 offset:16896
    s_lshl_b32 s78, s54, 5
    s_add_u32 s78, s78, s72
    s_add_u32 s55, s80, 1024
    s_add_u32 s56, s80, 2048
    s_mov_b32 s60, s78
    v_lshrrev_b32 v117, 5, v1
    s_waitcnt lgkmcnt(2)
    v_mfma_f32_32x32x16_bf16 v[32:47], v[28:31], v[168:171], v[32:47]
    s_add_u32 m0, s51, 90112
    s_mul_i32 s62, s32, 28672
    s_add_u32 s62, s62, s54
    buffer_load_dwordx4 v4, s[16:19], s62 offen lds
    s_waitcnt vmcnt(6)
    s_barrier
    ds_read_b128 v[176:179], v12 offset:24576
    ds_read_b128 v[180:183], v13 offset:24576
    ds_read_b128 v[184:187], v14 offset:24576
    ds_read_b128 v[188:191], v15 offset:24576
    ds_read_b64_tr_b16 v[20:21], v8 offset:40960
    ds_read_b64_tr_b16 v[22:23], v8 offset:41472
    v_lshlrev_b32 v127, 4, v117
    v_add_u32 v127, 147456, v127
    s_waitcnt lgkmcnt(6)
    v_mfma_f32_32x32x16_bf16 v[32:47], v[108:111], v[172:175], v[32:47]
    s_add_u32 m0, s51, 98304
    s_lshl4_add_u32 s62, s33, s53
    buffer_load_dwordx4 v2, s[8:11], s62 offen lds
    ds_read_b64_tr_b16 v[24:25], v9 offset:40960
    ds_read_b64_tr_b16 v[26:27], v9 offset:41472
    s_lshl_b32 s71, s76, 13
    s_add_u32 s71, s71, 10485760
    buffer_load_ushort v92, v116, s[40:43], s54 offen offset:64
    s_waitcnt lgkmcnt(2)
    v_mfma_f32_32x32x16_bf16 v[32:47], v[20:23], v[176:179], v[32:47]
    v_smfmac_f32_16x16x64_bf16 v[80:83], v[84:87], v[16:23], v103
    s_setprio 0
    s_add_u32 m0, s51, 106496
    s_lshl4_add_u32 s62, s33, s69
    buffer_load_dwordx4 v2, s[8:11], s62 offen lds
    ds_read_b64_tr_b16 v[28:29], v10 offset:40960
    ds_read_b64_tr_b16 v[30:31], v10 offset:41472
    s_mov_b32 s64, 0x3fb8aa3b
    s_mov_b32 s65, 0x358637bd
    s_mov_b32 s48, 0x0000ffff
    s_mov_b32 s49, 0x0000ffff
    s_mul_i32 s79, s77, 147456
    v_lshlrev_b32 v7, 4, v1
    s_waitcnt lgkmcnt(2)
    v_mfma_f32_32x32x16_bf16 v[32:47], v[24:27], v[180:183], v[32:47]
    s_add_u32 m0, s51, 114688
    s_mul_i32 s62, s33, 28672
    s_add_u32 s62, s62, s54
    buffer_load_dwordx4 v4, s[16:19], s62 offen lds
    v_smfmac_f32_16x16x64_bf16 v[88:91], v[84:87], v[176:183], v103
    v_smfmac_f32_16x16x64_bf16 v[88:91], v[84:87], v[184:191], v103
    ds_read_b64_tr_b16 v[108:109], v11 offset:40960
    ds_read_b64_tr_b16 v[110:111], v11 offset:41472
    v_add_u32 v7, s79, v7
    s_lshr_b32 s79, s66, 1
    s_lshl_b32 s79, s79, 11
    s_add_u32 s79, s79, 10486912
    s_add_u32 s44, s28, s79
    s_addc_u32 s45, s29, 0
    s_lshl_b32 s68, s75, 11
    s_lshl2_add_u32 s68, s76, s68
    s_add_u32 s68, s68, 10486944
    s_lshl_b32 s79, s66, 1
    s_add_u32 s79, s79, 1
    s_mul_i32 s79, s79, 147456
    s_mul_i32 s70, s77, 28672
    s_add_u32 s70, s70, s79
    s_lshl_b32 s74, s77, 13
    s_add_u32 s74, s74, s79
    s_add_u32 s74, s74, 114688
    s_waitcnt lgkmcnt(2)
    v_mfma_f32_32x32x16_bf16 v[32:47], v[28:31], v[184:187], v[32:47]
    s_add_u32 m0, s51, 122880
    s_lshl4_add_u32 s62, s34, s53
    buffer_load_dwordx4 v2, s[8:11], s62 offen lds
    s_waitcnt vmcnt(8)
    s_barrier
    ds_read_b128 v[192:195], v12 offset:49152
    ds_read_b128 v[196:199], v13 offset:49152
    ds_read_b128 v[200:203], v14 offset:49152
    ds_read_b128 v[204:207], v15 offset:49152
    v_add_u32 v8, 57344, v8
    v_add_u32 v9, 57344, v9
    v_add_u32 v10, 57344, v10
    v_add_u32 v11, 57344, v11
    ds_read_b64_tr_b16 v[16:17], v8 offset:8192
    ds_read_b64_tr_b16 v[18:19], v8 offset:8704
    s_waitcnt lgkmcnt(6)
    v_mfma_f32_32x32x16_bf16 v[32:47], v[108:111], v[188:191], v[32:47]
    s_add_u32 m0, s51, 131072
    s_lshl4_add_u32 s62, s34, s69
    buffer_load_dwordx4 v2, s[8:11], s62 offen lds
    ds_read_b64_tr_b16 v[24:25], v9 offset:8192
    ds_read_b64_tr_b16 v[26:27], v9 offset:8704
    s_waitcnt lgkmcnt(2)
    v_mfma_f32_32x32x16_bf16 v[32:47], v[16:19], v[192:195], v[32:47]
    s_setprio 1
    s_add_u32 m0, s51, 139264
    s_mul_i32 s62, s34, 28672
    s_add_u32 s62, s62, s54
    buffer_load_dwordx4 v4, s[16:19], s62 offen lds
    ds_read_b64_tr_b16 v[28:29], v10 offset:8192
    ds_read_b64_tr_b16 v[30:31], v10 offset:8704
    s_waitcnt lgkmcnt(2)
    v_mfma_f32_32x32x16_bf16 v[32:47], v[24:27], v[196:199], v[32:47]
    s_add_u32 m0, s51, 0
    s_mul_i32 s62, s3, 24576
    s_add_u32 s62, s62, s55
    buffer_load_dwordx4 v3, s[12:15], s62 offen lds
    v_smfmac_f32_16x16x64_bf16 v[88:91], v[84:87], v[192:199], v103
    v_smfmac_f32_16x16x64_bf16 v[88:91], v[84:87], v[200:207], v103
    ds_read_b64_tr_b16 v[108:109], v11 offset:8192
    ds_read_b64_tr_b16 v[110:111], v11 offset:8704
    s_waitcnt lgkmcnt(2)
    v_mfma_f32_32x32x16_bf16 v[32:47], v[28:31], v[200:203], v[32:47]
    s_add_u32 m0, s51, 8192
    s_mul_i32 s62, s4, 24576
    s_add_u32 s62, s62, s55
    buffer_load_dwordx4 v3, s[12:15], s62 offen lds
    s_waitcnt vmcnt(9)
    s_barrier
    v_add_u32 v12, 57344, v12
    v_add_u32 v13, 57344, v13
    v_add_u32 v14, 57344, v14
    v_add_u32 v15, 57344, v15
    ds_read_b128 v[208:211], v12 offset:16384
    ds_read_b128 v[212:215], v13 offset:16384
    ds_read_b128 v[216:219], v14 offset:16384
    ds_read_b128 v[220:223], v15 offset:16384
    ds_read_b64_tr_b16 v[20:21], v8 offset:32768
    ds_read_b64_tr_b16 v[22:23], v8 offset:33280
    s_waitcnt lgkmcnt(6)
    v_mfma_f32_32x32x16_bf16 v[32:47], v[108:111], v[204:207], v[32:47]
    s_add_u32 m0, s51, 16384
    s_mul_i32 s62, s5, 24576
    s_add_u32 s62, s62, s55
    buffer_load_dwordx4 v3, s[12:15], s62 offen lds
    ds_read_b64_tr_b16 v[24:25], v9 offset:32768
    ds_read_b64_tr_b16 v[26:27], v9 offset:33280
    s_waitcnt lgkmcnt(2)
    v_mfma_f32_32x32x16_bf16 v[32:47], v[20:23], v[208:211], v[32:47]
    v_smfmac_f32_16x16x64_bf16 v[80:83], v[84:87], v[16:23], v103
    s_setprio 0
    s_add_u32 m0, s51, 24576
    s_mul_i32 s62, s6, 24576
    s_add_u32 s62, s62, s55
    buffer_load_dwordx4 v3, s[12:15], s62 offen lds
    ds_read_b64_tr_b16 v[28:29], v10 offset:32768
    ds_read_b64_tr_b16 v[30:31], v10 offset:33280
    s_waitcnt lgkmcnt(2)
    v_mfma_f32_32x32x16_bf16 v[32:47], v[24:27], v[212:215], v[32:47]
    s_add_u32 m0, s51, 32768
    s_mul_i32 s62, s7, 24576
    s_add_u32 s62, s62, s55
    buffer_load_dwordx4 v3, s[12:15], s62 offen lds
    v_smfmac_f32_16x16x64_bf16 v[88:91], v[84:87], v[208:215], v103
    v_smfmac_f32_16x16x64_bf16 v[88:91], v[84:87], v[216:223], v103
    s_and_b32 s72, s50, 3
    s_lshl_b32 s72, s72, 11
    s_add_u32 s72, s72, 155648
    v_lshlrev_b32 v2, 2, v1
    v_add_u32 v2, s72, v2
    ds_read_b64_tr_b16 v[108:109], v11 offset:32768
    ds_read_b64_tr_b16 v[110:111], v11 offset:33280
    s_waitcnt lgkmcnt(2)
    v_mfma_f32_32x32x16_bf16 v[32:47], v[28:31], v[216:219], v[32:47]
    s_add_u32 m0, s51, 40960
    s_mul_i32 s62, s32, 24576
    s_add_u32 s62, s62, s55
    buffer_load_dwordx4 v3, s[12:15], s62 offen lds
    s_waitcnt vmcnt(9)
    s_barrier
    s_cmp_lg_u32 s50, 0
    s_cbranch_scc1 L_ip_29
    buffer_load_dword v107, off, s[36:39], 0 sc1
L_ip_29:
    ds_read_b128 v[224:227], v12 offset:40960
    ds_read_b128 v[228:231], v13 offset:40960
    ds_read_b128 v[232:235], v14 offset:40960
    ds_read_b128 v[236:239], v15 offset:40960
    v_add_u32 v8, 57344, v8
    v_add_u32 v9, 57344, v9
    v_add_u32 v10, 57344, v10
    v_add_u32 v11, 57344, v11
    ds_read_b64_tr_b16 v[16:17], v8 offset:0
    ds_read_b64_tr_b16 v[18:19], v8 offset:512
    s_waitcnt lgkmcnt(6)
    v_mfma_f32_32x32x16_bf16 v[32:47], v[108:111], v[220:223], v[32:47]
    s_add_u32 m0, s51, 49152
    s_mul_i32 s62, s33, 24576
    s_add_u32 s62, s62, s55
    buffer_load_dwordx4 v3, s[12:15], s62 offen lds
    ds_read_b64_tr_b16 v[24:25], v9 offset:0
    ds_read_b64_tr_b16 v[26:27], v9 offset:512
    s_waitcnt lgkmcnt(2)
    v_mfma_f32_32x32x16_bf16 v[32:47], v[16:19], v[224:227], v[32:47]
    s_setprio 1
    s_add_u32 m0, s51, 57344
    s_mul_i32 s62, s34, 24576
    s_add_u32 s62, s62, s55
    buffer_load_dwordx4 v3, s[12:15], s62 offen lds
    ds_read_b64_tr_b16 v[28:29], v10 offset:0
    ds_read_b64_tr_b16 v[30:31], v10 offset:512
    s_waitcnt lgkmcnt(2)
    v_mfma_f32_32x32x16_bf16 v[32:47], v[24:27], v[228:231], v[32:47]
    s_add_u32 m0, s51, 65536
    s_mul_i32 s62, s3, 24576
    s_add_u32 s62, s62, s56
    buffer_load_dwordx4 v3, s[12:15], s62 offen lds
    v_smfmac_f32_16x16x64_bf16 v[88:91], v[84:87], v[224:231], v103
    v_smfmac_f32_16x16x64_bf16 v[88:91], v[84:87], v[232:239], v103
    ds_read_b64_tr_b16 v[108:109], v11 offset:0
    ds_read_b64_tr_b16 v[110:111], v11 offset:512
    s_waitcnt lgkmcnt(2)
    v_mfma_f32_32x32x16_bf16 v[32:47], v[28:31], v[232:235], v[32:47]
    s_add_u32 m0, s51, 73728
    s_mul_i32 s62, s4, 24576
    s_add_u32 s62, s62, s56
    buffer_load_dwordx4 v3, s[12:15], s62 offen lds
    s_waitcnt vmcnt(10)
    s_barrier
    v_add_u32 v12, 57344, v12
    v_add_u32 v13, 57344, v13
    v_add_u32 v14, 57344, v14
    v_add_u32 v15, 57344, v15
    ds_read_b128 v[240:243], v12 offset:8192
    ds_read_b128 v[244:247], v13 offset:8192
    ds_read_b128 v[248:251], v14 offset:8192
    ds_read_b128 v[252:255], v15 offset:8192
    ds_read_b64_tr_b16 v[20:21], v8 offset:24576
    ds_read_b64_tr_b16 v[22:23], v8 offset:25088
    s_waitcnt lgkmcnt(6)
    v_mfma_f32_32x32x16_bf16 v[32:47], v[108:111], v[236:239], v[32:47]
    s_add_u32 m0, s51, 81920
    s_mul_i32 s62, s5, 24576
    s_add_u32 s62, s62, s56
    buffer_load_dwordx4 v3, s[12:15], s62 offen lds
    s_waitcnt lgkmcnt(2)
    v_smfmac_f32_16x16x64_bf16 v[88:91], v[84:87], v[240:247], v103
    v_smfmac_f32_16x16x64_bf16 v[88:91], v[84:87], v[248:255], v103
    ds_read_b64_tr_b16 v[24:25], v9 offset:24576
    ds_read_b64_tr_b16 v[26:27], v9 offset:25088
    s_waitcnt lgkmcnt(2)
    v_mfma_f32_32x32x16_bf16 v[32:47], v[20:23], v[240:243], v[32:47]
    v_smfmac_f32_16x16x64_bf16 v[80:83], v[84:87], v[16:23], v103
    s_setprio 0
    s_add_u32 m0, s51, 90112
    s_mul_i32 s62, s6, 24576
    s_add_u32 s62, s62, s56
    buffer_load_dwordx4 v3, s[12:15], s62 offen lds
    ds_read_b64_tr_b16 v[28:29], v10 offset:24576
    ds_read_b64_tr_b16 v[30:31], v10 offset:25088
    s_waitcnt lgkmcnt(2)
    v_mfma_f32_32x32x16_bf16 v[32:47], v[24:27], v[244:247], v[32:47]
    s_add_u32 m0, s51, 98304
    s_mul_i32 s62, s7, 24576
    s_add_u32 s62, s62, s56
    buffer_load_dwordx4 v3, s[12:15], s62 offen lds
    v_add_f32 v124, v124, v125
    v_add_f32 v88, v88, v89
    v_lshlrev_b32 v125, 2, v0
    v_add_u32 v125, 147456, v125
    ds_write2st64_b32 v125, v124, v88 offset0:0 offset1:16
    v_and_b32 v124, 0xdf, v0
    v_lshlrev_b32 v124, 2, v124
    v_add_u32 v125, 147584, v124
    v_add_u32 v124, 147456, v124
    ds_read_b64_tr_b16 v[108:109], v11 offset:24576
    ds_read_b64_tr_b16 v[110:111], v11 offset:25088
    s_waitcnt lgkmcnt(3)
    v_mfma_f32_32x32x16_bf16 v[32:47], v[28:31], v[248:251], v[32:47]
    s_add_u32 m0, s51, 106496
    s_mul_i32 s62, s32, 24576
    s_add_u32 s62, s62, s56
    buffer_load_dwordx4 v3, s[12:15], s62 offen lds
    v_add_f32 v82, v80, v81
    ds_write_b32 v2, v82 offset:1280
    v_mov_b32 v80, 0
    v_mov_b32 v81, 0
    s_waitcnt vmcnt(12) lgkmcnt(0)
    s_barrier
    v_subrev_u32 v8, 114688, v8
    v_subrev_u32 v9, 114688, v9
    v_subrev_u32 v10, 114688, v10
    v_subrev_u32 v11, 114688, v11
    ds_read_b64_tr_b16 v[16:17], v8 offset:0
    ds_read_b64_tr_b16 v[18:19], v8 offset:512
    v_mfma_f32_32x32x16_bf16 v[32:47], v[108:111], v[252:255], v[32:47]
    s_add_u32 m0, s51, 114688
    s_mul_i32 s62, s33, 24576
    s_add_u32 s62, s62, s56
    buffer_load_dwordx4 v3, s[12:15], s62 offen lds
    ds_read_b64_tr_b16 v[24:25], v9 offset:0
    ds_read_b64_tr_b16 v[26:27], v9 offset:512
    ds_read2st64_b32 v[112:113], v124 offset0:16 offset1:20
    ds_read2st64_b32 v[116:117], v124 offset0:0 offset1:4
    ds_read2st64_b32 v[118:119], v125 offset0:0 offset1:4
    v_mov_b32 v99, 0
    v_cmp_gt_u32 vcc, 32, v1
    s_waitcnt lgkmcnt(0)
    v_add_f32 v116, v116, v118
    v_add_f32 v117, v117, v119
    v_add_f32 v112, v112, v113
    v_mfma_f32_32x32x16_bf16 v[48:63], v[128:131], v[16:19], 0
    s_setprio 1
    ds_read_b64_tr_b16 v[28:29], v10 offset:0
    ds_read_b64_tr_b16 v[30:31], v10 offset:512
    v_add_f32 v116, v116, v117
    v_mul_f32 v112, 0xbb000000, v112
    v_mul_f32 v116, 0x3b000000, v116
    v_fma_f32 v116, -v112, v112, v116
    v_and_b32 v113, 0xffff0000, v112
    v_max_f32 v116, 0, v116
    v_sub_f32 v112, v112, v113
    v_add_f32 v116, 0x3727c5ac, v116
    v_mfma_f32_32x32x16_bf16 v[48:63], v[132:135], v[24:27], v[48:63]
    s_add_u32 m0, s51, 122880
    s_mul_i32 s62, s34, 24576
    s_add_u32 s62, s62, s56
    buffer_load_dwordx4 v3, s[12:15], s62 offen lds
    s_lshr_b32 s73, s2, 6
    s_add_u32 s73, s73, s67
    s_and_b32 s73, s73, 3
    s_lshl_b32 s73, s73, 2
    s_lshr_b32 s73, 0x60416041, s73
    s_bfe_u32 s75, s73, 0x40000
    s_lshl_b32 s75, s75, 12
    s_bfe_u32 s63, s73, 0x40004
    s_lshl_b32 s63, s63, 12
    s_bfe_u32 s54, s73, 0x40008
    s_lshl_b32 s54, s54, 12
    s_bfe_u32 s53, s73, 0x4000c
    s_lshl_b32 s53, s53, 12
    ds_read_b64_tr_b16 v[108:109], v11 offset:0
    ds_read_b64_tr_b16 v[110:111], v11 offset:512
    v_cvt_pk_bf16_f32 v96, v113, v113
    v_rsq_f32 v120, v116
    v_sqrt_f32 v121, v116
    v_cndmask_b32 v96, 0, v96, vcc
    v_mul_f32 v116, v120, v120
    v_and_b32 v114, 0xffff0000, v121
    s_waitcnt lgkmcnt(2)
    v_mfma_f32_32x32x16_bf16 v[48:63], v[136:139], v[28:31], v[48:63]
    ds_read_b64_tr_b16 v[20:21], v8 offset:8192
    ds_read_b64_tr_b16 v[22:23], v8 offset:8704
    v_mul_f32 v122, 0xc0135761, v120
    v_sub_f32 v115, v121, v114
    v_cvt_pk_bf16_f32 v97, v112, v114
    v_mul_f32 v123, v122, v116
    v_cvt_pk_bf16_f32 v98, v115, v99
    v_mul_f32 v123, 0x3d372713, v123
    v_cndmask_b32 v97, 0, v97, vcc
    v_cndmask_b32 v98, 0, v98, vcc
    s_and_b32 s72, s50, 3
    s_lshl_b32 s72, s72, 7
    v_add_u32 v112, s72, v126
    s_waitcnt lgkmcnt(2)
    v_mfma_f32_32x32x16_bf16 v[48:63], v[140:143], v[108:111], v[48:63]
    ds_read_b64_tr_b16 v[24:25], v9 offset:8192
    ds_read_b64_tr_b16 v[26:27], v9 offset:8704
    v_add_u32 v127, s72, v127
    ds_write_b32 v112, v120 offset:2048
    ds_read2st64_b32 v[88:89], v126 offset0:37 offset1:45
    ds_read2st64_b32 v[90:91], v126 offset0:53 offset1:61
    v_mov_b32 v102, v92
    v_lshlrev_b32 v113, 16, v92
    s_waitcnt lgkmcnt(0)
    v_add_f32 v88, v88, v89
    v_add_f32 v90, v90, v91
    v_mfma_f32_32x32x16_bf16 v[48:63], v[144:147], v[20:23], v[48:63]
    v_smfmac_f32_16x16x64_bf16 v[80:83], v[84:87], v[16:23], v103
    s_setprio 0
    ds_read_b64_tr_b16 v[28:29], v10 offset:8192
    ds_read_b64_tr_b16 v[30:31], v10 offset:8704
    v_add_f32 v88, v88, v90
    v_and_b32 v112, 0xffff0000, v88
    v_sub_f32 v88, v88, v112
    v_cvt_pk_bf16_f32 v101, v112, v113
    v_cvt_pk_bf16_f32 v100, v112, v88
    s_nop 1
    v_mfma_f32_32x32x16_bf16 v[32:47], v[100:103], v[96:99], v[32:47]
    v_mfma_f32_32x32x16_bf16 v[48:63], v[148:151], v[24:27], v[48:63]
    ds_read_b64_tr_b16 v[108:109], v11 offset:8192
    ds_read_b64_tr_b16 v[110:111], v11 offset:8704
    s_waitcnt lgkmcnt(2)
    v_mfma_f32_32x32x16_bf16 v[48:63], v[152:155], v[28:31], v[48:63]
    s_cmp_lg_u32 s50, 0
    s_cbranch_scc1 L_ic_30
    s_mov_b32 s69, 0
    s_waitcnt vmcnt(10)
L_il_31:
    v_readfirstlane_b32 s72, v107
    s_nop 1
    s_cmp_ge_u32 s72, 8
    s_cbranch_scc1 L_ic_30
    s_add_u32 s69, s69, 1
    s_cmp_ge_u32 s69, 0x40000
    s_cbranch_scc1 L_ic_30
    buffer_load_dword v107, off, s[36:39], 0 sc1
    s_waitcnt vmcnt(0)
    s_branch L_il_31
L_ic_30:
    s_waitcnt vmcnt(12)
    s_barrier
    ds_read_b64_tr_b16 v[16:17], v8 offset:16384
    ds_read_b64_tr_b16 v[18:19], v8 offset:16896
    s_nop 0
    v_mul_f32 v116, v32, v32
    v_mul_f32 v117, v33, v33
    v_mul_f32 v118, v34, v34
    v_mul_f32 v119, v35, v35
    v_fma_f32 v116, v116, v123, v122
    v_fma_f32 v117, v117, v123, v122
    v_fma_f32 v118, v118, v123, v122
    s_waitcnt lgkmcnt(2)
    v_mfma_f32_32x32x16_bf16 v[48:63], v[156:159], v[108:111], v[48:63]
    ds_read_b64_tr_b16 v[24:25], v9 offset:16384
    ds_read_b64_tr_b16 v[26:27], v9 offset:16896
    v_fma_f32 v119, v119, v123, v122
    v_mul_f32 v116, v32, v116
    v_mul_f32 v117, v33, v117
    v_mul_f32 v118, v34, v118
    v_mul_f32 v119, v35, v119
    v_exp_f32 v116, v116
    s_waitcnt lgkmcnt(2)
    v_mfma_f32_32x32x16_bf16 v[48:63], v[160:163], v[16:19], v[48:63]
    s_setprio 1
    ds_read_b64_tr_b16 v[28:29], v10 offset:16384
    ds_read_b64_tr_b16 v[30:31], v10 offset:16896
    v_exp_f32 v117, v117
    v_exp_f32 v118, v118
    v_exp_f32 v119, v119
    v_fma_f32 v116, v116, v121, v121
    v_fma_f32 v117, v117, v121, v121
    s_waitcnt lgkmcnt(2)
    v_mfma_f32_32x32x16_bf16 v[48:63], v[164:167], v[24:27], v[48:63]
    s_lshl3_add_u32 s35, s2, s50
    s_mul_i32 s62, s35, 896
    v_lshlrev_b32 v124, 6, v1
    s_mov_b64 exec, 0x3fff
    buffer_load_dword v5, v124, s[20:23], s62 offen sc1
    s_lshl_b32 s62, s35, 8
    v_add_u32 v124, s62, v124
    s_mov_b64 exec, 15
    global_load_dword v5, v124, s[24:25] sc1
    s_mov_b64 exec, -1
    ds_read_b64_tr_b16 v[108:109], v11 offset:16384
    ds_read_b64_tr_b16 v[110:111], v11 offset:16896
    v_fma_f32 v118, v118, v121, v121
    v_fma_f32 v119, v119, v121, v121
    v_rcp_f32 v116, v116
    v_rcp_f32 v117, v117
    s_waitcnt lgkmcnt(2)
    v_mfma_f32_32x32x16_bf16 v[48:63], v[168:171], v[28:31], v[48:63]
    ds_read_b64_tr_b16 v[20:21], v8 offset:24576
    ds_read_b64_tr_b16 v[22:23], v8 offset:25088
    v_rcp_f32 v118, v118
    v_rcp_f32 v119, v119
    v_mul_f32 v112, v32, v116
    v_mul_f32 v113, v33, v117
    v_mul_f32 v114, v34, v118
    v_mul_f32 v115, v35, v119
    v_cvt_pk_bf16_f32 v104, v112, v113
    s_waitcnt lgkmcnt(2)
    v_mfma_f32_32x32x16_bf16 v[48:63], v[172:175], v[108:111], v[48:63]
    ds_read_b64_tr_b16 v[24:25], v9 offset:24576
    ds_read_b64_tr_b16 v[26:27], v9 offset:25088
    v_cvt_pk_bf16_f32 v105, v114, v115
    v_mul_f32 v116, v36, v36
    v_mul_f32 v117, v37, v37
    v_mul_f32 v118, v38, v38
    v_mul_f32 v119, v39, v39
    v_fma_f32 v116, v116, v123, v122
    v_fma_f32 v117, v117, v123, v122
    s_waitcnt lgkmcnt(2)
    v_mfma_f32_32x32x16_bf16 v[48:63], v[176:179], v[20:23], v[48:63]
    v_smfmac_f32_16x16x64_bf16 v[80:83], v[84:87], v[16:23], v103
    s_setprio 0
    ds_read_b64_tr_b16 v[28:29], v10 offset:24576
    ds_read_b64_tr_b16 v[30:31], v10 offset:25088
    v_fma_f32 v118, v118, v123, v122
    v_fma_f32 v119, v119, v123, v122
    v_mul_f32 v116, v36, v116
    v_mul_f32 v117, v37, v117
    v_mul_f32 v118, v38, v118
    v_mul_f32 v119, v39, v119
    v_exp_f32 v116, v116
    s_waitcnt lgkmcnt(2)
    v_mfma_f32_32x32x16_bf16 v[48:63], v[180:183], v[24:27], v[48:63]
    ds_read_b64_tr_b16 v[108:109], v11 offset:24576
    ds_read_b64_tr_b16 v[110:111], v11 offset:25088
    v_exp_f32 v117, v117
    v_exp_f32 v118, v118
    v_exp_f32 v119, v119
    v_fma_f32 v116, v116, v121, v121
    s_waitcnt lgkmcnt(2)
    v_mfma_f32_32x32x16_bf16 v[48:63], v[184:187], v[28:31], v[48:63]
    s_waitcnt vmcnt(12)
    s_barrier
    ds_read_b64_tr_b16 v[16:17], v8 offset:32768
    ds_read_b64_tr_b16 v[18:19], v8 offset:33280
    v_fma_f32 v117, v117, v121, v121
    v_fma_f32 v118, v118, v121, v121
    v_fma_f32 v119, v119, v121, v121
    v_rcp_f32 v116, v116
    v_rcp_f32 v117, v117
    s_waitcnt lgkmcnt(2)
    v_mfma_f32_32x32x16_bf16 v[48:63], v[188:191], v[108:111], v[48:63]
    s_add_u32 m0, s51, 0
    s_lshl4_add_u32 s62, s75, 0
    buffer_load_dwordx4 v6, s[20:23], s62 offen lds
    ds_read_b64_tr_b16 v[24:25], v9 offset:32768
    ds_read_b64_tr_b16 v[26:27], v9 offset:33280
    v_rcp_f32 v118, v118
    v_rcp_f32 v119, v119
    v_mul_f32 v112, v36, v116
    v_mul_f32 v113, v37, v117
    v_mul_f32 v114, v38, v118
    s_waitcnt lgkmcnt(2)
    v_mfma_f32_32x32x16_bf16 v[48:63], v[192:195], v[16:19], v[48:63]
    s_setprio 1
    ds_read_b64_tr_b16 v[28:29], v10 offset:32768
    ds_read_b64_tr_b16 v[30:31], v10 offset:33280
    v_mul_f32 v115, v39, v119
    v_cvt_pk_bf16_f32 v106, v112, v113
    v_cvt_pk_bf16_f32 v107, v114, v115
    buffer_store_dwordx4 v[104:107], v7, s[28:31], s60 offen offset:0 sc1
    v_mul_f32 v116, v40, v40
    v_mul_f32 v117, v41, v41
    v_mul_f32 v118, v42, v42
    s_waitcnt lgkmcnt(2)
    v_mfma_f32_32x32x16_bf16 v[48:63], v[196:199], v[24:27], v[48:63]
    s_add_u32 m0, s51, 8192
    s_lshl4_add_u32 s62, s75, 458752
    buffer_load_dwordx4 v6, s[20:23], s62 offen lds
    ds_read_b64_tr_b16 v[108:109], v11 offset:32768
    ds_read_b64_tr_b16 v[110:111], v11 offset:33280
    v_mul_f32 v119, v43, v43
    v_fma_f32 v116, v116, v123, v122
    v_fma_f32 v117, v117, v123, v122
    v_fma_f32 v118, v118, v123, v122
    v_fma_f32 v119, v119, v123, v122
    s_waitcnt lgkmcnt(2)
    v_mfma_f32_32x32x16_bf16 v[48:63], v[200:203], v[28:31], v[48:63]
    ds_read_b64_tr_b16 v[20:21], v8 offset:40960
    ds_read_b64_tr_b16 v[22:23], v8 offset:41472
    v_mul_f32 v116, v40, v116
    v_mul_f32 v117, v41, v117
    v_mul_f32 v118, v42, v118
    v_mul_f32 v119, v43, v119
    v_exp_f32 v116, v116
    v_exp_f32 v117, v117
    v_exp_f32 v118, v118
    s_waitcnt lgkmcnt(2)
    v_mfma_f32_32x32x16_bf16 v[48:63], v[204:207], v[108:111], v[48:63]
    ds_read_b64_tr_b16 v[24:25], v9 offset:40960
    ds_read_b64_tr_b16 v[26:27], v9 offset:41472
    v_exp_f32 v119, v119
    v_fma_f32 v116, v116, v121, v121
    v_fma_f32 v117, v117, v121, v121
    v_fma_f32 v118, v118, v121, v121
    s_waitcnt lgkmcnt(2)
    v_mfma_f32_32x32x16_bf16 v[48:63], v[208:211], v[20:23], v[48:63]
    v_smfmac_f32_16x16x64_bf16 v[80:83], v[84:87], v[16:23], v103
    s_setprio 0
    ds_read_b64_tr_b16 v[28:29], v10 offset:40960
    ds_read_b64_tr_b16 v[30:31], v10 offset:41472
    v_fma_f32 v119, v119, v121, v121
    v_rcp_f32 v116, v116
    v_rcp_f32 v117, v117
    v_rcp_f32 v118, v118
    v_rcp_f32 v119, v119
    s_waitcnt lgkmcnt(2)
    v_mfma_f32_32x32x16_bf16 v[48:63], v[212:215], v[24:27], v[48:63]
    ds_read_b64_tr_b16 v[108:109], v11 offset:40960
    ds_read_b64_tr_b16 v[110:111], v11 offset:41472
    v_mul_f32 v112, v40, v116
    v_mul_f32 v113, v41, v117
    v_mul_f32 v114, v42, v118
    v_mul_f32 v115, v43, v119
    v_cvt_pk_bf16_f32 v104, v112, v113
    v_cvt_pk_bf16_f32 v105, v114, v115
    v_mul_f32 v116, v44, v44
    v_mul_f32 v117, v45, v45
    s_waitcnt lgkmcnt(2)
    v_mfma_f32_32x32x16_bf16 v[48:63], v[216:219], v[28:31], v[48:63]
    s_waitcnt vmcnt(13)
    s_barrier
    ds_read_b64_tr_b16 v[16:17], v8 offset:49152
    ds_read_b64_tr_b16 v[18:19], v8 offset:49664
    v_mul_f32 v118, v46, v46
    v_mul_f32 v119, v47, v47
    v_fma_f32 v116, v116, v123, v122
    v_fma_f32 v117, v117, v123, v122
    v_fma_f32 v118, v118, v123, v122
    v_fma_f32 v119, v119, v123, v122
    s_waitcnt lgkmcnt(2)
    v_mfma_f32_32x32x16_bf16 v[48:63], v[220:223], v[108:111], v[48:63]
    s_add_u32 m0, s51, 16384
    s_lshl4_add_u32 s62, s75, 917504
    buffer_load_dwordx4 v6, s[20:23], s62 offen lds
    ds_read_b64_tr_b16 v[24:25], v9 offset:49152
    ds_read_b64_tr_b16 v[26:27], v9 offset:49664
    v_mul_f32 v116, v44, v116
    v_mul_f32 v117, v45, v117
    v_mul_f32 v118, v46, v118
    v_mul_f32 v119, v47, v119
    v_exp_f32 v116, v116
    v_exp_f32 v117, v117
    s_waitcnt lgkmcnt(2)
    v_mfma_f32_32x32x16_bf16 v[48:63], v[224:227], v[16:19], v[48:63]
    s_setprio 1
    ds_read_b64_tr_b16 v[28:29], v10 offset:49152
    ds_read_b64_tr_b16 v[30:31], v10 offset:49664
    v_exp_f32 v118, v118
    v_exp_f32 v119, v119
    v_fma_f32 v116, v116, v121, v121
    v_fma_f32 v117, v117, v121, v121
    v_fma_f32 v118, v118, v121, v121
    s_waitcnt lgkmcnt(2)
    v_mfma_f32_32x32x16_bf16 v[48:63], v[228:231], v[24:27], v[48:63]
    s_add_u32 m0, s51, 24576
    s_lshl4_add_u32 s62, s75, 1376256
    buffer_load_dwordx4 v6, s[20:23], s62 offen lds
    ds_read_b64_tr_b16 v[108:109], v11 offset:49152
    ds_read_b64_tr_b16 v[110:111], v11 offset:49664
    v_fma_f32 v119, v119, v121, v121
    v_rcp_f32 v116, v116
    v_rcp_f32 v117, v117
    v_rcp_f32 v118, v118
    v_rcp_f32 v119, v119
    s_waitcnt lgkmcnt(2)
    v_mfma_f32_32x32x16_bf16 v[48:63], v[232:235], v[28:31], v[48:63]
    v_add_u32 v8, 57344, v8
    v_add_u32 v9, 57344, v9
    v_add_u32 v10, 57344, v10
    v_add_u32 v11, 57344, v11
    ds_read_b64_tr_b16 v[20:21], v8 offset:0
    ds_read_b64_tr_b16 v[22:23], v8 offset:512
    v_mul_f32 v112, v44, v116
    v_mul_f32 v113, v45, v117
    v_mul_f32 v114, v46, v118
    v_mul_f32 v115, v47, v119
    v_cvt_pk_bf16_f32 v106, v112, v113
    v_cvt_pk_bf16_f32 v107, v114, v115
    buffer_store_dwordx4 v[104:107], v7, s[28:31], s60 offen offset:1024 sc1
    s_waitcnt lgkmcnt(2)
    v_mfma_f32_32x32x16_bf16 v[48:63], v[236:239], v[108:111], v[48:63]
    ds_read_b64_tr_b16 v[24:25], v9 offset:0
    ds_read_b64_tr_b16 v[26:27], v9 offset:512
    s_waitcnt lgkmcnt(2)
    v_mfma_f32_32x32x16_bf16 v[48:63], v[240:243], v[20:23], v[48:63]
    v_smfmac_f32_16x16x64_bf16 v[80:83], v[84:87], v[16:23], v103
    s_setprio 0
    ds_read_b64_tr_b16 v[28:29], v10 offset:0
    ds_read_b64_tr_b16 v[30:31], v10 offset:512
    s_waitcnt lgkmcnt(2)
    v_mfma_f32_32x32x16_bf16 v[48:63], v[244:247], v[24:27], v[48:63]
    ds_read_b64_tr_b16 v[108:109], v11 offset:0
    ds_read_b64_tr_b16 v[110:111], v11 offset:512
    s_waitcnt lgkmcnt(2)
    v_mfma_f32_32x32x16_bf16 v[48:63], v[248:251], v[28:31], v[48:63]
    s_nop 2
    v_add_f32 v82, v80, v81
    ds_write_b32 v2, v82 offset:256
    v_mov_b32 v80, 0
    v_mov_b32 v81, 0
    s_waitcnt vmcnt(14) lgkmcnt(0)
    s_barrier
    ds_read_b64_tr_b16 v[16:17], v8 offset:8192
    ds_read_b64_tr_b16 v[18:19], v8 offset:8704
    v_mfma_f32_32x32x16_bf16 v[48:63], v[252:255], v[108:111], v[48:63]
    s_add_u32 m0, s51, 32768
    s_lshl4_add_u32 s62, s63, 0
    buffer_load_dwordx4 v6, s[20:23], s62 offen lds
    ds_read_b64_tr_b16 v[24:25], v9 offset:8192
    ds_read_b64_tr_b16 v[26:27], v9 offset:8704
    ds_read2st64_b32 v[88:89], v126 offset0:33 offset1:41
    ds_read2st64_b32 v[90:91], v126 offset0:49 offset1:57
    v_mov_b32 v102, 0x3586
    v_mov_b32 v113, 0x35860000
    s_waitcnt lgkmcnt(4)
    v_mfma_f32_32x32x16_bf16 v[32:47], v[128:131], v[16:19], 0
    s_setprio 1
    ds_read_b64_tr_b16 v[28:29], v10 offset:8192
    ds_read_b64_tr_b16 v[30:31], v10 offset:8704
    s_waitcnt lgkmcnt(2)
    v_add_f32 v88, v88, v89
    v_add_f32 v90, v90, v91
    v_add_f32 v88, v88, v90
    v_and_b32 v112, 0xffff0000, v88
    v_mfma_f32_32x32x16_bf16 v[32:47], v[132:135], v[24:27], v[32:47]
    s_add_u32 m0, s51, 40960
    s_lshl4_add_u32 s62, s63, 458752
    buffer_load_dwordx4 v6, s[20:23], s62 offen lds
    ds_read_b64_tr_b16 v[108:109], v11 offset:8192
    ds_read_b64_tr_b16 v[110:111], v11 offset:8704
    v_sub_f32 v88, v88, v112
    v_cvt_pk_bf16_f32 v101, v112, v113
    v_cvt_pk_bf16_f32 v100, v112, v88
    s_waitcnt lgkmcnt(2)
    v_mfma_f32_32x32x16_bf16 v[32:47], v[136:139], v[28:31], v[32:47]
    ds_read_b64_tr_b16 v[20:21], v8 offset:16384
    ds_read_b64_tr_b16 v[22:23], v8 offset:16896
    v_mfma_f32_32x32x16_bf16 v[48:63], v[96:99], v[100:103], v[48:63]
    s_waitcnt lgkmcnt(2)
    v_mfma_f32_32x32x16_bf16 v[32:47], v[140:143], v[108:111], v[32:47]
    ds_read_b64_tr_b16 v[24:25], v9 offset:16384
    ds_read_b64_tr_b16 v[26:27], v9 offset:16896
    ds_read_b128 v[92:95], v127 offset:2048
    ds_read_b128 v[88:91], v127 offset:2080
    s_waitcnt lgkmcnt(4)
    v_mfma_f32_32x32x16_bf16 v[32:47], v[144:147], v[20:23], v[32:47]
    v_smfmac_f32_16x16x64_bf16 v[80:83], v[84:87], v[16:23], v103
    s_setprio 0
    ds_read_b64_tr_b16 v[28:29], v10 offset:16384
    ds_read_b64_tr_b16 v[30:31], v10 offset:16896
    s_waitcnt lgkmcnt(3)
    v_mul_f32 v112, v48, v92
    v_mul_f32 v113, v49, v93
    v_mfma_f32_32x32x16_bf16 v[32:47], v[148:151], v[24:27], v[32:47]
    ds_read_b64_tr_b16 v[108:109], v11 offset:16384
    ds_read_b64_tr_b16 v[110:111], v11 offset:16896
    v_mul_f32 v114, v50, v94
    v_mul_f32 v115, v51, v95
    v_mul_f32 v116, s64, v112
    v_mul_f32 v117, s64, v113
    v_mul_f32 v118, s64, v114
    s_waitcnt lgkmcnt(2)
    v_mfma_f32_32x32x16_bf16 v[32:47], v[152:155], v[28:31], v[32:47]
    s_waitcnt vmcnt(2)
    s_barrier
    s_cmp_lg_u32 s50, 1
    s_cbranch_scc1 L_pub_32
    v_mov_b32 v104, 1
    s_mov_b64 exec, 1
    buffer_store_dword v104, off, s[28:31], s68 sc1
    s_mov_b64 exec, -1
L_pub_32:
    ds_read_b64_tr_b16 v[16:17], v8 offset:24576
    ds_read_b64_tr_b16 v[18:19], v8 offset:25088
    v_mul_f32 v119, s64, v115
    v_max_f32 v112, s65, v112
    v_max_f32 v113, s65, v113
    v_max_f32 v114, s65, v114
    v_max_f32 v115, s65, v115
    s_waitcnt lgkmcnt(2)
    v_mfma_f32_32x32x16_bf16 v[32:47], v[156:159], v[108:111], v[32:47]
    s_add_u32 m0, s51, 49152
    s_lshl4_add_u32 s62, s63, 917504
    buffer_load_dwordx4 v6, s[20:23], s62 offen lds
    ds_read_b64_tr_b16 v[24:25], v9 offset:24576
    ds_read_b64_tr_b16 v[26:27], v9 offset:25088
    v_exp_f32 v116, v116 clamp
    v_exp_f32 v117, v117 clamp
    s_waitcnt lgkmcnt(2)
    v_mfma_f32_32x32x16_bf16 v[32:47], v[160:163], v[16:19], v[32:47]
    s_setprio 1
    ds_read_b64_tr_b16 v[28:29], v10 offset:24576
    ds_read_b64_tr_b16 v[30:31], v10 offset:25088
    v_exp_f32 v118, v118 clamp
    v_exp_f32 v119, v119 clamp
    s_waitcnt lgkmcnt(2)
    v_mfma_f32_32x32x16_bf16 v[32:47], v[164:167], v[24:27], v[32:47]
    s_add_u32 m0, s51, 57344
    s_lshl4_add_u32 s62, s63, 1376256
    buffer_load_dwordx4 v6, s[20:23], s62 offen lds
    ds_read_b64_tr_b16 v[108:109], v11 offset:24576
    ds_read_b64_tr_b16 v[110:111], v11 offset:25088
    v_add_f32 v112, v112, v116
    v_add_f32 v113, v113, v117
    v_add_f32 v114, v114, v118
    v_add_f32 v115, v115, v119
    s_waitcnt lgkmcnt(2)
    v_mfma_f32_32x32x16_bf16 v[32:47], v[168:171], v[28:31], v[32:47]
    ds_read_b64_tr_b16 v[20:21], v8 offset:32768
    ds_read_b64_tr_b16 v[22:23], v8 offset:33280
    v_cvt_pk_bf16_f32 v64, v112, v113
    v_cvt_pk_bf16_f32 v65, v114, v115
    v_add_f32 v112, v112, v113
    v_add_f32 v114, v114, v115
    v_add_f32 v125, v112, v114
    ds_read_b128 v[92:95], v127 offset:2112
    s_waitcnt lgkmcnt(3)
    v_mfma_f32_32x32x16_bf16 v[32:47], v[172:175], v[108:111], v[32:47]
    ds_read_b64_tr_b16 v[24:25], v9 offset:32768
    ds_read_b64_tr_b16 v[26:27], v9 offset:33280
    v_mul_f32 v112, v52, v88
    v_mul_f32 v113, v53, v89
    v_mul_f32 v114, v54, v90
    v_mul_f32 v115, v55, v91
    v_mul_f32 v116, s64, v112
    s_waitcnt lgkmcnt(3)
    v_mfma_f32_32x32x16_bf16 v[32:47], v[176:179], v[20:23], v[32:47]
    v_smfmac_f32_16x16x64_bf16 v[80:83], v[84:87], v[16:23], v103
    s_setprio 0
    ds_read_b64_tr_b16 v[28:29], v10 offset:32768
    ds_read_b64_tr_b16 v[30:31], v10 offset:33280
    v_mul_f32 v117, s64, v113
    v_mul_f32 v118, s64, v114
    v_mul_f32 v119, s64, v115
    v_max_f32 v112, s65, v112
    v_max_f32 v113, s65, v113
    s_waitcnt lgkmcnt(2)
    v_mfma_f32_32x32x16_bf16 v[32:47], v[180:183], v[24:27], v[32:47]
    ds_read_b64_tr_b16 v[108:109], v11 offset:32768
    ds_read_b64_tr_b16 v[110:111], v11 offset:33280
    v_max_f32 v114, s65, v114
    v_max_f32 v115, s65, v115
    v_exp_f32 v116, v116 clamp
    s_waitcnt lgkmcnt(2)
    v_mfma_f32_32x32x16_bf16 v[32:47], v[184:187], v[28:31], v[32:47]
    s_barrier
    ds_read_b64_tr_b16 v[16:17], v8 offset:40960
    ds_read_b64_tr_b16 v[18:19], v8 offset:41472
    v_exp_f32 v117, v117 clamp
    v_exp_f32 v118, v118 clamp
    v_exp_f32 v119, v119 clamp
    s_waitcnt lgkmcnt(2)
    v_mfma_f32_32x32x16_bf16 v[32:47], v[188:191], v[108:111], v[32:47]
    s_add_u32 m0, s51, 65536
    s_lshl4_add_u32 s62, s54, 0
    buffer_load_dwordx4 v6, s[20:23], s62 offen lds
    ds_read_b64_tr_b16 v[24:25], v9 offset:40960
    ds_read_b64_tr_b16 v[26:27], v9 offset:41472
    v_add_f32 v112, v112, v116
    v_add_f32 v113, v113, v117
    v_add_f32 v114, v114, v118
    s_waitcnt lgkmcnt(2)
    v_mfma_f32_32x32x16_bf16 v[32:47], v[192:195], v[16:19], v[32:47]
    s_setprio 1
    ds_read_b64_tr_b16 v[28:29], v10 offset:40960
    ds_read_b64_tr_b16 v[30:31], v10 offset:41472
    v_add_f32 v115, v115, v119
    v_cvt_pk_bf16_f32 v66, v112, v113
    v_cvt_pk_bf16_f32 v67, v114, v115
    v_add_f32 v112, v112, v113
    v_add_f32 v114, v114, v115
    s_waitcnt lgkmcnt(2)
    v_mfma_f32_32x32x16_bf16 v[32:47], v[196:199], v[24:27], v[32:47]
    s_add_u32 m0, s51, 73728
    s_lshl4_add_u32 s62, s54, 458752
    buffer_load_dwordx4 v6, s[20:23], s62 offen lds
    ds_read_b64_tr_b16 v[108:109], v11 offset:40960
    ds_read_b64_tr_b16 v[110:111], v11 offset:41472
    v_add_f32 v112, v112, v114
    v_add_f32 v125, v125, v112
    ds_read_b128 v[88:91], v127 offset:2144
    v_mul_f32 v112, v56, v92
    v_mul_f32 v113, v57, v93
    s_waitcnt lgkmcnt(3)
    v_mfma_f32_32x32x16_bf16 v[32:47], v[200:203], v[28:31], v[32:47]
    ds_read_b64_tr_b16 v[20:21], v8 offset:49152
    ds_read_b64_tr_b16 v[22:23], v8 offset:49664
    v_mul_f32 v114, v58, v94
    v_mul_f32 v115, v59, v95
    v_mul_f32 v116, s64, v112
    v_mul_f32 v117, s64, v113
    v_mul_f32 v118, s64, v114
    s_waitcnt lgkmcnt(3)
    v_mfma_f32_32x32x16_bf16 v[32:47], v[204:207], v[108:111], v[32:47]
    ds_read_b64_tr_b16 v[24:25], v9 offset:49152
    ds_read_b64_tr_b16 v[26:27], v9 offset:49664
    v_mul_f32 v119, s64, v115
    v_max_f32 v112, s65, v112
    v_max_f32 v113, s65, v113
    v_max_f32 v114, s65, v114
    v_max_f32 v115, s65, v115
    s_waitcnt lgkmcnt(2)
    v_mfma_f32_32x32x16_bf16 v[32:47], v[208:211], v[20:23], v[32:47]
    v_smfmac_f32_16x16x64_bf16 v[80:83], v[84:87], v[16:23], v103
    s_setprio 0
    ds_read_b64_tr_b16 v[28:29], v10 offset:49152
    ds_read_b64_tr_b16 v[30:31], v10 offset:49664
    v_exp_f32 v116, v116 clamp
    v_exp_f32 v117, v117 clamp
    v_exp_f32 v118, v118 clamp
    s_waitcnt lgkmcnt(2)
    v_mfma_f32_32x32x16_bf16 v[32:47], v[212:215], v[24:27], v[32:47]
    ds_read_b64_tr_b16 v[108:109], v11 offset:49152
    ds_read_b64_tr_b16 v[110:111], v11 offset:49664
    v_exp_f32 v119, v119 clamp
    v_add_f32 v112, v112, v116
    v_add_f32 v113, v113, v117
    s_waitcnt lgkmcnt(2)
    v_mfma_f32_32x32x16_bf16 v[32:47], v[216:219], v[28:31], v[32:47]
    s_barrier
    v_add_u32 v8, 57344, v8
    v_add_u32 v9, 57344, v9
    v_add_u32 v10, 57344, v10
    v_add_u32 v11, 57344, v11
    ds_read_b64_tr_b16 v[16:17], v8 offset:0
    ds_read_b64_tr_b16 v[18:19], v8 offset:512
    v_add_f32 v114, v114, v118
    v_add_f32 v115, v115, v119
    v_cvt_pk_bf16_f32 v68, v112, v113
    v_cvt_pk_bf16_f32 v69, v114, v115
    v_add_f32 v112, v112, v113
    s_waitcnt lgkmcnt(2)
    v_mfma_f32_32x32x16_bf16 v[32:47], v[220:223], v[108:111], v[32:47]
    s_add_u32 m0, s51, 81920
    s_lshl4_add_u32 s62, s54, 917504
    buffer_load_dwordx4 v6, s[20:23], s62 offen lds
    ds_read_b64_tr_b16 v[24:25], v9 offset:0
    ds_read_b64_tr_b16 v[26:27], v9 offset:512
    v_add_f32 v114, v114, v115
    v_add_f32 v112, v112, v114
    v_add_f32 v125, v125, v112
    v_mul_f32 v112, v60, v88
    s_waitcnt lgkmcnt(2)
    v_mfma_f32_32x32x16_bf16 v[32:47], v[224:227], v[16:19], v[32:47]
    s_setprio 1
    ds_read_b64_tr_b16 v[28:29], v10 offset:0
    ds_read_b64_tr_b16 v[30:31], v10 offset:512
    v_mul_f32 v113, v61, v89
    v_mul_f32 v114, v62, v90
    v_mul_f32 v115, v63, v91
    v_mul_f32 v116, s64, v112
    v_mul_f32 v117, s64, v113
    s_waitcnt lgkmcnt(2)
    v_mfma_f32_32x32x16_bf16 v[32:47], v[228:231], v[24:27], v[32:47]
    s_add_u32 m0, s51, 90112
    s_lshl4_add_u32 s62, s54, 1376256
    buffer_load_dwordx4 v6, s[20:23], s62 offen lds
    ds_read_b64_tr_b16 v[108:109], v11 offset:0
    ds_read_b64_tr_b16 v[110:111], v11 offset:512
    v_mul_f32 v118, s64, v114
    v_mul_f32 v119, s64, v115
    v_max_f32 v112, s65, v112
    v_max_f32 v113, s65, v113
    s_waitcnt lgkmcnt(2)
    v_mfma_f32_32x32x16_bf16 v[32:47], v[232:235], v[28:31], v[32:47]
    ds_read_b64_tr_b16 v[20:21], v8 offset:8192
    ds_read_b64_tr_b16 v[22:23], v8 offset:8704
    v_max_f32 v114, s65, v114
    v_max_f32 v115, s65, v115
    v_exp_f32 v116, v116 clamp
    v_exp_f32 v117, v117 clamp
    s_waitcnt lgkmcnt(2)
    v_mfma_f32_32x32x16_bf16 v[32:47], v[236:239], v[108:111], v[32:47]
    ds_read_b64_tr_b16 v[24:25], v9 offset:8192
    ds_read_b64_tr_b16 v[26:27], v9 offset:8704
    v_exp_f32 v118, v118 clamp
    v_exp_f32 v119, v119 clamp
    v_add_f32 v112, v112, v116
    s_waitcnt lgkmcnt(2)
    v_mfma_f32_32x32x16_bf16 v[32:47], v[240:243], v[20:23], v[32:47]
    v_smfmac_f32_16x16x64_bf16 v[80:83], v[84:87], v[16:23], v103
    s_setprio 0
    ds_read_b64_tr_b16 v[28:29], v10 offset:8192
    ds_read_b64_tr_b16 v[30:31], v10 offset:8704
    v_add_f32 v113, v113, v117
    v_add_f32 v114, v114, v118
    v_add_f32 v115, v115, v119
    v_cvt_pk_bf16_f32 v70, v112, v113
    v_cvt_pk_bf16_f32 v71, v114, v115
    s_waitcnt lgkmcnt(2)
    v_mfma_f32_32x32x16_bf16 v[32:47], v[244:247], v[24:27], v[32:47]
    ds_read_b64_tr_b16 v[108:109], v11 offset:8192
    ds_read_b64_tr_b16 v[110:111], v11 offset:8704
    v_add_f32 v112, v112, v113
    v_add_f32 v114, v114, v115
    v_add_f32 v112, v112, v114
    v_add_f32 v125, v125, v112
    v_lshlrev_b32 v112, 2, v0
    v_add_u32 v112, 147456, v112
    ds_write_b32 v112, v125
    s_waitcnt lgkmcnt(3)
    v_mfma_f32_32x32x16_bf16 v[32:47], v[248:251], v[28:31], v[32:47]
    v_add_f32 v82, v80, v81
    ds_write_b32 v2, v82 offset:768
    v_mov_b32 v80, 0
    v_mov_b32 v81, 0
    s_waitcnt lgkmcnt(0)
    s_barrier
    ds_read2st64_b32 v[88:89], v126 offset0:35 offset1:43
    ds_read2st64_b32 v[90:91], v126 offset0:51 offset1:59
    v_mov_b32 v102, 0x0
    v_mov_b32 v113, 0x0
    v_mfma_f32_32x32x16_bf16 v[32:47], v[252:255], v[108:111], v[32:47]
    s_add_u32 m0, s51, 98304
    s_lshl4_add_u32 s62, s53, 0
    buffer_load_dwordx4 v6, s[20:23], s62 offen lds
    s_setprio 0
    s_waitcnt lgkmcnt(0)
    v_add_f32 v88, v88, v89
    v_add_f32 v90, v90, v91
    v_add_f32 v88, v88, v90
    v_and_b32 v112, 0xffff0000, v88
    v_sub_f32 v88, v88, v112
    v_cvt_pk_bf16_f32 v101, v112, v113
    v_cvt_pk_bf16_f32 v100, v112, v88
    s_nop 1
    v_mfma_f32_32x32x16_bf16 v[32:47], v[96:99], v[100:103], v[32:47]
    s_add_u32 m0, s51, 106496
    s_lshl4_add_u32 s62, s53, 458752
    buffer_load_dwordx4 v6, s[20:23], s62 offen lds
    v_lshrrev_b32 v8, 5, v1
    v_lshlrev_b32 v8, 9, v8
    v_bfe_u32 v112, v1, 2, 2
    v_lshl_add_u32 v8, v112, 7, v8
    v_bfe_u32 v112, v1, 3, 1
    v_lshl_add_u32 v8, v112, 6, v8
    v_bfe_u32 v112, v1, 4, 1
    v_lshl_add_u32 v8, v112, 5, v8
    v_bfe_u32 v112, v1, 0, 2
    v_lshl_add_u32 v8, v112, 3, v8
    s_and_b32 s72, s50, 3
    s_lshl_b32 s72, s72, 13
    v_add_u32 v8, s72, v8
    v_xor_b32 v9, 64, v8
    v_add_u32 v10, 0x10000, v8
    v_add_u32 v11, 0x10000, v9
    ds_read_b128 v[92:95], v127 offset:2048
    ds_read_b128 v[88:91], v127 offset:2080
    s_waitcnt lgkmcnt(1)
    v_mul_f32 v112, v32, v92
    v_mul_f32 v113, v33, v93
    v_mul_f32 v114, v34, v94
    v_mul_f32 v115, v35, v95
    v_cvt_pk_bf16_f32 v72, v112, v113
    v_cvt_pk_bf16_f32 v73, v114, v115
    ds_read_b128 v[92:95], v127 offset:2112
    s_waitcnt lgkmcnt(1)
    v_mul_f32 v112, v36, v88
    v_mul_f32 v113, v37, v89
    v_mul_f32 v114, v38, v90
    v_mul_f32 v115, v39, v91
    v_cvt_pk_bf16_f32 v74, v112, v113
    v_cvt_pk_bf16_f32 v75, v114, v115
    ds_read_b128 v[88:91], v127 offset:2144
    s_waitcnt lgkmcnt(1)
    v_mul_f32 v112, v40, v92
    v_mul_f32 v113, v41, v93
    v_mul_f32 v114, v42, v94
    v_mul_f32 v115, v43, v95
    v_cvt_pk_bf16_f32 v76, v112, v113
    v_cvt_pk_bf16_f32 v77, v114, v115
    s_waitcnt lgkmcnt(0)
    v_mul_f32 v112, v44, v88
    v_mul_f32 v113, v45, v89
    v_mul_f32 v114, v46, v90
    v_mul_f32 v115, v47, v91
    v_cvt_pk_bf16_f32 v78, v112, v113
    v_cvt_pk_bf16_f32 v79, v114, v115
    v_mfma_f32_32x32x16_bf16 v[88:103], v[64:67], v[72:75], 0
    s_nop 0
    v_mfma_f32_32x32x16_bf16 v[88:103], v[68:71], v[76:79], v[88:103]
    v_lshlrev_b32 v112, 2, v1
    s_lshl_b32 s72, s51, 1
    s_add_u32 s72, s72, 131072
    v_add_u32 v112, s72, v112
    s_lshr_b32 s72, s50, 1
    s_and_b32 s73, s50, 1
    v_and_b32 v116, 3, v1
    v_lshlrev_b32 v116, 8, v116
    v_and_b32 v117, 0x3c, v1
    v_add_u32 v116, v116, v117
    s_lshr_b32 s69, s50, 2
    s_lshl_b32 s69, s69, 13
    s_lshl_b32 s62, s73, 10
    s_add_u32 s69, s69, s62
    s_and_b32 s62, s72, 1
    s_lshl_b32 s62, s62, 6
    s_add_u32 s69, s69, s62
    s_add_u32 s69, s69, 131072
    v_add_u32 v116, s69, v116
    v_add_u32 v117, 128, v116
    v_and_b32 v118, 31, v1
    v_lshrrev_b32 v119, 5, v1
    v_lshl_add_u32 v118, v119, 8, v118
    v_lshlrev_b32 v118, 2, v118
    v_add_u32 v118, 147456, v118
    v_cndmask_b32 v88, v96, v88, s[48:49]
    v_cndmask_b32 v89, v97, v89, s[48:49]
    v_cndmask_b32 v90, v98, v90, s[48:49]
    v_cndmask_b32 v91, v99, v91, s[48:49]
    v_cndmask_b32 v92, v100, v92, s[48:49]
    v_cndmask_b32 v93, v101, v93, s[48:49]
    v_cndmask_b32 v94, v102, v94, s[48:49]
    v_cndmask_b32 v95, v103, v95, s[48:49]
    ds_write2st64_b32 v112, v88, v89 offset0:0 offset1:1
    ds_write2st64_b32 v112, v90, v91 offset0:2 offset1:3
    ds_write2st64_b32 v112, v92, v93 offset0:4 offset1:5
    ds_write2st64_b32 v112, v94, v95 offset0:6 offset1:7
    s_waitcnt lgkmcnt(0)
    s_barrier
    ds_read2st64_b32 v[48:49], v116 offset0:0 offset1:8
    ds_read2st64_b32 v[50:51], v116 offset0:16 offset1:24
    ds_read2st64_b32 v[52:53], v117 offset0:0 offset1:8
    ds_read2st64_b32 v[54:55], v117 offset0:16 offset1:24
    ds_read2_b32 v[56:57], v118 offset0:0 offset1:32
    ds_read2_b32 v[58:59], v118 offset0:64 offset1:96
    ds_read2_b32 v[60:61], v118 offset0:128 offset1:160
    ds_read2_b32 v[62:63], v118 offset0:192 offset1:224
    s_lshl_b32 s72, s72, 11
    s_lshl_b32 s73, s73, 9
    s_add_u32 s72, s72, s73
    s_add_u32 s72, s72, s71
    v_lshlrev_b32 v112, 2, v1
    v_lshrrev_b32 v114, 4, v1
    v_and_b32 v115, 15, v1
    v_lshlrev_b32 v115, 2, v115
    v_lshl_add_u32 v115, v114, 11, v115
    s_waitcnt lgkmcnt(4)
    v_add_f32 v48, v48, v49
    v_add_f32 v50, v50, v51
    v_add_f32 v48, v48, v50
    buffer_atomic_add_f32 v48, v112, s[28:31], s72 offen offset:0
    v_add_f32 v52, v52, v53
    v_add_f32 v54, v54, v55
    v_add_f32 v52, v52, v54
    buffer_atomic_add_f32 v52, v112, s[28:31], s72 offen offset:256
    s_waitcnt lgkmcnt(0)
    v_add_f32 v56, v56, v60
    v_add_f32 v57, v57, v61
    v_add_f32 v58, v58, v62
    v_add_f32 v59, v59, v63
    v_add_f32 v56, v56, v57
    v_add_f32 v58, v58, v59
    v_add_f32 v56, v56, v58
    s_cmp_eq_u32 s50, 2
    s_cselect_b32 s72, s71, 0x7ff00000
    buffer_atomic_add_f32 v56, v115, s[28:31], s72 offen offset:1024
    s_cmp_lg_u32 s50, 0
    s_cbranch_scc1 L_pi_33
    s_load_dwordx8 s[76:83], s[44:45], 0 glc
    s_load_dwordx8 s[84:91], s[44:45], 32 glc
L_pi_33:
    s_waitcnt vmcnt(0)
    s_barrier
    s_cmp_lg_u32 s50, 1
    s_cbranch_scc1 L_pk_34
    v_mov_b32 v112, 1
    v_lshlrev_b32 v113, 11, v1
    s_and_b32 s62, s2, 3
    s_lshl_b32 s62, s62, 7
    s_add_u32 s62, s62, 10487040
    s_mov_b64 exec, 0xffff
    buffer_atomic_add v112, v113, s[28:31], s62 offen
    s_mov_b64 exec, -1
L_pk_34:
    s_cmp_lg_u32 s50, 0
    s_cbranch_scc1 L_pc_35
    s_mov_b32 s69, 0
L_pl_36:
    s_waitcnt lgkmcnt(0)
    s_min_u32 s76, s76, s80
    s_min_u32 s77, s77, s81
    s_min_u32 s78, s78, s82
    s_min_u32 s79, s79, s83
    s_min_u32 s76, s76, s78
    s_min_u32 s77, s77, s79
    s_min_u32 s76, s76, s77
    s_min_u32 s84, s84, s88
    s_min_u32 s85, s85, s89
    s_min_u32 s86, s86, s90
    s_min_u32 s87, s87, s91
    s_min_u32 s84, s84, s86
    s_min_u32 s85, s85, s87
    s_min_u32 s84, s84, s85
    s_cmp_ge_u32 s84, 1
    s_cselect_b32 s76, s76, 0
    s_cmp_ge_u32 s76, 1
    s_cbranch_scc1 L_pc_35
    s_add_u32 s69, s69, 1
    s_cmp_ge_u32 s69, 0x40000
    s_cbranch_scc1 L_pc_35
    s_load_dwordx8 s[76:83], s[44:45], 0 glc
    s_load_dwordx8 s[84:91], s[44:45], 32 glc
    s_branch L_pl_36
L_pc_35:
    s_barrier
    v_lshlrev_b32 v3, 4, v1
    s_add_u32 s62, s70, s75
    buffer_load_dwordx4 v[128:131], v3, s[28:31], s62 offen offset:0 sc1
    s_add_u32 s62, s70, s75
    buffer_load_dwordx4 v[132:135], v3, s[28:31], s62 offen offset:1024 sc1
    s_add_u32 s62, s70, s75
    buffer_load_dwordx4 v[136:139], v3, s[28:31], s62 offen offset:2048 sc1
    s_add_u32 s62, s70, s75
    buffer_load_dwordx4 v[140:143], v3, s[28:31], s62 offen offset:3072 sc1
    s_add_u32 s62, s70, s63
    buffer_load_dwordx4 v[144:147], v3, s[28:31], s62 offen offset:0 sc1
    s_add_u32 s62, s70, s63
    buffer_load_dwordx4 v[148:151], v3, s[28:31], s62 offen offset:1024 sc1
    s_add_u32 s62, s70, s63
    buffer_load_dwordx4 v[152:155], v3, s[28:31], s62 offen offset:2048 sc1
    s_add_u32 s62, s70, s63
    buffer_load_dwordx4 v[156:159], v3, s[28:31], s62 offen offset:3072 sc1
    s_add_u32 s62, s70, s54
    buffer_load_dwordx4 v[160:163], v3, s[28:31], s62 offen offset:0 sc1
    s_add_u32 s62, s70, s54
    buffer_load_dwordx4 v[164:167], v3, s[28:31], s62 offen offset:1024 sc1
    s_add_u32 s62, s70, s54
    buffer_load_dwordx4 v[168:171], v3, s[28:31], s62 offen offset:2048 sc1
    s_add_u32 s62, s70, s54
    buffer_load_dwordx4 v[172:175], v3, s[28:31], s62 offen offset:3072 sc1
    s_add_u32 s62, s70, s53
    buffer_load_dwordx4 v[176:179], v3, s[28:31], s62 offen offset:0 sc1
    s_add_u32 s62, s70, s53
    buffer_load_dwordx4 v[180:183], v3, s[28:31], s62 offen offset:1024 sc1
    s_add_u32 s62, s70, s53
    buffer_load_dwordx4 v[184:187], v3, s[28:31], s62 offen offset:2048 sc1
    s_add_u32 s62, s70, s53
    buffer_load_dwordx4 v[188:191], v3, s[28:31], s62 offen offset:3072 sc1
    s_branch L_p2kv
.p2align 6
L_p2q:
    s_mov_b32 s12, s24
    s_mov_b32 s13, s25
    s_mov_b32 s14, 524288
    s_lshr_b32 s73, s2, 6
    s_add_u32 s73, s73, s67
    s_and_b32 s73, s73, 3
    s_bitcmp1_b32 s73, 0
    s_cselect_b32 s4, 5, 2
    s_cselect_b32 s5, 2, 5
    s_cselect_b32 s6, 1, 0
    s_cselect_b32 s7, 0, 1
    s_lshl_b32 s4, s4, 12
    s_lshl_b32 s5, s5, 12
    s_lshl_b32 s6, s6, 12
    s_lshl_b32 s7, s7, 12
    ds_read_b64_tr_b16 v[24:25], v8 offset:2048
    ds_read_b64_tr_b16 v[26:27], v8 offset:3072
    ds_read_b64_tr_b16 v[28:29], v9 offset:2048
    ds_read_b64_tr_b16 v[30:31], v9 offset:3072
    s_waitcnt vmcnt(20) lgkmcnt(4)
    v_mfma_f32_32x32x16_bf16 v[48:63], v[16:19], v[128:131], 0
    v_add_f32 v88, v88, v116
    v_add_f32 v89, v89, v117
    v_add_f32 v90, v90, v118
    v_add_f32 v91, v91, v119
    v_add_f32 v88, v88, v89
    v_add_f32 v90, v90, v91
    v_add_f32 v88, v88, v90
    v_and_b32 v112, 0xffff0000, v88
    v_sub_f32 v88, v88, v112
    v_cvt_pk_bf16_f32 v101, v112, v113
    v_cvt_pk_bf16_f32 v100, v112, v88
    v_mfma_f32_32x32x16_bf16 v[192:207], v[20:23], v[128:131], 0
    ds_write_b128 v124, v[40:43]
    ds_write_b128 v124, v[44:47] offset:8192
    s_waitcnt lgkmcnt(0)
    v_mfma_f32_32x32x16_bf16 v[32:47], v[100:103], v[96:99], v[32:47]
    s_barrier
    ds_read_b128 v[80:83], v125
    ds_read_b128 v[84:87], v125 offset:8192
    ds_read_b64_tr_b16 v[16:17], v8 offset:4096
    ds_read_b64_tr_b16 v[18:19], v8 offset:5120
    ds_read_b64_tr_b16 v[20:21], v9 offset:4096
    ds_read_b64_tr_b16 v[22:23], v9 offset:5120
    s_waitcnt vmcnt(19)
    v_mfma_f32_32x32x16_bf16 v[48:63], v[24:27], v[132:135], v[48:63]
    s_add_u32 m0, s51, 139264
    s_lshl4_add_u32 s62, s6, 131072
    buffer_load_dwordx4 v6, s[12:15], s62 offen lds
    s_add_u32 m0, s51, 131072
    s_lshl4_add_u32 s62, s6, 0
    buffer_load_dwordx4 v6, s[12:15], s62 offen lds
    v_lshrrev_b32 v248, 4, v1
    v_bfe_u32 v249, v1, 2, 2
    v_lshlrev_b32 v249, 4, v249
    v_lshl_add_u32 v12, v248, 11, v249
    s_and_b32 s72, s50, 3
    s_lshr_b32 s73, s50, 2
    s_lshl1_add_u32 s73, s72, s73
    s_lshl_b32 s71, s73, 13
    s_add_u32 s71, s71, 10485760
    v_mfma_f32_32x32x16_bf16 v[192:207], v[28:31], v[132:135], v[192:207]
    s_waitcnt lgkmcnt(4)
    v_add_f32 v32, v32, v80
    v_add_f32 v33, v33, v81
    v_add_f32 v34, v34, v82
    v_add_f32 v35, v35, v83
    v_add_f32 v36, v36, v84
    v_add_f32 v37, v37, v85
    v_add_f32 v38, v38, v86
    v_add_f32 v39, v39, v87
    v_mul_f32 v116, v32, v32
    ds_read_b64_tr_b16 v[24:25], v8 offset:6144
    ds_read_b64_tr_b16 v[26:27], v8 offset:7168
    ds_read_b64_tr_b16 v[28:29], v9 offset:6144
    ds_read_b64_tr_b16 v[30:31], v9 offset:7168
    s_waitcnt vmcnt(19) lgkmcnt(4)
    v_mfma_f32_32x32x16_bf16 v[48:63], v[16:19], v[136:139], v[48:63]
    s_add_u32 m0, s51, 147456
    s_lshl4_add_u32 s62, s6, 262144
    buffer_load_dwordx4 v6, s[12:15], s62 offen lds
    v_mul_f32 v117, v33, v33
    v_mul_f32 v118, v34, v34
    v_mul_f32 v119, v35, v35
    v_fma_f32 v116, v116, v123, v122
    v_fma_f32 v117, v117, v123, v122
    v_fma_f32 v118, v118, v123, v122
    v_fma_f32 v119, v119, v123, v122
    v_mul_f32 v116, v32, v116
    v_mul_f32 v117, v33, v117
    v_mul_f32 v118, v34, v118
    v_mul_f32 v119, v35, v119
    v_mfma_f32_32x32x16_bf16 v[192:207], v[20:23], v[136:139], v[192:207]
    v_exp_f32 v116, v116
    v_exp_f32 v117, v117
    v_exp_f32 v118, v118
    v_exp_f32 v119, v119
    v_fma_f32 v116, v116, v121, v121
    v_fma_f32 v117, v117, v121, v121
    v_fma_f32 v118, v118, v121, v121
    v_fma_f32 v119, v119, v121, v121
    s_waitcnt vmcnt(19) lgkmcnt(0)
    s_waitcnt vmcnt(8)
    s_barrier
    ds_read_b64_tr_b16 v[16:17], v8 offset:32768
    ds_read_b64_tr_b16 v[18:19], v8 offset:33792
    ds_read_b64_tr_b16 v[20:21], v9 offset:32768
    ds_read_b64_tr_b16 v[22:23], v9 offset:33792
    s_cmp_lg_u32 s50, 1
    s_cbranch_scc1 L_pub_37
    v_mov_b32 v255, 3
    s_mov_b64 exec, 1
    buffer_store_dword v255, off, s[28:31], s68 sc1
    s_mov_b64 exec, -1
L_pub_37:
    v_mfma_f32_32x32x16_bf16 v[48:63], v[24:27], v[140:143], v[48:63]
    s_add_u32 m0, s51, 155648
    s_lshl4_add_u32 s62, s6, 393216
    buffer_load_dwordx4 v6, s[12:15], s62 offen lds
    v_rcp_f32 v116, v116
    v_rcp_f32 v117, v117
    v_rcp_f32 v118, v118
    v_rcp_f32 v119, v119
    v_mul_f32 v112, v32, v116
    v_mul_f32 v113, v33, v117
    v_mul_f32 v114, v34, v118
    v_mul_f32 v115, v35, v119
    v_mfma_f32_32x32x16_bf16 v[192:207], v[28:31], v[140:143], v[192:207]
    v_cvt_pk_bf16_f32 v104, v112, v113
    v_cvt_pk_bf16_f32 v105, v114, v115
    v_mul_f32 v116, v36, v36
    v_mul_f32 v117, v37, v37
    v_mul_f32 v118, v38, v38
    v_mul_f32 v119, v39, v39
    v_fma_f32 v116, v116, v123, v122
    v_fma_f32 v117, v117, v123, v122
    v_fma_f32 v118, v118, v123, v122
    v_fma_f32 v119, v119, v123, v122
    v_mul_f32 v116, v36, v116
    ds_read_b64_tr_b16 v[24:25], v8 offset:34816
    ds_read_b64_tr_b16 v[26:27], v8 offset:35840
    ds_read_b64_tr_b16 v[28:29], v9 offset:34816
    ds_read_b64_tr_b16 v[30:31], v9 offset:35840
    s_waitcnt lgkmcnt(4)
    v_mfma_f32_32x32x16_bf16 v[48:63], v[16:19], v[144:147], v[48:63]
    s_add_u32 m0, s51, 114688
    s_lshl4_add_u32 s62, s53, 917504
    buffer_load_dwordx4 v6, s[20:23], s62 offen lds
    v_mul_f32 v117, v37, v117
    v_mul_f32 v118, v38, v118
    v_mul_f32 v119, v39, v119
    v_exp_f32 v116, v116
    v_exp_f32 v117, v117
    v_exp_f32 v118, v118
    v_exp_f32 v119, v119
    v_fma_f32 v116, v116, v121, v121
    v_fma_f32 v117, v117, v121, v121
    v_mfma_f32_32x32x16_bf16 v[192:207], v[20:23], v[144:147], v[192:207]
    s_add_u32 m0, s51, 0
    s_lshl4_add_u32 s62, s7, 0
    buffer_load_dwordx4 v6, s[12:15], s62 offen lds
    v_fma_f32 v118, v118, v121, v121
    v_fma_f32 v119, v119, v121, v121
    v_rcp_f32 v116, v116
    v_rcp_f32 v117, v117
    v_rcp_f32 v118, v118
    v_rcp_f32 v119, v119
    v_mul_f32 v112, v36, v116
    s_cmp_lg_u32 s50, 0
    s_cbranch_scc1 L_pi_38
    s_load_dwordx8 s[76:83], s[44:45], 0 glc
    s_load_dword s84, s[44:45], 128 glc
    s_load_dword s85, s[44:45], 256 glc
    s_load_dword s86, s[44:45], 384 glc
    s_load_dword s87, s[44:45], 512 glc
L_pi_38:
    ds_read_b64_tr_b16 v[16:17], v8 offset:36864
    ds_read_b64_tr_b16 v[18:19], v8 offset:37888
    ds_read_b64_tr_b16 v[20:21], v9 offset:36864
    ds_read_b64_tr_b16 v[22:23], v9 offset:37888
    s_waitcnt lgkmcnt(4)
    v_mfma_f32_32x32x16_bf16 v[48:63], v[24:27], v[148:151], v[48:63]
    s_add_u32 m0, s51, 122880
    s_lshl4_add_u32 s62, s53, 1376256
    buffer_load_dwordx4 v6, s[20:23], s62 offen lds
    v_mul_f32 v113, v37, v117
    v_mul_f32 v114, v38, v118
    v_mul_f32 v115, v39, v119
    v_cvt_pk_bf16_f32 v106, v112, v113
    v_cvt_pk_bf16_f32 v107, v114, v115
    buffer_store_dwordx4 v[104:107], v7, s[28:31], s60 offen offset:0 sc1
    v_and_b32 v248, 31, v1
    v_lshrrev_b32 v249, 5, v1
    v_and_b32 v250, 7, v1
    v_bfe_u32 v251, v1, 3, 0
    v_xor_b32 v249, v249, v251
    v_mfma_f32_32x32x16_bf16 v[192:207], v[28:31], v[148:151], v[192:207]
    s_add_u32 m0, s51, 8192
    s_lshl4_add_u32 s62, s7, 131072
    buffer_load_dwordx4 v6, s[12:15], s62 offen lds
    v_lshlrev_b32 v248, 7, v248
    v_lshl_add_u32 v248, v249, 3, v248
    v_lshl_add_u32 v248, v250, 4, v248
    s_lshl_b32 s35, s73, 12
    v_add_u32 v14, s35, v248
    v_lshrrev_b32 v248, 3, v0
    v_and_b32 v249, 7, v248
    v_and_b32 v250, 7, v0
    v_lshlrev_b32 v5, 4, v250
    v_lshl_add_u32 v2, v248, 10, v5
    v_xor_b32 v249, v249, v250
    v_lshlrev_b32 v248, 7, v248
    v_lshl_add_u32 v15, v249, 4, v248
    ds_read_b64_tr_b16 v[24:25], v8 offset:38912
    ds_read_b64_tr_b16 v[26:27], v8 offset:39936
    ds_read_b64_tr_b16 v[28:29], v9 offset:38912
    ds_read_b64_tr_b16 v[30:31], v9 offset:39936
    s_waitcnt lgkmcnt(4)
    v_mfma_f32_32x32x16_bf16 v[48:63], v[16:19], v[152:155], v[48:63]
    v_mfma_f32_32x32x16_bf16 v[192:207], v[20:23], v[152:155], v[192:207]
    s_add_u32 m0, s51, 16384
    s_lshl4_add_u32 s62, s7, 262144
    buffer_load_dwordx4 v6, s[12:15], s62 offen lds
    s_waitcnt lgkmcnt(0)
    s_cmp_lg_u32 s50, 0
    s_cbranch_scc1 L_pc_39
    s_mov_b32 s69, 0
L_pl_40:
    s_waitcnt lgkmcnt(0)
    s_min_u32 s76, s76, s80
    s_min_u32 s77, s77, s81
    s_min_u32 s78, s78, s82
    s_min_u32 s79, s79, s83
    s_min_u32 s76, s76, s78
    s_min_u32 s77, s77, s79
    s_min_u32 s76, s76, s77
    s_add_u32 s84, s84, s85
    s_add_u32 s86, s86, s87
    s_add_u32 s84, s84, s86
    s_cmp_ge_u32 s84, 128
    s_cselect_b32 s76, s76, 0
    s_cmp_ge_u32 s76, 2
    s_cbranch_scc1 L_pc_39
    s_add_u32 s69, s69, 1
    s_cmp_ge_u32 s69, 0x40000
    s_cbranch_scc1 L_pc_39
    s_load_dwordx8 s[76:83], s[44:45], 0 glc
    s_load_dword s84, s[44:45], 128 glc
    s_load_dword s85, s[44:45], 256 glc
    s_load_dword s86, s[44:45], 384 glc
    s_load_dword s87, s[44:45], 512 glc
    s_branch L_pl_40
L_pc_39:
    s_barrier
    ds_read_b64_tr_b16 v[16:17], v10 offset:0
    ds_read_b64_tr_b16 v[18:19], v10 offset:1024
    ds_read_b64_tr_b16 v[20:21], v11 offset:0
    ds_read_b64_tr_b16 v[22:23], v11 offset:1024
    v_mfma_f32_32x32x16_bf16 v[48:63], v[24:27], v[156:159], v[48:63]
    v_mfma_f32_32x32x16_bf16 v[192:207], v[28:31], v[156:159], v[192:207]
    s_add_u32 m0, s51, 24576
    s_lshl4_add_u32 s62, s7, 393216
    buffer_load_dwordx4 v6, s[12:15], s62 offen lds
    ds_read_b64_tr_b16 v[24:25], v10 offset:2048
    ds_read_b64_tr_b16 v[26:27], v10 offset:3072
    ds_read_b64_tr_b16 v[28:29], v11 offset:2048
    ds_read_b64_tr_b16 v[30:31], v11 offset:3072
    s_waitcnt lgkmcnt(4)
    v_mfma_f32_32x32x16_bf16 v[48:63], v[16:19], v[160:163], v[48:63]
    s_add_u32 s62, s71, 0
    buffer_load_dwordx4 v[208:211], v3, s[28:31], s62 offen sc1
    v_mfma_f32_32x32x16_bf16 v[192:207], v[20:23], v[160:163], v[192:207]
    s_add_u32 s62, s74, s6
    buffer_load_dwordx4 v[128:131], v3, s[28:31], s62 offen offset:0 sc1
    ds_read_b64_tr_b16 v[16:17], v10 offset:4096
    ds_read_b64_tr_b16 v[18:19], v10 offset:5120
    ds_read_b64_tr_b16 v[20:21], v11 offset:4096
    ds_read_b64_tr_b16 v[22:23], v11 offset:5120
    s_waitcnt lgkmcnt(4)
    v_mfma_f32_32x32x16_bf16 v[48:63], v[24:27], v[164:167], v[48:63]
    s_add_u32 s62, s71, 2048
    buffer_load_dwordx4 v[212:215], v3, s[28:31], s62 offen sc1
    v_mfma_f32_32x32x16_bf16 v[192:207], v[28:31], v[164:167], v[192:207]
    s_add_u32 s62, s74, s6
    buffer_load_dwordx4 v[132:135], v3, s[28:31], s62 offen offset:1024 sc1
    ds_read_b64_tr_b16 v[24:25], v10 offset:6144
    ds_read_b64_tr_b16 v[26:27], v10 offset:7168
    ds_read_b64_tr_b16 v[28:29], v11 offset:6144
    ds_read_b64_tr_b16 v[30:31], v11 offset:7168
    s_waitcnt lgkmcnt(4)
    v_mfma_f32_32x32x16_bf16 v[48:63], v[16:19], v[168:171], v[48:63]
    s_add_u32 s62, s71, 4096
    buffer_load_dwordx4 v[216:219], v3, s[28:31], s62 offen sc1
    v_mfma_f32_32x32x16_bf16 v[192:207], v[20:23], v[168:171], v[192:207]
    s_add_u32 s62, s74, s6
    buffer_load_dwordx4 v[136:139], v3, s[28:31], s62 offen offset:2048 sc1
    s_waitcnt vmcnt(21) lgkmcnt(0)
    s_waitcnt vmcnt(9)
    s_barrier
    ds_read_b64_tr_b16 v[16:17], v10 offset:32768
    ds_read_b64_tr_b16 v[18:19], v10 offset:33792
    ds_read_b64_tr_b16 v[20:21], v11 offset:32768
    ds_read_b64_tr_b16 v[22:23], v11 offset:33792
    s_cmp_lg_u32 s50, 1
    s_cbranch_scc1 L_pub_41
    v_mov_b32 v255, 4
    s_mov_b64 exec, 1
    buffer_store_dword v255, off, s[28:31], s68 sc1
    s_mov_b64 exec, -1
L_pub_41:
    v_mfma_f32_32x32x16_bf16 v[48:63], v[24:27], v[172:175], v[48:63]
    s_add_u32 s62, s71, 6144
    buffer_load_dwordx4 v[220:223], v3, s[28:31], s62 offen sc1
    buffer_load_dwordx4 v[224:227], v12, s[28:31], s71 offen offset:1024 sc1
    v_mfma_f32_32x32x16_bf16 v[192:207], v[28:31], v[172:175], v[192:207]
    s_add_u32 s62, s74, s6
    buffer_load_dwordx4 v[140:143], v3, s[28:31], s62 offen offset:3072 sc1
    s_branch L_p2tail
.p2align 6
L_p2kv:
    s_mov_b32 s12, s24
    s_mov_b32 s13, s25
    s_mov_b32 s14, 524288
    s_lshr_b32 s73, s2, 6
    s_add_u32 s73, s73, s67
    s_and_b32 s73, s73, 3
    s_bitcmp1_b32 s73, 0
    s_cselect_b32 s4, 5, 2
    s_cselect_b32 s5, 2, 5
    s_cselect_b32 s6, 1, 0
    s_cselect_b32 s7, 0, 1
    s_lshl_b32 s4, s4, 12
    s_lshl_b32 s5, s5, 12
    s_lshl_b32 s6, s6, 12
    s_lshl_b32 s7, s7, 12
    ds_read_b64_tr_b16 v[16:17], v8 offset:0
    ds_read_b64_tr_b16 v[18:19], v8 offset:1024
    ds_read_b64_tr_b16 v[20:21], v9 offset:0
    ds_read_b64_tr_b16 v[22:23], v9 offset:1024
    ds_read_b64_tr_b16 v[24:25], v8 offset:2048
    ds_read_b64_tr_b16 v[26:27], v8 offset:3072
    ds_read_b64_tr_b16 v[28:29], v9 offset:2048
    ds_read_b64_tr_b16 v[30:31], v9 offset:3072
    s_waitcnt vmcnt(15) lgkmcnt(4)
    v_mfma_f32_32x32x16_bf16 v[48:63], v[16:19], v[128:131], 0
    s_add_u32 m0, s51, 131072
    s_lshl4_add_u32 s62, s6, 0
    buffer_load_dwordx4 v6, s[12:15], s62 offen lds
    v_lshrrev_b32 v248, 4, v1
    v_bfe_u32 v249, v1, 2, 2
    v_lshlrev_b32 v249, 4, v249
    v_lshl_add_u32 v12, v248, 11, v249
    s_and_b32 s72, s50, 3
    s_lshr_b32 s73, s50, 2
    s_lshl1_add_u32 s73, s72, s73
    s_lshl_b32 s71, s73, 13
    s_add_u32 s71, s71, 10485760
    v_and_b32 v248, 31, v1
    v_lshrrev_b32 v249, 5, v1
    v_mfma_f32_32x32x16_bf16 v[192:207], v[20:23], v[128:131], 0
    v_and_b32 v250, 7, v1
    v_bfe_u32 v251, v1, 3, 0
    v_xor_b32 v249, v249, v251
    v_lshlrev_b32 v248, 7, v248
    v_lshl_add_u32 v248, v249, 3, v248
    v_lshl_add_u32 v248, v250, 4, v248
    s_lshl_b32 s35, s73, 12
    ds_read_b64_tr_b16 v[16:17], v8 offset:4096
    ds_read_b64_tr_b16 v[18:19], v8 offset:5120
    ds_read_b64_tr_b16 v[20:21], v9 offset:4096
    ds_read_b64_tr_b16 v[22:23], v9 offset:5120
    s_waitcnt vmcnt(15) lgkmcnt(4)
    v_mfma_f32_32x32x16_bf16 v[48:63], v[24:27], v[132:135], v[48:63]
    s_add_u32 m0, s51, 139264
    s_lshl4_add_u32 s62, s6, 131072
    buffer_load_dwordx4 v6, s[12:15], s62 offen lds
    v_add_u32 v14, s35, v248
    v_lshrrev_b32 v248, 3, v0
    v_and_b32 v249, 7, v248
    v_and_b32 v250, 7, v0
    v_lshlrev_b32 v5, 4, v250
    v_lshl_add_u32 v2, v248, 10, v5
    v_mfma_f32_32x32x16_bf16 v[192:207], v[28:31], v[132:135], v[192:207]
    v_xor_b32 v249, v249, v250
    v_lshlrev_b32 v248, 7, v248
    v_lshl_add_u32 v15, v249, 4, v248
    ds_read_b64_tr_b16 v[24:25], v8 offset:6144
    ds_read_b64_tr_b16 v[26:27], v8 offset:7168
    ds_read_b64_tr_b16 v[28:29], v9 offset:6144
    ds_read_b64_tr_b16 v[30:31], v9 offset:7168
    s_waitcnt vmcnt(15) lgkmcnt(4)
    v_mfma_f32_32x32x16_bf16 v[48:63], v[16:19], v[136:139], v[48:63]
    s_add_u32 m0, s51, 147456
    s_lshl4_add_u32 s62, s6, 262144
    buffer_load_dwordx4 v6, s[12:15], s62 offen lds
    v_mfma_f32_32x32x16_bf16 v[192:207], v[20:23], v[136:139], v[192:207]
    s_waitcnt vmcnt(15) lgkmcnt(0)
    s_barrier
    ds_read_b64_tr_b16 v[16:17], v8 offset:32768
    ds_read_b64_tr_b16 v[18:19], v8 offset:33792
    ds_read_b64_tr_b16 v[20:21], v9 offset:32768
    ds_read_b64_tr_b16 v[22:23], v9 offset:33792
    v_mfma_f32_32x32x16_bf16 v[48:63], v[24:27], v[140:143], v[48:63]
    s_add_u32 m0, s51, 155648
    s_lshl4_add_u32 s62, s6, 393216
    buffer_load_dwordx4 v6, s[12:15], s62 offen lds
    v_mfma_f32_32x32x16_bf16 v[192:207], v[28:31], v[140:143], v[192:207]
    ds_read_b64_tr_b16 v[24:25], v8 offset:34816
    ds_read_b64_tr_b16 v[26:27], v8 offset:35840
    ds_read_b64_tr_b16 v[28:29], v9 offset:34816
    ds_read_b64_tr_b16 v[30:31], v9 offset:35840
    s_waitcnt vmcnt(15) lgkmcnt(4)
    v_mfma_f32_32x32x16_bf16 v[48:63], v[16:19], v[144:147], v[48:63]
    s_add_u32 m0, s51, 114688
    s_lshl4_add_u32 s62, s53, 917504
    buffer_load_dwordx4 v6, s[20:23], s62 offen lds
    v_mfma_f32_32x32x16_bf16 v[192:207], v[20:23], v[144:147], v[192:207]
    s_add_u32 m0, s51, 0
    s_lshl4_add_u32 s62, s7, 0
    buffer_load_dwordx4 v6, s[12:15], s62 offen lds
    s_cmp_lg_u32 s50, 0
    s_cbranch_scc1 L_pi_42
    s_load_dwordx8 s[76:83], s[44:45], 0 glc
    s_load_dword s84, s[44:45], 128 glc
    s_load_dword s85, s[44:45], 256 glc
    s_load_dword s86, s[44:45], 384 glc
    s_load_dword s87, s[44:45], 512 glc
L_pi_42:
    ds_read_b64_tr_b16 v[16:17], v8 offset:36864
    ds_read_b64_tr_b16 v[18:19], v8 offset:37888
    ds_read_b64_tr_b16 v[20:21], v9 offset:36864
    ds_read_b64_tr_b16 v[22:23], v9 offset:37888
    s_waitcnt vmcnt(16) lgkmcnt(4)
    v_mfma_f32_32x32x16_bf16 v[48:63], v[24:27], v[148:151], v[48:63]
    s_add_u32 m0, s51, 122880
    s_lshl4_add_u32 s62, s53, 1376256
    buffer_load_dwordx4 v6, s[20:23], s62 offen lds
    v_mfma_f32_32x32x16_bf16 v[192:207], v[28:31], v[148:151], v[192:207]
    s_add_u32 m0, s51, 8192
    s_lshl4_add_u32 s62, s7, 131072
    buffer_load_dwordx4 v6, s[12:15], s62 offen lds
    ds_read_b64_tr_b16 v[24:25], v8 offset:38912
    ds_read_b64_tr_b16 v[26:27], v8 offset:39936
    ds_read_b64_tr_b16 v[28:29], v9 offset:38912
    ds_read_b64_tr_b16 v[30:31], v9 offset:39936
    s_waitcnt vmcnt(17) lgkmcnt(4)
    v_mfma_f32_32x32x16_bf16 v[48:63], v[16:19], v[152:155], v[48:63]
    v_mfma_f32_32x32x16_bf16 v[192:207], v[20:23], v[152:155], v[192:207]
    s_add_u32 m0, s51, 16384
    s_lshl4_add_u32 s62, s7, 262144
    buffer_load_dwordx4 v6, s[12:15], s62 offen lds
    s_waitcnt vmcnt(17) lgkmcnt(0)
    s_cmp_lg_u32 s50, 0
    s_cbranch_scc1 L_pc_43
    s_mov_b32 s69, 0
L_pl_44:
    s_waitcnt lgkmcnt(0)
    s_min_u32 s76, s76, s80
    s_min_u32 s77, s77, s81
    s_min_u32 s78, s78, s82
    s_min_u32 s79, s79, s83
    s_min_u32 s76, s76, s78
    s_min_u32 s77, s77, s79
    s_min_u32 s76, s76, s77
    s_add_u32 s84, s84, s85
    s_add_u32 s86, s86, s87
    s_add_u32 s84, s84, s86
    s_cmp_ge_u32 s84, 128
    s_cselect_b32 s76, s76, 0
    s_cmp_ge_u32 s76, 2
    s_cbranch_scc1 L_pc_43
    s_add_u32 s69, s69, 1
    s_cmp_ge_u32 s69, 0x40000
    s_cbranch_scc1 L_pc_43
    s_load_dwordx8 s[76:83], s[44:45], 0 glc
    s_load_dword s84, s[44:45], 128 glc
    s_load_dword s85, s[44:45], 256 glc
    s_load_dword s86, s[44:45], 384 glc
    s_load_dword s87, s[44:45], 512 glc
    s_branch L_pl_44
L_pc_43:
    s_barrier
    ds_read_b64_tr_b16 v[16:17], v10 offset:0
    ds_read_b64_tr_b16 v[18:19], v10 offset:1024
    ds_read_b64_tr_b16 v[20:21], v11 offset:0
    ds_read_b64_tr_b16 v[22:23], v11 offset:1024
    v_mfma_f32_32x32x16_bf16 v[48:63], v[24:27], v[156:159], v[48:63]
    v_mfma_f32_32x32x16_bf16 v[192:207], v[28:31], v[156:159], v[192:207]
    s_add_u32 m0, s51, 24576
    s_lshl4_add_u32 s62, s7, 393216
    buffer_load_dwordx4 v6, s[12:15], s62 offen lds
    ds_read_b64_tr_b16 v[24:25], v10 offset:2048
    ds_read_b64_tr_b16 v[26:27], v10 offset:3072
    ds_read_b64_tr_b16 v[28:29], v11 offset:2048
    ds_read_b64_tr_b16 v[30:31], v11 offset:3072
    s_waitcnt vmcnt(17) lgkmcnt(4)
    v_mfma_f32_32x32x16_bf16 v[48:63], v[16:19], v[160:163], v[48:63]
    s_add_u32 s62, s71, 0
    buffer_load_dwordx4 v[208:211], v3, s[28:31], s62 offen sc1
    v_mfma_f32_32x32x16_bf16 v[192:207], v[20:23], v[160:163], v[192:207]
    s_add_u32 s62, s74, s6
    buffer_load_dwordx4 v[128:131], v3, s[28:31], s62 offen offset:0 sc1
    ds_read_b64_tr_b16 v[16:17], v10 offset:4096
    ds_read_b64_tr_b16 v[18:19], v10 offset:5120
    ds_read_b64_tr_b16 v[20:21], v11 offset:4096
    ds_read_b64_tr_b16 v[22:23], v11 offset:5120
    s_waitcnt vmcnt(18) lgkmcnt(4)
    v_mfma_f32_32x32x16_bf16 v[48:63], v[24:27], v[164:167], v[48:63]
    s_add_u32 s62, s71, 2048
    buffer_load_dwordx4 v[212:215], v3, s[28:31], s62 offen sc1
    v_mfma_f32_32x32x16_bf16 v[192:207], v[28:31], v[164:167], v[192:207]
    s_add_u32 s62, s74, s6
    buffer_load_dwordx4 v[132:135], v3, s[28:31], s62 offen offset:1024 sc1
    ds_read_b64_tr_b16 v[24:25], v10 offset:6144
    ds_read_b64_tr_b16 v[26:27], v10 offset:7168
    ds_read_b64_tr_b16 v[28:29], v11 offset:6144
    ds_read_b64_tr_b16 v[30:31], v11 offset:7168
    s_waitcnt vmcnt(19) lgkmcnt(4)
    v_mfma_f32_32x32x16_bf16 v[48:63], v[16:19], v[168:171], v[48:63]
    s_add_u32 s62, s71, 4096
    buffer_load_dwordx4 v[216:219], v3, s[28:31], s62 offen sc1
    v_mfma_f32_32x32x16_bf16 v[192:207], v[20:23], v[168:171], v[192:207]
    s_add_u32 s62, s74, s6
    buffer_load_dwordx4 v[136:139], v3, s[28:31], s62 offen offset:2048 sc1
    s_waitcnt vmcnt(20) lgkmcnt(0)
    s_waitcnt vmcnt(9)
    s_barrier
    ds_read_b64_tr_b16 v[16:17], v10 offset:32768
    ds_read_b64_tr_b16 v[18:19], v10 offset:33792
    ds_read_b64_tr_b16 v[20:21], v11 offset:32768
    ds_read_b64_tr_b16 v[22:23], v11 offset:33792
    v_mfma_f32_32x32x16_bf16 v[48:63], v[24:27], v[172:175], v[48:63]
    s_add_u32 s62, s71, 6144
    buffer_load_dwordx4 v[220:223], v3, s[28:31], s62 offen sc1
    buffer_load_dwordx4 v[224:227], v12, s[28:31], s71 offen offset:1024 sc1
    v_mfma_f32_32x32x16_bf16 v[192:207], v[28:31], v[172:175], v[192:207]
    s_add_u32 s62, s74, s6
    buffer_load_dwordx4 v[140:143], v3, s[28:31], s62 offen offset:3072 sc1
L_p2tail:
    s_lshl_b32 s73, s73, 12
    s_add_u32 s73, s73, 65536
    v_and_b32 v248, 15, v1
    v_bfe_u32 v249, v1, 4, 1
    v_lshl_add_u32 v248, v249, 5, v248
    v_lshrrev_b32 v250, 5, v1
    v_lshlrev_b32 v248, 4, v248
    v_lshl_add_u32 v248, v250, 3, v248
    v_add_u32 v12, s73, v248
    v_xor_b32 v249, 1, v249
    ds_read_b64_tr_b16 v[24:25], v10 offset:34816
    ds_read_b64_tr_b16 v[26:27], v10 offset:35840
    ds_read_b64_tr_b16 v[28:29], v11 offset:34816
    ds_read_b64_tr_b16 v[30:31], v11 offset:35840
    s_waitcnt lgkmcnt(4)
    v_mfma_f32_32x32x16_bf16 v[48:63], v[16:19], v[176:179], v[48:63]
    s_add_u32 s62, s74, s7
    buffer_load_dwordx4 v[144:147], v3, s[28:31], s62 offen offset:0 sc1
    v_and_b32 v248, 3, v1
    v_lshl_add_u32 v248, v249, 4, v248
    v_bfe_u32 v249, v1, 2, 1
    v_lshl_add_u32 v248, v249, 5, v248
    v_lshlrev_b32 v248, 4, v248
    v_bfe_u32 v249, v1, 3, 1
    v_mfma_f32_32x32x16_bf16 v[192:207], v[20:23], v[176:179], v[192:207]
    s_add_u32 m0, s51, 32768
    s_lshl4_add_u32 s62, s4, 0
    buffer_load_dwordx4 v6, s[20:23], s62 offen lds
    v_lshl_add_u32 v248, v249, 3, v248
    v_lshrrev_b32 v249, 4, v1
    v_lshl_add_u32 v248, v249, 10, v248
    v_add_u32 v7, s73, v248
    s_lshl_b32 s73, s72, 13
    s_add_u32 s73, s73, 65536
    v_add_u32 v13, s73, v3
    v_add_u32 v4, s7, v13
    s_cmp_lg_u32 s50, 0
    s_cbranch_scc1 L_pi_45
    s_load_dwordx8 s[76:83], s[44:45], 0 glc
L_pi_45:
    ds_read_b64_tr_b16 v[16:17], v10 offset:36864
    ds_read_b64_tr_b16 v[18:19], v10 offset:37888
    ds_read_b64_tr_b16 v[20:21], v11 offset:36864
    ds_read_b64_tr_b16 v[22:23], v11 offset:37888
    s_waitcnt vmcnt(10)
    v_cvt_pk_bf16_f32 v208, v208, v209
    v_cvt_pk_bf16_f32 v209, v210, v211
    ds_write_b64 v12, v[208:209] offset:0
    s_waitcnt vmcnt(8)
    v_cvt_pk_bf16_f32 v212, v212, v213
    v_cvt_pk_bf16_f32 v213, v214, v215
    ds_write_b64 v12, v[212:213] offset:1280
    s_waitcnt lgkmcnt(6)
    v_mfma_f32_32x32x16_bf16 v[48:63], v[24:27], v[180:183], v[48:63]
    s_add_u32 s62, s74, s7
    buffer_load_dwordx4 v[148:151], v3, s[28:31], s62 offen offset:1024 sc1
    v_add_u32 v13, s6, v13
    s_mov_b32 s16, s26
    s_mov_b32 s17, s27
    s_mov_b32 s18, 2097152
    s_mov_b32 s40, s46
    s_mov_b32 s41, s47
    s_mov_b32 s42, 1024
    s_lshl_b32 s53, s66, 16
    s_lshl_b32 s73, s67, 7
    s_add_u32 s53, s53, s73
    v_mfma_f32_32x32x16_bf16 v[192:207], v[28:31], v[180:183], v[192:207]
    s_add_u32 m0, s51, 40960
    s_lshl4_add_u32 s62, s4, 458752
    buffer_load_dwordx4 v6, s[20:23], s62 offen lds
    ds_read_b64_tr_b16 v[24:25], v10 offset:38912
    ds_read_b64_tr_b16 v[26:27], v10 offset:39936
    ds_read_b64_tr_b16 v[28:29], v11 offset:38912
    ds_read_b64_tr_b16 v[30:31], v11 offset:39936
    s_waitcnt vmcnt(8)
    v_cvt_pk_bf16_f32 v216, v216, v217
    v_cvt_pk_bf16_f32 v217, v218, v219
    ds_write_b64 v12, v[216:217] offset:2048
    s_waitcnt vmcnt(6)
    v_cvt_pk_bf16_f32 v220, v220, v221
    v_cvt_pk_bf16_f32 v221, v222, v223
    ds_write_b64 v12, v[220:221] offset:3328
    s_waitcnt lgkmcnt(8)
    v_mfma_f32_32x32x16_bf16 v[48:63], v[16:19], v[184:187], v[48:63]
    s_add_u32 s62, s74, s7
    buffer_load_dwordx4 v[152:155], v3, s[28:31], s62 offen offset:2048 sc1
    v_mfma_f32_32x32x16_bf16 v[192:207], v[20:23], v[184:187], v[192:207]
    s_add_u32 m0, s51, 49152
    s_lshl4_add_u32 s62, s4, 917504
    buffer_load_dwordx4 v6, s[20:23], s62 offen lds
    s_waitcnt vmcnt(7)
    v_cvt_pk_bf16_f32 v224, v224, v225
    v_cvt_pk_bf16_f32 v225, v226, v227
    ds_write_b64 v7, v[224:225] offset:0
    ds_write_b64 v7, v[224:225] offset:64
    ds_write_b64 v7, v[224:225] offset:128
    ds_write_b64 v7, v[224:225] offset:192
    s_waitcnt lgkmcnt(6)
    s_cmp_lg_u32 s50, 0
    s_cbranch_scc1 L_pc_46
    s_mov_b32 s69, 0
L_pl_47:
    s_waitcnt lgkmcnt(0)
    s_min_u32 s76, s76, s80
    s_min_u32 s77, s77, s81
    s_min_u32 s78, s78, s82
    s_min_u32 s79, s79, s83
    s_min_u32 s76, s76, s78
    s_min_u32 s77, s77, s79
    s_min_u32 s76, s76, s77
    s_cmp_ge_u32 s76, 3
    s_cbranch_scc1 L_pc_46
    s_add_u32 s69, s69, 1
    s_cmp_ge_u32 s69, 0x40000
    s_cbranch_scc1 L_pc_46
    s_load_dwordx8 s[76:83], s[44:45], 0 glc
    s_branch L_pl_47
L_pc_46:
    s_waitcnt lgkmcnt(0)
    s_barrier
    ds_read_b128 v[96:99], v13 offset:0
    ds_read_b128 v[100:103], v13 offset:1024
    ds_read_b128 v[104:107], v13 offset:2048
    ds_read_b128 v[108:111], v13 offset:3072
    ds_read_b128 v[112:115], v4 offset:0
    ds_read_b128 v[116:119], v4 offset:1024
    ds_read_b128 v[120:123], v4 offset:2048
    ds_read_b128 v[124:127], v4 offset:3072
    v_add_u32 v10, 0x10000, v10
    v_add_u32 v11, 0x10000, v11
    ds_read_b64_tr_b16 v[16:17], v10 offset:0
    ds_read_b64_tr_b16 v[18:19], v10 offset:1024
    ds_read_b64_tr_b16 v[20:21], v11 offset:0
    ds_read_b64_tr_b16 v[22:23], v11 offset:1024
    v_mfma_f32_32x32x16_bf16 v[48:63], v[24:27], v[188:191], v[48:63]
    s_add_u32 s62, s74, s7
    buffer_load_dwordx4 v[156:159], v3, s[28:31], s62 offen offset:3072 sc1
    v_mfma_f32_32x32x16_bf16 v[192:207], v[28:31], v[188:191], v[192:207]
    s_add_u32 m0, s51, 57344
    s_lshl4_add_u32 s62, s4, 1376256
    buffer_load_dwordx4 v6, s[20:23], s62 offen lds
    s_waitcnt lgkmcnt(11)
    v_mfma_f32_32x32x16_bf16 v[208:223], v[96:99], v[128:131], 0
    s_waitcnt lgkmcnt(10)
    v_mfma_f32_32x32x16_bf16 v[224:239], v[100:103], v[132:135], 0
    s_add_u32 s62, s70, s4
    buffer_load_dwordx4 v[160:163], v3, s[28:31], s62 offen offset:0 sc1
    s_nop 7
    v_add_f32 v216, s65, v216
    v_rcp_f32 v216, v216
    s_nop 0
    v_mul_f32 v208, v208, v216
    v_mul_f32 v209, v209, v216
    v_mul_f32 v210, v210, v216
    v_mul_f32 v211, v211, v216
    v_mul_f32 v212, v212, v216
    v_mul_f32 v213, v213, v216
    v_mul_f32 v214, v214, v216
    v_mul_f32 v215, v215, v216
    v_cvt_pk_bf16_f32 v240, v208, v209
    v_cvt_pk_bf16_f32 v241, v210, v211
    v_cvt_pk_bf16_f32 v242, v212, v213
    v_cvt_pk_bf16_f32 v243, v214, v215
    s_add_u32 s62, s70, s5
    buffer_load_dwordx4 v[176:179], v3, s[28:31], s62 offen offset:0 sc1
    ds_read_b64_tr_b16 v[24:25], v10 offset:2048
    ds_read_b64_tr_b16 v[26:27], v10 offset:3072
    ds_read_b64_tr_b16 v[28:29], v11 offset:2048
    ds_read_b64_tr_b16 v[30:31], v11 offset:3072
    s_waitcnt lgkmcnt(4)
    s_cmp_lg_u32 s50, 0
    s_cbranch_scc1 L_pi_48
    s_load_dwordx8 s[76:83], s[44:45], 0 glc
L_pi_48:
    v_mfma_f32_32x32x16_bf16 v[208:223], v[104:107], v[136:139], 0
    s_add_u32 s62, s70, s4
    buffer_load_dwordx4 v[164:167], v3, s[28:31], s62 offen offset:1024 sc1
    v_add_f32 v224, s65, v224
    v_rcp_f32 v224, v224
    s_nop 0
    v_mul_f32 v232, v232, v224
    v_mul_f32 v233, v233, v224
    v_mul_f32 v234, v234, v224
    v_mul_f32 v235, v235, v224
    v_mul_f32 v236, v236, v224
    v_mfma_f32_32x32x16_bf16 v[32:47], v[16:19], v[240:243], 0
    v_mul_f32 v237, v237, v224
    v_mul_f32 v238, v238, v224
    v_mul_f32 v239, v239, v224
    v_cvt_pk_bf16_f32 v244, v232, v233
    v_cvt_pk_bf16_f32 v245, v234, v235
    v_cvt_pk_bf16_f32 v246, v236, v237
    v_cvt_pk_bf16_f32 v247, v238, v239
    v_mfma_f32_32x32x16_bf16 v[64:79], v[20:23], v[240:243], 0
    s_add_u32 s62, s70, s5
    buffer_load_dwordx4 v[180:183], v3, s[28:31], s62 offen offset:1024 sc1
    ds_read_b64_tr_b16 v[16:17], v10 offset:4096
    ds_read_b64_tr_b16 v[18:19], v10 offset:5120
    ds_read_b64_tr_b16 v[20:21], v11 offset:4096
    ds_read_b64_tr_b16 v[22:23], v11 offset:5120
    s_waitcnt lgkmcnt(4)
    s_waitcnt vmcnt(12)
    v_mfma_f32_32x32x16_bf16 v[224:239], v[108:111], v[140:143], 0
    s_add_u32 s62, s70, s4
    buffer_load_dwordx4 v[168:171], v3, s[28:31], s62 offen offset:2048 sc1
    v_add_f32 v216, s65, v216
    v_rcp_f32 v216, v216
    s_nop 0
    v_mul_f32 v208, v208, v216
    v_mul_f32 v209, v209, v216
    v_mul_f32 v210, v210, v216
    v_mul_f32 v211, v211, v216
    v_mul_f32 v212, v212, v216
    v_mfma_f32_32x32x16_bf16 v[32:47], v[24:27], v[244:247], v[32:47]
    v_mul_f32 v213, v213, v216
    v_mul_f32 v214, v214, v216
    v_mul_f32 v215, v215, v216
    v_cvt_pk_bf16_f32 v240, v208, v209
    v_cvt_pk_bf16_f32 v241, v210, v211
    v_cvt_pk_bf16_f32 v242, v212, v213
    v_cvt_pk_bf16_f32 v243, v214, v215
    v_mfma_f32_32x32x16_bf16 v[64:79], v[28:31], v[244:247], v[64:79]
    s_add_u32 s62, s70, s5
    buffer_load_dwordx4 v[184:187], v3, s[28:31], s62 offen offset:2048 sc1
    ds_read_b64_tr_b16 v[24:25], v10 offset:6144
    ds_read_b64_tr_b16 v[26:27], v10 offset:7168
    ds_read_b64_tr_b16 v[28:29], v11 offset:6144
    ds_read_b64_tr_b16 v[30:31], v11 offset:7168
    s_waitcnt lgkmcnt(4)
    s_waitcnt vmcnt(13)
    v_mfma_f32_32x32x16_bf16 v[208:223], v[112:115], v[144:147], 0
    s_add_u32 s62, s70, s4
    buffer_load_dwordx4 v[172:175], v3, s[28:31], s62 offen offset:3072 sc1
    v_add_f32 v224, s65, v224
    v_rcp_f32 v224, v224
    s_nop 0
    v_mul_f32 v232, v232, v224
    v_mul_f32 v233, v233, v224
    v_mul_f32 v234, v234, v224
    v_mul_f32 v235, v235, v224
    v_mul_f32 v236, v236, v224
    v_mfma_f32_32x32x16_bf16 v[32:47], v[16:19], v[240:243], v[32:47]
    v_mul_f32 v237, v237, v224
    v_mul_f32 v238, v238, v224
    v_mul_f32 v239, v239, v224
    v_cvt_pk_bf16_f32 v244, v232, v233
    v_cvt_pk_bf16_f32 v245, v234, v235
    v_cvt_pk_bf16_f32 v246, v236, v237
    v_cvt_pk_bf16_f32 v247, v238, v239
    v_mfma_f32_32x32x16_bf16 v[64:79], v[20:23], v[240:243], v[64:79]
    s_add_u32 s62, s70, s5
    buffer_load_dwordx4 v[188:191], v3, s[28:31], s62 offen offset:3072 sc1
    s_cmp_lg_u32 s50, 0
    s_cbranch_scc1 L_pc_49
    s_mov_b32 s69, 0
L_pl_50:
    s_waitcnt lgkmcnt(0)
    s_min_u32 s76, s76, s80
    s_min_u32 s77, s77, s81
    s_min_u32 s78, s78, s82
    s_min_u32 s79, s79, s83
    s_min_u32 s76, s76, s78
    s_min_u32 s77, s77, s79
    s_min_u32 s76, s76, s77
    s_cmp_ge_u32 s76, 4
    s_cbranch_scc1 L_pc_49
    s_add_u32 s69, s69, 1
    s_cmp_ge_u32 s69, 0x40000
    s_cbranch_scc1 L_pc_49
    s_load_dwordx8 s[76:83], s[44:45], 0 glc
    s_branch L_pl_50
L_pc_49:
    s_waitcnt lgkmcnt(0)
    s_barrier
    v_subrev_u32 v10, 0x10000, v10
    v_subrev_u32 v11, 0x10000, v11
    ds_read_b64_tr_b16 v[16:17], v8 offset:0
    ds_read_b64_tr_b16 v[18:19], v8 offset:1024
    ds_read_b64_tr_b16 v[20:21], v9 offset:0
    ds_read_b64_tr_b16 v[22:23], v9 offset:1024
    s_waitcnt vmcnt(13)
    v_mfma_f32_32x32x16_bf16 v[224:239], v[116:119], v[148:151], 0
    s_add_u32 m0, s51, 65536
    s_lshl4_add_u32 s62, s5, 0
    buffer_load_dwordx4 v6, s[20:23], s62 offen lds
    v_add_f32 v216, s65, v216
    v_rcp_f32 v216, v216
    s_nop 0
    v_mul_f32 v208, v208, v216
    v_mul_f32 v209, v209, v216
    v_mul_f32 v210, v210, v216
    v_mul_f32 v211, v211, v216
    v_mul_f32 v212, v212, v216
    v_mfma_f32_32x32x16_bf16 v[32:47], v[24:27], v[244:247], v[32:47]
    v_mul_f32 v213, v213, v216
    v_mul_f32 v214, v214, v216
    v_mul_f32 v215, v215, v216
    v_cvt_pk_bf16_f32 v240, v208, v209
    v_cvt_pk_bf16_f32 v241, v210, v211
    v_cvt_pk_bf16_f32 v242, v212, v213
    v_cvt_pk_bf16_f32 v243, v214, v215
    v_mfma_f32_32x32x16_bf16 v[64:79], v[28:31], v[244:247], v[64:79]
    s_add_u32 m0, s51, 98304
    s_mov_b32 s62, 196608
    buffer_load_dwordx4 v6, s[20:23], s62 offen lds
    ds_read_b64_tr_b16 v[24:25], v8 offset:2048
    ds_read_b64_tr_b16 v[26:27], v8 offset:3072
    ds_read_b64_tr_b16 v[28:29], v9 offset:2048
    ds_read_b64_tr_b16 v[30:31], v9 offset:3072
    s_waitcnt lgkmcnt(4)
    s_waitcnt vmcnt(13)
    v_mfma_f32_32x32x16_bf16 v[208:223], v[120:123], v[152:155], 0
    s_add_u32 m0, s51, 73728
    s_lshl4_add_u32 s62, s5, 458752
    buffer_load_dwordx4 v6, s[20:23], s62 offen lds
    v_add_f32 v224, s65, v224
    v_rcp_f32 v224, v224
    s_nop 0
    v_mul_f32 v232, v232, v224
    v_mul_f32 v233, v233, v224
    v_mul_f32 v234, v234, v224
    v_mul_f32 v235, v235, v224
    v_mul_f32 v236, v236, v224
    v_mfma_f32_32x32x16_bf16 v[32:47], v[16:19], v[240:243], v[32:47]
    v_mul_f32 v237, v237, v224
    v_mul_f32 v238, v238, v224
    v_mul_f32 v239, v239, v224
    v_cvt_pk_bf16_f32 v244, v232, v233
    v_cvt_pk_bf16_f32 v245, v234, v235
    v_cvt_pk_bf16_f32 v246, v236, v237
    v_cvt_pk_bf16_f32 v247, v238, v239
    v_mfma_f32_32x32x16_bf16 v[64:79], v[20:23], v[240:243], v[64:79]
    s_add_u32 m0, s51, 106496
    s_mov_b32 s62, 655360
    buffer_load_dwordx4 v6, s[20:23], s62 offen lds
    ds_read_b64_tr_b16 v[16:17], v8 offset:4096
    ds_read_b64_tr_b16 v[18:19], v8 offset:5120
    ds_read_b64_tr_b16 v[20:21], v9 offset:4096
    ds_read_b64_tr_b16 v[22:23], v9 offset:5120
    s_waitcnt lgkmcnt(4)
    s_waitcnt vmcnt(13)
    v_mfma_f32_32x32x16_bf16 v[224:239], v[124:127], v[156:159], 0
    s_add_u32 m0, s51, 81920
    s_lshl4_add_u32 s62, s5, 917504
    buffer_load_dwordx4 v6, s[20:23], s62 offen lds
    v_add_f32 v216, s65, v216
    v_rcp_f32 v216, v216
    s_nop 0
    v_mul_f32 v208, v208, v216
    v_mul_f32 v209, v209, v216
    v_mul_f32 v210, v210, v216
    v_mul_f32 v211, v211, v216
    v_mul_f32 v212, v212, v216
    v_mfma_f32_32x32x16_bf16 v[32:47], v[24:27], v[244:247], v[32:47]
    v_mul_f32 v213, v213, v216
    v_mul_f32 v214, v214, v216
    v_mul_f32 v215, v215, v216
    v_cvt_pk_bf16_f32 v240, v208, v209
    v_cvt_pk_bf16_f32 v241, v210, v211
    v_cvt_pk_bf16_f32 v242, v212, v213
    v_cvt_pk_bf16_f32 v243, v214, v215
    v_mfma_f32_32x32x16_bf16 v[64:79], v[28:31], v[244:247], v[64:79]
    s_add_u32 m0, s51, 114688
    s_mov_b32 s62, 1114112
    buffer_load_dwordx4 v6, s[20:23], s62 offen lds
    ds_read_b64_tr_b16 v[24:25], v8 offset:6144
    ds_read_b64_tr_b16 v[26:27], v8 offset:7168
    ds_read_b64_tr_b16 v[28:29], v9 offset:6144
    ds_read_b64_tr_b16 v[30:31], v9 offset:7168
    s_waitcnt lgkmcnt(4)
    s_add_u32 m0, s51, 90112
    s_lshl4_add_u32 s62, s5, 1376256
    buffer_load_dwordx4 v6, s[20:23], s62 offen lds
    v_add_f32 v224, s65, v224
    v_rcp_f32 v224, v224
    s_nop 0
    v_mul_f32 v232, v232, v224
    v_mul_f32 v233, v233, v224
    v_mul_f32 v234, v234, v224
    v_mul_f32 v235, v235, v224
    v_mul_f32 v236, v236, v224
    v_mfma_f32_32x32x16_bf16 v[32:47], v[16:19], v[240:243], v[32:47]
    v_mul_f32 v237, v237, v224
    v_mul_f32 v238, v238, v224
    v_mul_f32 v239, v239, v224
    v_cvt_pk_bf16_f32 v244, v232, v233
    v_cvt_pk_bf16_f32 v245, v234, v235
    v_cvt_pk_bf16_f32 v246, v236, v237
    v_cvt_pk_bf16_f32 v247, v238, v239
    v_mfma_f32_32x32x16_bf16 v[64:79], v[20:23], v[240:243], v[64:79]
    s_add_u32 m0, s51, 122880
    s_mov_b32 s62, 1572864
    buffer_load_dwordx4 v6, s[20:23], s62 offen lds
    s_waitcnt vmcnt(16)
    s_waitcnt lgkmcnt(0)
    s_barrier
    ds_read_b64_tr_b16 v[16:17], v8 offset:32768
    ds_read_b64_tr_b16 v[18:19], v8 offset:33792
    ds_read_b64_tr_b16 v[20:21], v9 offset:32768
    ds_read_b64_tr_b16 v[22:23], v9 offset:33792
    v_mfma_f32_32x32x16_bf16 v[32:47], v[24:27], v[244:247], v[32:47]
    v_mfma_f32_32x32x16_bf16 v[64:79], v[28:31], v[244:247], v[64:79]
    ds_read_b64_tr_b16 v[24:25], v8 offset:34816
    ds_read_b64_tr_b16 v[26:27], v8 offset:35840
    ds_read_b64_tr_b16 v[28:29], v9 offset:34816
    ds_read_b64_tr_b16 v[30:31], v9 offset:35840
    s_nop 6
    v_cvt_pk_bf16_f32 v32, v32, v33
    v_cvt_pk_bf16_f32 v33, v34, v35
    ds_write_b64 v14, v[32:33] offset:0
    v_cvt_pk_bf16_f32 v64, v64, v65
    v_cvt_pk_bf16_f32 v65, v66, v67
    v_xor_b32 v66, 64, v14
    ds_write_b64 v66, v[64:65] offset:0
    s_waitcnt vmcnt(15) lgkmcnt(6)
    v_mfma_f32_32x32x16_bf16 v[48:63], v[16:19], v[160:163], v[48:63]
    s_add_u32 s62, s70, 12288
    buffer_load_dwordx4 v[128:131], v3, s[28:31], s62 offen offset:0 sc1
    v_mfma_f32_32x32x16_bf16 v[192:207], v[20:23], v[160:163], v[192:207]
    ds_read_b64_tr_b16 v[16:17], v8 offset:36864
    ds_read_b64_tr_b16 v[18:19], v8 offset:37888
    ds_read_b64_tr_b16 v[20:21], v9 offset:36864
    ds_read_b64_tr_b16 v[22:23], v9 offset:37888
    v_cvt_pk_bf16_f32 v36, v36, v37
    v_cvt_pk_bf16_f32 v37, v38, v39
    v_xor_b32 v38, 16, v14
    ds_write_b64 v38, v[36:37] offset:0
    v_cvt_pk_bf16_f32 v68, v68, v69
    v_cvt_pk_bf16_f32 v69, v70, v71
    v_xor_b32 v70, 80, v14
    ds_write_b64 v70, v[68:69] offset:0
    s_waitcnt vmcnt(14) lgkmcnt(8)
    v_mfma_f32_32x32x16_bf16 v[48:63], v[24:27], v[164:167], v[48:63]
    s_add_u32 s62, s70, 12288
    buffer_load_dwordx4 v[132:135], v3, s[28:31], s62 offen offset:1024 sc1
    v_mfma_f32_32x32x16_bf16 v[192:207], v[28:31], v[164:167], v[192:207]
    ds_read_b64_tr_b16 v[24:25], v8 offset:38912
    ds_read_b64_tr_b16 v[26:27], v8 offset:39936
    ds_read_b64_tr_b16 v[28:29], v9 offset:38912
    ds_read_b64_tr_b16 v[30:31], v9 offset:39936
    v_cvt_pk_bf16_f32 v40, v40, v41
    v_cvt_pk_bf16_f32 v41, v42, v43
    v_xor_b32 v42, 32, v14
    ds_write_b64 v42, v[40:41] offset:0
    v_cvt_pk_bf16_f32 v72, v72, v73
    v_cvt_pk_bf16_f32 v73, v74, v75
    v_xor_b32 v74, 96, v14
    ds_write_b64 v74, v[72:73] offset:0
    s_waitcnt vmcnt(13) lgkmcnt(8)
    v_mfma_f32_32x32x16_bf16 v[48:63], v[16:19], v[168:171], v[48:63]
    s_add_u32 s62, s70, 12288
    buffer_load_dwordx4 v[136:139], v3, s[28:31], s62 offen offset:2048 sc1
    v_mfma_f32_32x32x16_bf16 v[192:207], v[20:23], v[168:171], v[192:207]
    v_cvt_pk_bf16_f32 v44, v44, v45
    v_cvt_pk_bf16_f32 v45, v46, v47
    v_xor_b32 v46, 48, v14
    ds_write_b64 v46, v[44:45] offset:0
    v_cvt_pk_bf16_f32 v76, v76, v77
    v_cvt_pk_bf16_f32 v77, v78, v79
    v_xor_b32 v78, 112, v14
    ds_write_b64 v78, v[76:77] offset:0
    s_waitcnt vmcnt(12) lgkmcnt(4)
    s_waitcnt vmcnt(4)
    s_waitcnt lgkmcnt(0)
    s_barrier
    ds_read_b64_tr_b16 v[16:17], v10 offset:0
    ds_read_b64_tr_b16 v[18:19], v10 offset:1024
    ds_read_b64_tr_b16 v[20:21], v11 offset:0
    ds_read_b64_tr_b16 v[22:23], v11 offset:1024
    v_mfma_f32_32x32x16_bf16 v[48:63], v[24:27], v[172:175], v[48:63]
    s_add_u32 s62, s70, 12288
    buffer_load_dwordx4 v[140:143], v3, s[28:31], s62 offen offset:3072 sc1
    v_mfma_f32_32x32x16_bf16 v[192:207], v[28:31], v[172:175], v[192:207]
    ds_read_b64_tr_b16 v[24:25], v10 offset:2048
    ds_read_b64_tr_b16 v[26:27], v10 offset:3072
    ds_read_b64_tr_b16 v[28:29], v11 offset:2048
    ds_read_b64_tr_b16 v[30:31], v11 offset:3072
    buffer_load_dwordx4 v[32:35], v2, s[8:11], s53 offen
    buffer_load_dwordx4 v[36:39], v5, s[40:43], s73 offen
    ds_read_b128 v[224:227], v15 offset:0
    ds_read_b128 v[228:231], v15 offset:8192
    ds_read_b128 v[232:235], v15 offset:16384
    ds_read_b128 v[236:239], v15 offset:24576
    s_waitcnt lgkmcnt(8)
    v_mfma_f32_32x32x16_bf16 v[48:63], v[16:19], v[176:179], v[48:63]
    v_mfma_f32_32x32x16_bf16 v[192:207], v[20:23], v[176:179], v[192:207]
    s_waitcnt lgkmcnt(0)
    v_lshlrev_b32 v96, 16, v224
    v_and_b32 v97, 0xffff0000, v224
    v_lshlrev_b32 v98, 16, v225
    v_and_b32 v99, 0xffff0000, v225
    v_lshlrev_b32 v100, 16, v226
    v_and_b32 v101, 0xffff0000, v226
    ds_read_b64_tr_b16 v[16:17], v10 offset:4096
    ds_read_b64_tr_b16 v[18:19], v10 offset:5120
    ds_read_b64_tr_b16 v[20:21], v11 offset:4096
    ds_read_b64_tr_b16 v[22:23], v11 offset:5120
    v_mfma_f32_32x32x16_bf16 v[48:63], v[24:27], v[180:183], v[48:63]
    v_lshlrev_b32 v102, 16, v227
    v_and_b32 v103, 0xffff0000, v227
    v_lshlrev_b32 v248, 16, v228
    v_and_b32 v228, 0xffff0000, v228
    v_lshlrev_b32 v249, 16, v229
    v_and_b32 v229, 0xffff0000, v229
    v_mfma_f32_32x32x16_bf16 v[192:207], v[28:31], v[180:183], v[192:207]
    v_lshlrev_b32 v250, 16, v230
    v_and_b32 v230, 0xffff0000, v230
    v_lshlrev_b32 v251, 16, v231
    v_and_b32 v231, 0xffff0000, v231
    v_add_f32 v96, v96, v248
    v_add_f32 v97, v97, v228
    ds_read_b64_tr_b16 v[24:25], v10 offset:6144
    ds_read_b64_tr_b16 v[26:27], v10 offset:7168
    ds_read_b64_tr_b16 v[28:29], v11 offset:6144
    ds_read_b64_tr_b16 v[30:31], v11 offset:7168
    s_waitcnt lgkmcnt(4)
    v_mfma_f32_32x32x16_bf16 v[48:63], v[16:19], v[184:187], v[48:63]
    v_add_f32 v98, v98, v249
    v_add_f32 v99, v99, v229
    v_add_f32 v100, v100, v250
    v_add_f32 v101, v101, v230
    v_add_f32 v102, v102, v251
    v_add_f32 v103, v103, v231
    v_mfma_f32_32x32x16_bf16 v[192:207], v[20:23], v[184:187], v[192:207]
    v_lshlrev_b32 v248, 16, v232
    v_and_b32 v232, 0xffff0000, v232
    v_lshlrev_b32 v249, 16, v233
    v_and_b32 v233, 0xffff0000, v233
    v_lshlrev_b32 v250, 16, v234
    v_and_b32 v234, 0xffff0000, v234
    s_waitcnt lgkmcnt(0)
    s_waitcnt vmcnt(6)
    s_barrier
    ds_read_b64_tr_b16 v[16:17], v10 offset:32768
    ds_read_b64_tr_b16 v[18:19], v10 offset:33792
    ds_read_b64_tr_b16 v[20:21], v11 offset:32768
    ds_read_b64_tr_b16 v[22:23], v11 offset:33792
    v_mfma_f32_32x32x16_bf16 v[48:63], v[24:27], v[188:191], v[48:63]
    v_lshlrev_b32 v251, 16, v235
    v_and_b32 v235, 0xffff0000, v235
    v_add_f32 v96, v96, v248
    v_add_f32 v97, v97, v232
    v_add_f32 v98, v98, v249
    v_add_f32 v99, v99, v233
    v_mfma_f32_32x32x16_bf16 v[192:207], v[28:31], v[188:191], v[192:207]
    v_add_f32 v100, v100, v250
    v_add_f32 v101, v101, v234
    v_add_f32 v102, v102, v251
    v_add_f32 v103, v103, v235
    v_lshlrev_b32 v248, 16, v236
    v_and_b32 v236, 0xffff0000, v236
    ds_read_b64_tr_b16 v[24:25], v10 offset:34816
    ds_read_b64_tr_b16 v[26:27], v10 offset:35840
    ds_read_b64_tr_b16 v[28:29], v11 offset:34816
    ds_read_b64_tr_b16 v[30:31], v11 offset:35840
    s_waitcnt vmcnt(5) lgkmcnt(4)
    v_mfma_f32_32x32x16_bf16 v[48:63], v[16:19], v[128:131], v[48:63]
    v_lshlrev_b32 v249, 16, v237
    v_and_b32 v237, 0xffff0000, v237
    v_lshlrev_b32 v250, 16, v238
    v_and_b32 v238, 0xffff0000, v238
    v_lshlrev_b32 v251, 16, v239
    v_and_b32 v239, 0xffff0000, v239
    v_mfma_f32_32x32x16_bf16 v[192:207], v[20:23], v[128:131], v[192:207]
    v_add_f32 v96, v96, v248
    v_add_f32 v97, v97, v236
    v_add_f32 v98, v98, v249
    v_add_f32 v99, v99, v237
    v_add_f32 v100, v100, v250
    v_add_f32 v101, v101, v238
    ds_read_b64_tr_b16 v[16:17], v10 offset:36864
    ds_read_b64_tr_b16 v[18:19], v10 offset:37888
    ds_read_b64_tr_b16 v[20:21], v11 offset:36864
    ds_read_b64_tr_b16 v[22:23], v11 offset:37888
    s_waitcnt vmcnt(4) lgkmcnt(4)
    v_mfma_f32_32x32x16_bf16 v[48:63], v[24:27], v[132:135], v[48:63]
    v_add_f32 v102, v102, v251
    v_add_f32 v103, v103, v239
    s_waitcnt vmcnt(0)
    v_lshlrev_b32 v104, 16, v32
    v_and_b32 v105, 0xffff0000, v32
    v_mfma_f32_32x32x16_bf16 v[192:207], v[28:31], v[132:135], v[192:207]
    v_lshlrev_b32 v106, 16, v33
    v_and_b32 v107, 0xffff0000, v33
    v_lshlrev_b32 v108, 16, v34
    v_and_b32 v109, 0xffff0000, v34
    v_lshlrev_b32 v110, 16, v35
    v_and_b32 v111, 0xffff0000, v35
    ds_read_b64_tr_b16 v[24:25], v10 offset:38912
    ds_read_b64_tr_b16 v[26:27], v10 offset:39936
    ds_read_b64_tr_b16 v[28:29], v11 offset:38912
    ds_read_b64_tr_b16 v[30:31], v11 offset:39936
    s_waitcnt lgkmcnt(4)
    v_mfma_f32_32x32x16_bf16 v[48:63], v[16:19], v[136:139], v[48:63]
    v_lshlrev_b32 v112, 16, v36
    v_and_b32 v113, 0xffff0000, v36
    v_lshlrev_b32 v114, 16, v37
    v_and_b32 v115, 0xffff0000, v37
    v_lshlrev_b32 v116, 16, v38
    v_and_b32 v117, 0xffff0000, v38
    v_mfma_f32_32x32x16_bf16 v[192:207], v[20:23], v[136:139], v[192:207]
    v_lshlrev_b32 v118, 16, v39
    v_and_b32 v119, 0xffff0000, v39
    s_waitcnt lgkmcnt(0)
    v_mfma_f32_32x32x16_bf16 v[48:63], v[24:27], v[140:143], v[48:63]
    v_mfma_f32_32x32x16_bf16 v[192:207], v[28:31], v[140:143], v[192:207]
    s_nop 10
    v_cvt_pk_bf16_f32 v48, v48, v49
    v_cvt_pk_bf16_f32 v49, v50, v51
    ds_write_b64 v14, v[48:49] offset:32768
    v_cvt_pk_bf16_f32 v52, v52, v53
    v_cvt_pk_bf16_f32 v53, v54, v55
    v_xor_b32 v54, 16, v14
    ds_write_b64 v54, v[52:53] offset:32768
    v_cvt_pk_bf16_f32 v56, v56, v57
    v_cvt_pk_bf16_f32 v57, v58, v59
    v_xor_b32 v58, 32, v14
    ds_write_b64 v58, v[56:57] offset:32768
    v_cvt_pk_bf16_f32 v60, v60, v61
    v_cvt_pk_bf16_f32 v61, v62, v63
    v_xor_b32 v62, 48, v14
    ds_write_b64 v62, v[60:61] offset:32768
    v_cvt_pk_bf16_f32 v192, v192, v193
    v_cvt_pk_bf16_f32 v193, v194, v195
    v_xor_b32 v194, 64, v14
    ds_write_b64 v194, v[192:193] offset:32768
    v_cvt_pk_bf16_f32 v196, v196, v197
    v_cvt_pk_bf16_f32 v197, v198, v199
    v_xor_b32 v198, 80, v14
    ds_write_b64 v198, v[196:197] offset:32768
    v_cvt_pk_bf16_f32 v200, v200, v201
    v_cvt_pk_bf16_f32 v201, v202, v203
    v_xor_b32 v202, 96, v14
    ds_write_b64 v202, v[200:201] offset:32768
    v_cvt_pk_bf16_f32 v204, v204, v205
    v_cvt_pk_bf16_f32 v205, v206, v207
    v_xor_b32 v206, 112, v14
    ds_write_b64 v206, v[204:205] offset:32768
    s_waitcnt lgkmcnt(0)
    s_barrier
    ds_read_b128 v[224:227], v15 offset:32768
    ds_read_b128 v[228:231], v15 offset:40960
    ds_read_b128 v[232:235], v15 offset:49152
    ds_read_b128 v[236:239], v15 offset:57344
    s_waitcnt lgkmcnt(3)
    v_lshlrev_b32 v248, 16, v224
    v_and_b32 v224, 0xffff0000, v224
    v_lshlrev_b32 v249, 16, v225
    v_and_b32 v225, 0xffff0000, v225
    v_lshlrev_b32 v250, 16, v226
    v_and_b32 v226, 0xffff0000, v226
    v_lshlrev_b32 v251, 16, v227
    v_and_b32 v227, 0xffff0000, v227
    v_add_f32 v208, v112, v248
    v_add_f32 v209, v113, v224
    v_add_f32 v210, v114, v249
    v_add_f32 v211, v115, v225
    v_add_f32 v212, v116, v250
    v_add_f32 v213, v117, v226
    v_add_f32 v214, v118, v251
    v_add_f32 v215, v119, v227
    s_waitcnt lgkmcnt(2)
    v_lshlrev_b32 v248, 16, v228
    v_and_b32 v228, 0xffff0000, v228
    v_lshlrev_b32 v249, 16, v229
    v_and_b32 v229, 0xffff0000, v229
    v_lshlrev_b32 v250, 16, v230
    v_and_b32 v230, 0xffff0000, v230
    v_lshlrev_b32 v251, 16, v231
    v_and_b32 v231, 0xffff0000, v231
    v_add_f32 v208, v208, v248
    v_add_f32 v209, v209, v228
    v_add_f32 v210, v210, v249
    v_add_f32 v211, v211, v229
    v_add_f32 v212, v212, v250
    v_add_f32 v213, v213, v230
    v_add_f32 v214, v214, v251
    v_add_f32 v215, v215, v231
    s_waitcnt lgkmcnt(1)
    v_lshlrev_b32 v248, 16, v232
    v_and_b32 v232, 0xffff0000, v232
    v_lshlrev_b32 v249, 16, v233
    v_and_b32 v233, 0xffff0000, v233
    v_lshlrev_b32 v250, 16, v234
    v_and_b32 v234, 0xffff0000, v234
    v_lshlrev_b32 v251, 16, v235
    v_and_b32 v235, 0xffff0000, v235
    v_add_f32 v208, v208, v248
    v_add_f32 v209, v209, v232
    v_add_f32 v210, v210, v249
    v_add_f32 v211, v211, v233
    v_add_f32 v212, v212, v250
    v_add_f32 v213, v213, v234
    v_add_f32 v214, v214, v251
    v_add_f32 v215, v215, v235
    s_waitcnt lgkmcnt(0)
    v_lshlrev_b32 v248, 16, v236
    v_and_b32 v236, 0xffff0000, v236
    v_lshlrev_b32 v249, 16, v237
    v_and_b32 v237, 0xffff0000, v237
    v_lshlrev_b32 v250, 16, v238
    v_and_b32 v238, 0xffff0000, v238
    v_lshlrev_b32 v251, 16, v239
    v_and_b32 v239, 0xffff0000, v239
    v_add_f32 v208, v208, v248
    v_add_f32 v209, v209, v236
    v_add_f32 v210, v210, v249
    v_add_f32 v211, v211, v237
    v_add_f32 v212, v212, v250
    v_add_f32 v213, v213, v238
    v_add_f32 v214, v214, v251
    v_add_f32 v215, v215, v239
    v_mul_f32 v216, 0xbfb8aa3b, v208
    v_mul_f32 v217, 0xbfb8aa3b, v209
    v_mul_f32 v218, 0xbfb8aa3b, v210
    v_mul_f32 v219, 0xbfb8aa3b, v211
    v_mul_f32 v220, 0xbfb8aa3b, v212
    v_mul_f32 v221, 0xbfb8aa3b, v213
    v_mul_f32 v222, 0xbfb8aa3b, v214
    v_mul_f32 v223, 0xbfb8aa3b, v215
    v_exp_f32 v216, v216
    v_exp_f32 v217, v217
    v_exp_f32 v218, v218
    v_exp_f32 v219, v219
    v_exp_f32 v220, v220
    v_exp_f32 v221, v221
    v_exp_f32 v222, v222
    v_exp_f32 v223, v223
    v_mul_f32 v208, v208, v96
    v_mul_f32 v209, v209, v97
    v_mul_f32 v210, v210, v98
    v_mul_f32 v211, v211, v99
    v_mul_f32 v212, v212, v100
    v_mul_f32 v213, v213, v101
    v_mul_f32 v214, v214, v102
    v_mul_f32 v215, v215, v103
    v_add_f32 v216, 1.0, v216
    v_add_f32 v217, 1.0, v217
    v_add_f32 v218, 1.0, v218
    v_add_f32 v219, 1.0, v219
    v_add_f32 v220, 1.0, v220
    v_add_f32 v221, 1.0, v221
    v_add_f32 v222, 1.0, v222
    v_add_f32 v223, 1.0, v223
    v_rcp_f32 v216, v216
    v_rcp_f32 v217, v217
    v_rcp_f32 v218, v218
    v_rcp_f32 v219, v219
    v_rcp_f32 v220, v220
    v_rcp_f32 v221, v221
    v_rcp_f32 v222, v222
    v_rcp_f32 v223, v223
    v_fma_f32 v208, v208, v216, v104
    v_fma_f32 v209, v209, v217, v105
    v_fma_f32 v210, v210, v218, v106
    v_fma_f32 v211, v211, v219, v107
    v_fma_f32 v212, v212, v220, v108
    v_fma_f32 v213, v213, v221, v109
    v_fma_f32 v214, v214, v222, v110
    v_fma_f32 v215, v215, v223, v111
    v_cvt_pk_bf16_f32 v216, v208, v209
    v_cvt_pk_bf16_f32 v217, v210, v211
    v_cvt_pk_bf16_f32 v218, v212, v213
    v_cvt_pk_bf16_f32 v219, v214, v215
    buffer_store_dwordx4 v[216:219], v2, s[16:19], s53 offen sc1
    s_endpgm
L_code_end:

.section .rodata,"a"
.p2align 6
.amdhsa_kernel recurrent_scan__linear_attn_block__dense_activation_gelu__prompt_kernel
  .amdhsa_next_free_vgpr 256
  .amdhsa_next_free_sgpr 102
  .amdhsa_accum_offset 256
  .amdhsa_group_segment_fixed_size 0
  .amdhsa_kernarg_size 88
  .amdhsa_user_sgpr_count 2
  .amdhsa_user_sgpr_kernarg_segment_ptr 1
  .amdhsa_system_sgpr_workgroup_id_x 1
  .amdhsa_float_denorm_mode_32 3
.end_amdhsa_kernel
```
